```python
import torch

def _softmax(x, axis=-1):
    return torch.softmax(x, dim=axis)
def _gelu(x):
    return torch.nn.functional.gelu(x, approximate="tanh")
def _silu(x):
    return torch.nn.functional.silu(x)
def _sigmoid(x):
    return torch.sigmoid(x)
def _layernorm(x, axis=-1, eps=1e-5):
    m = x.mean(dim=axis, keepdim=True)
    v = x.var(dim=axis, keepdim=True, unbiased=False)
    return (x - m) / torch.sqrt(v + eps)
def _scatter_add(tgt, idx, src, axis=0):
    return tgt.clone().index_add_(axis, idx, src)
def _segment_sum(src, seg, n):
    out = torch.zeros((n,) + src.shape[1:], dtype=src.dtype)
    return out.index_add_(0, seg, src)
def _pad(x, pw):
    flat = tuple(v for pair in reversed(pw) for v in pair)
    return torch.nn.functional.pad(x, flat)

kernel_name = 'standalone__gqa_softmax__near_ridge'

def setup_inputs():

    _w = (lambda a: (lambda t: t.to(torch.bfloat16) if t.is_floating_point() else t)(torch.as_tensor(a)))
    B, Hq, Hkv, Sq, Sk, D = 16, 32, 4, 384, 384, 128
    return {
        "q": _w((lambda *s: torch.randn(*s, dtype=torch.bfloat16) * 0.8)(B, Hq, Sq, D)),
        "k": _w((lambda *s: torch.randn(*s, dtype=torch.bfloat16) * 0.8)(B, Hkv, Sk, D)),
        "v": _w((lambda *s: torch.randn(*s, dtype=torch.bfloat16) * 0.05)(B, Hkv, Sk, D)),
    }

def reference(q, k, v):
    B, Hq, Sq, D = q.shape
    Hkv = k.shape[1]
    rep = Hq // Hkv
    k = (lambda x, n, axis: torch.repeat_interleave(x, n, dim=axis))(k, rep, axis=1)
    v = (lambda x, n, axis: torch.repeat_interleave(x, n, dim=axis))(v, rep, axis=1)
    scale = D ** -0.5
    scores = torch.einsum("bhqd,bhkd->bhqk", q, k) * scale
    p = _softmax(scores, axis=-1)
    return torch.einsum("bhqk,bhkd->bhqd", p, v)
```

```asm
; @launch grid=(256,1,1) block=(512,1,1) lds=163840
.amdgcn_target "amdgcn-amd-amdhsa--gfx950"
.text
.globl standalone__gqa_softmax__near_ridge_kernel
.p2align 8
.type standalone__gqa_softmax__near_ridge_kernel,@function
standalone__gqa_softmax__near_ridge_kernel:
    s_cmp_ge_u32 s2, 256
    s_cbranch_scc1 L_end
    s_load_dwordx4 s[4:7], s[0:1], 0
    s_load_dwordx4 s[8:11], s[0:1], 16
    v_and_b32 v64, 63, v0
    v_lshrrev_b32 v65, 6, v0
    s_nop 0
    v_readfirstlane_b32 s28, v65
    s_and_b32 s30, s2, 7
    s_lshr_b32 s31, s2, 3
    s_lshr_b32 s32, s31, 2
    s_lshl_b32 s30, s30, 3
    s_add_u32 s30, s30, s32
    s_and_b32 s31, s31, 3
    s_mul_i32 s29, s30, 98304
    s_mul_i32 s33, s30, 786432
    s_mul_i32 s34, s31, 196608
    s_add_u32 s33, s33, s34
    s_lshl_b32 s34, s28, 13
    s_add_u32 s33, s33, s34
    s_add_u32 s34, s33, 65536
    s_add_u32 s35, s33, 131072
    s_lshl_b32 s36, s28, 10
    s_add_u32 s37, s29, s36
    s_lshr_b32 s39, s28, 2
    s_lshl_b32 s40, s39, 15
    s_xor_b32 s41, s40, 32768
    s_mov_b32 s42, s40
    s_add_u32 s43, s40, 32768
    s_cmp_eq_u32 s39, 0
    s_cselect_b32 s44, 65536, 0
    s_sub_u32 s45, s43, s42
    s_sub_u32 s46, s44, s43
    s_sub_u32 s47, s42, s44
    s_add_u32 s80, s36, 98304
    s_add_u32 s81, s80, s41
    s_add_u32 s80, s80, s40
    s_add_u32 s82, s37, s42
    s_add_u32 s83, s37, s43
    s_add_u32 s84, s37, s44
    s_sub_u32 s85, s41, s40
    s_sub_u32 s86, s40, s41
    v_and_b32 v66, 15, v64
    v_lshrrev_b32 v68, 4, v64
    v_lshlrev_b32 v70, 8, v66
    v_lshl_add_u32 v236, v68, 4, v70
    v_and_b32 v67, 1, v68
    v_lshl_add_u32 v237, v67, 5, v70
    v_lshrrev_b32 v67, 1, v68
    v_lshl_add_u32 v237, v67, 4, v237
    v_lshrrev_b32 v67, 3, v66
    v_mul_u32_u24 v67, 1984, v67
    v_sub_u32 v237, v237, v67
    s_mov_b32 s96, 0xff00ff00
    s_mov_b32 s97, 0xff00ff00
    v_xor_b32 v239, v66, v68
    v_xor_b32 v224, 0, v239
    v_lshl_add_u32 v224, v224, 4, v70
    v_add_u32 v224, s42, v224
    v_xor_b32 v225, 4, v239
    v_lshl_add_u32 v225, v225, 4, v70
    v_add_u32 v225, s42, v225
    v_xor_b32 v226, 8, v239
    v_lshl_add_u32 v226, v226, 4, v70
    v_add_u32 v226, s42, v226
    v_xor_b32 v227, 12, v239
    v_lshl_add_u32 v227, v227, 4, v70
    v_add_u32 v227, s42, v227
    v_bfe_u32 v69, v64, 2, 2
    v_lshl_add_u32 v69, v68, 2, v69
    v_lshlrev_b32 v239, 8, v69
    v_and_b32 v67, 3, v64
    v_lshl_add_u32 v239, v67, 3, v239
    v_add_u32 v239, 98304, v239
    v_add_u32 v239, s40, v239
    v_and_b32 v69, 7, v69
    v_xor_b32 v228, 0, v69
    v_lshl_add_u32 v228, v228, 5, v239
    v_xor_b32 v229, 1, v69
    v_lshl_add_u32 v229, v229, 5, v239
    v_xor_b32 v230, 2, v69
    v_lshl_add_u32 v230, v230, 5, v239
    v_xor_b32 v231, 3, v69
    v_lshl_add_u32 v231, v231, 5, v239
    v_xor_b32 v232, 4, v69
    v_lshl_add_u32 v232, v232, 5, v239
    v_xor_b32 v233, 5, v69
    v_lshl_add_u32 v233, v233, 5, v239
    v_xor_b32 v234, 6, v69
    v_lshl_add_u32 v234, v234, 5, v239
    v_xor_b32 v235, 7, v69
    v_lshl_add_u32 v235, v235, 5, v239
    v_and_b32 v239, 1, v65
    v_lshl_add_u32 v239, v239, 2, v68
    v_lshlrev_b32 v239, 1, v239
    v_xor_b32 v239, v239, v66
    v_lshlrev_b32 v239, 4, v239
    v_lshl_add_u32 v238, v68, 8, v239
    v_and_b32 v239, 3, v65
    v_lshlrev_b32 v101, 10, v239
    v_lshl_add_u32 v101, v64, 4, v101
    v_lshl_add_u32 v239, v239, 2, v68
    v_xor_b32 v239, v239, v66
    v_lshlrev_b32 v239, 4, v239
    v_lshl_add_u32 v100, v68, 8, v239
    s_and_b32 s87, s28, 3
    s_lshl_b32 s87, s87, 10
    s_add_u32 s87, s87, s29
    s_waitcnt lgkmcnt(0)
    s_mov_b32 s12, s4
    s_and_b32 s13, s5, 0xffff
    s_mov_b32 s14, 50331648
    s_mov_b32 s15, 0x00020000
    s_mov_b32 s16, s6
    s_and_b32 s17, s7, 0xffff
    s_mov_b32 s18, 6291456
    s_mov_b32 s19, 0x00020000
    s_mov_b32 s20, s8
    s_and_b32 s21, s9, 0xffff
    s_mov_b32 s22, 6291456
    s_mov_b32 s23, 0x00020000
    s_mov_b32 s24, s10
    s_and_b32 s25, s11, 0xffff
    s_mov_b32 s26, 50331648
    s_mov_b32 s27, 0x00020000
    s_add_u32 s93, s33, 4096
    s_add_u32 s94, s34, 4096
    s_add_u32 s95, s35, 4096
    s_cmp_lg_u32 s39, 0
    s_cbranch_scc1 L_preB
    buffer_load_dwordx4 v[128:131], v236, s[12:15], s33 offen offset:0 nt
    buffer_load_dwordx4 v[132:135], v236, s[12:15], s33 offen offset:64 nt
    buffer_load_dwordx4 v[136:139], v236, s[12:15], s33 offen offset:128 nt
    buffer_load_dwordx4 v[140:143], v236, s[12:15], s33 offen offset:192 nt
    buffer_load_dwordx4 v[144:147], v236, s[12:15], s93 offen offset:0 nt
    buffer_load_dwordx4 v[148:151], v236, s[12:15], s93 offen offset:64 nt
    buffer_load_dwordx4 v[152:155], v236, s[12:15], s93 offen offset:128 nt
    buffer_load_dwordx4 v[156:159], v236, s[12:15], s93 offen offset:192 nt
    s_add_u32 m0, s36, 98304
    s_add_u32 s38, s37, 0
    buffer_load_dwordx4 v238, s[20:23], s38 offen nt lds
    s_add_u32 m0, s36, 106496
    s_add_u32 s38, s37, 8192
    buffer_load_dwordx4 v238, s[20:23], s38 offen nt lds
    s_add_u32 m0, s36, 114688
    s_add_u32 s38, s37, 16384
    buffer_load_dwordx4 v238, s[20:23], s38 offen nt lds
    s_add_u32 m0, s36, 122880
    s_add_u32 s38, s37, 24576
    buffer_load_dwordx4 v238, s[20:23], s38 offen nt lds
    s_barrier
    s_waitcnt vmcnt(4)
    s_branch L_common
L_preB:
    s_add_u32 s38, s87, 0
    buffer_load_dwordx4 v[0:3], v100, s[16:19], s38 offen nt
    s_add_u32 s38, s87, 4096
    buffer_load_dwordx4 v[4:7], v100, s[16:19], s38 offen nt
    s_add_u32 s38, s87, 8192
    buffer_load_dwordx4 v[8:11], v100, s[16:19], s38 offen nt
    s_add_u32 s38, s87, 12288
    buffer_load_dwordx4 v[12:15], v100, s[16:19], s38 offen nt
    s_add_u32 s38, s87, 16384
    buffer_load_dwordx4 v[16:19], v100, s[16:19], s38 offen nt
    s_add_u32 s38, s87, 20480
    buffer_load_dwordx4 v[20:23], v100, s[16:19], s38 offen nt
    s_add_u32 s38, s87, 24576
    buffer_load_dwordx4 v[24:27], v100, s[16:19], s38 offen nt
    s_add_u32 s38, s87, 28672
    buffer_load_dwordx4 v[28:31], v100, s[16:19], s38 offen nt
    s_add_u32 s38, s87, 32768
    buffer_load_dwordx4 v[192:195], v100, s[16:19], s38 offen nt
    s_add_u32 s38, s87, 36864
    buffer_load_dwordx4 v[196:199], v100, s[16:19], s38 offen nt
    s_add_u32 s38, s87, 40960
    buffer_load_dwordx4 v[200:203], v100, s[16:19], s38 offen nt
    s_add_u32 s38, s87, 45056
    buffer_load_dwordx4 v[204:207], v100, s[16:19], s38 offen nt
    s_add_u32 s38, s87, 49152
    buffer_load_dwordx4 v[208:211], v100, s[16:19], s38 offen nt
    s_add_u32 s38, s87, 53248
    buffer_load_dwordx4 v[212:215], v100, s[16:19], s38 offen nt
    s_add_u32 s38, s87, 57344
    buffer_load_dwordx4 v[216:219], v100, s[16:19], s38 offen nt
    s_add_u32 s38, s87, 61440
    buffer_load_dwordx4 v[220:223], v100, s[16:19], s38 offen nt
    s_add_u32 m0, s36, 98304
    s_add_u32 s38, s37, 0
    buffer_load_dwordx4 v238, s[20:23], s38 offen nt lds
    s_add_u32 m0, s36, 106496
    s_add_u32 s38, s37, 8192
    buffer_load_dwordx4 v238, s[20:23], s38 offen nt lds
    s_add_u32 m0, s36, 114688
    s_add_u32 s38, s37, 16384
    buffer_load_dwordx4 v238, s[20:23], s38 offen nt lds
    s_add_u32 m0, s36, 122880
    s_add_u32 s38, s37, 24576
    buffer_load_dwordx4 v238, s[20:23], s38 offen nt lds
    s_waitcnt vmcnt(19)
    v_lshlrev_b32 v40, 16, v0
    v_and_b32 v41, 0xffff0000, v0
    v_mul_f32 v40, 0x3e0293ee, v40
    v_mul_f32 v41, 0x3e0293ee, v41
    v_cvt_pk_bf16_f32 v0, v40, v41
    v_lshlrev_b32 v40, 16, v1
    v_and_b32 v41, 0xffff0000, v1
    v_mul_f32 v40, 0x3e0293ee, v40
    v_mul_f32 v41, 0x3e0293ee, v41
    v_cvt_pk_bf16_f32 v1, v40, v41
    v_lshlrev_b32 v40, 16, v2
    v_and_b32 v41, 0xffff0000, v2
    v_mul_f32 v40, 0x3e0293ee, v40
    v_mul_f32 v41, 0x3e0293ee, v41
    v_cvt_pk_bf16_f32 v2, v40, v41
    v_lshlrev_b32 v40, 16, v3
    v_and_b32 v41, 0xffff0000, v3
    v_mul_f32 v40, 0x3e0293ee, v40
    v_mul_f32 v41, 0x3e0293ee, v41
    v_cvt_pk_bf16_f32 v3, v40, v41
    ds_write_b128 v101, v[0:3] offset:0
    s_waitcnt vmcnt(18)
    v_lshlrev_b32 v40, 16, v4
    v_and_b32 v41, 0xffff0000, v4
    v_mul_f32 v40, 0x3e0293ee, v40
    v_mul_f32 v41, 0x3e0293ee, v41
    v_cvt_pk_bf16_f32 v4, v40, v41
    v_lshlrev_b32 v40, 16, v5
    v_and_b32 v41, 0xffff0000, v5
    v_mul_f32 v40, 0x3e0293ee, v40
    v_mul_f32 v41, 0x3e0293ee, v41
    v_cvt_pk_bf16_f32 v5, v40, v41
    v_lshlrev_b32 v40, 16, v6
    v_and_b32 v41, 0xffff0000, v6
    v_mul_f32 v40, 0x3e0293ee, v40
    v_mul_f32 v41, 0x3e0293ee, v41
    v_cvt_pk_bf16_f32 v6, v40, v41
    v_lshlrev_b32 v40, 16, v7
    v_and_b32 v41, 0xffff0000, v7
    v_mul_f32 v40, 0x3e0293ee, v40
    v_mul_f32 v41, 0x3e0293ee, v41
    v_cvt_pk_bf16_f32 v7, v40, v41
    ds_write_b128 v101, v[4:7] offset:4096
    s_waitcnt vmcnt(17)
    v_lshlrev_b32 v40, 16, v8
    v_and_b32 v41, 0xffff0000, v8
    v_mul_f32 v40, 0x3e0293ee, v40
    v_mul_f32 v41, 0x3e0293ee, v41
    v_cvt_pk_bf16_f32 v8, v40, v41
    v_lshlrev_b32 v40, 16, v9
    v_and_b32 v41, 0xffff0000, v9
    v_mul_f32 v40, 0x3e0293ee, v40
    v_mul_f32 v41, 0x3e0293ee, v41
    v_cvt_pk_bf16_f32 v9, v40, v41
    v_lshlrev_b32 v40, 16, v10
    v_and_b32 v41, 0xffff0000, v10
    v_mul_f32 v40, 0x3e0293ee, v40
    v_mul_f32 v41, 0x3e0293ee, v41
    v_cvt_pk_bf16_f32 v10, v40, v41
    v_lshlrev_b32 v40, 16, v11
    v_and_b32 v41, 0xffff0000, v11
    v_mul_f32 v40, 0x3e0293ee, v40
    v_mul_f32 v41, 0x3e0293ee, v41
    v_cvt_pk_bf16_f32 v11, v40, v41
    ds_write_b128 v101, v[8:11] offset:8192
    s_waitcnt vmcnt(16)
    v_lshlrev_b32 v40, 16, v12
    v_and_b32 v41, 0xffff0000, v12
    v_mul_f32 v40, 0x3e0293ee, v40
    v_mul_f32 v41, 0x3e0293ee, v41
    v_cvt_pk_bf16_f32 v12, v40, v41
    v_lshlrev_b32 v40, 16, v13
    v_and_b32 v41, 0xffff0000, v13
    v_mul_f32 v40, 0x3e0293ee, v40
    v_mul_f32 v41, 0x3e0293ee, v41
    v_cvt_pk_bf16_f32 v13, v40, v41
    v_lshlrev_b32 v40, 16, v14
    v_and_b32 v41, 0xffff0000, v14
    v_mul_f32 v40, 0x3e0293ee, v40
    v_mul_f32 v41, 0x3e0293ee, v41
    v_cvt_pk_bf16_f32 v14, v40, v41
    v_lshlrev_b32 v40, 16, v15
    v_and_b32 v41, 0xffff0000, v15
    v_mul_f32 v40, 0x3e0293ee, v40
    v_mul_f32 v41, 0x3e0293ee, v41
    v_cvt_pk_bf16_f32 v15, v40, v41
    ds_write_b128 v101, v[12:15] offset:12288
    s_waitcnt vmcnt(15)
    v_lshlrev_b32 v40, 16, v16
    v_and_b32 v41, 0xffff0000, v16
    v_mul_f32 v40, 0x3e0293ee, v40
    v_mul_f32 v41, 0x3e0293ee, v41
    v_cvt_pk_bf16_f32 v16, v40, v41
    v_lshlrev_b32 v40, 16, v17
    v_and_b32 v41, 0xffff0000, v17
    v_mul_f32 v40, 0x3e0293ee, v40
    v_mul_f32 v41, 0x3e0293ee, v41
    v_cvt_pk_bf16_f32 v17, v40, v41
    v_lshlrev_b32 v40, 16, v18
    v_and_b32 v41, 0xffff0000, v18
    v_mul_f32 v40, 0x3e0293ee, v40
    v_mul_f32 v41, 0x3e0293ee, v41
    v_cvt_pk_bf16_f32 v18, v40, v41
    v_lshlrev_b32 v40, 16, v19
    v_and_b32 v41, 0xffff0000, v19
    v_mul_f32 v40, 0x3e0293ee, v40
    v_mul_f32 v41, 0x3e0293ee, v41
    v_cvt_pk_bf16_f32 v19, v40, v41
    ds_write_b128 v101, v[16:19] offset:16384
    s_waitcnt vmcnt(14)
    v_lshlrev_b32 v40, 16, v20
    v_and_b32 v41, 0xffff0000, v20
    v_mul_f32 v40, 0x3e0293ee, v40
    v_mul_f32 v41, 0x3e0293ee, v41
    v_cvt_pk_bf16_f32 v20, v40, v41
    v_lshlrev_b32 v40, 16, v21
    v_and_b32 v41, 0xffff0000, v21
    v_mul_f32 v40, 0x3e0293ee, v40
    v_mul_f32 v41, 0x3e0293ee, v41
    v_cvt_pk_bf16_f32 v21, v40, v41
    v_lshlrev_b32 v40, 16, v22
    v_and_b32 v41, 0xffff0000, v22
    v_mul_f32 v40, 0x3e0293ee, v40
    v_mul_f32 v41, 0x3e0293ee, v41
    v_cvt_pk_bf16_f32 v22, v40, v41
    v_lshlrev_b32 v40, 16, v23
    v_and_b32 v41, 0xffff0000, v23
    v_mul_f32 v40, 0x3e0293ee, v40
    v_mul_f32 v41, 0x3e0293ee, v41
    v_cvt_pk_bf16_f32 v23, v40, v41
    ds_write_b128 v101, v[20:23] offset:20480
    s_waitcnt vmcnt(13)
    v_lshlrev_b32 v40, 16, v24
    v_and_b32 v41, 0xffff0000, v24
    v_mul_f32 v40, 0x3e0293ee, v40
    v_mul_f32 v41, 0x3e0293ee, v41
    v_cvt_pk_bf16_f32 v24, v40, v41
    v_lshlrev_b32 v40, 16, v25
    v_and_b32 v41, 0xffff0000, v25
    v_mul_f32 v40, 0x3e0293ee, v40
    v_mul_f32 v41, 0x3e0293ee, v41
    v_cvt_pk_bf16_f32 v25, v40, v41
    v_lshlrev_b32 v40, 16, v26
    v_and_b32 v41, 0xffff0000, v26
    v_mul_f32 v40, 0x3e0293ee, v40
    v_mul_f32 v41, 0x3e0293ee, v41
    v_cvt_pk_bf16_f32 v26, v40, v41
    v_lshlrev_b32 v40, 16, v27
    v_and_b32 v41, 0xffff0000, v27
    v_mul_f32 v40, 0x3e0293ee, v40
    v_mul_f32 v41, 0x3e0293ee, v41
    v_cvt_pk_bf16_f32 v27, v40, v41
    ds_write_b128 v101, v[24:27] offset:24576
    s_waitcnt vmcnt(12)
    v_lshlrev_b32 v40, 16, v28
    v_and_b32 v41, 0xffff0000, v28
    v_mul_f32 v40, 0x3e0293ee, v40
    v_mul_f32 v41, 0x3e0293ee, v41
    v_cvt_pk_bf16_f32 v28, v40, v41
    v_lshlrev_b32 v40, 16, v29
    v_and_b32 v41, 0xffff0000, v29
    v_mul_f32 v40, 0x3e0293ee, v40
    v_mul_f32 v41, 0x3e0293ee, v41
    v_cvt_pk_bf16_f32 v29, v40, v41
    v_lshlrev_b32 v40, 16, v30
    v_and_b32 v41, 0xffff0000, v30
    v_mul_f32 v40, 0x3e0293ee, v40
    v_mul_f32 v41, 0x3e0293ee, v41
    v_cvt_pk_bf16_f32 v30, v40, v41
    v_lshlrev_b32 v40, 16, v31
    v_and_b32 v41, 0xffff0000, v31
    v_mul_f32 v40, 0x3e0293ee, v40
    v_mul_f32 v41, 0x3e0293ee, v41
    v_cvt_pk_bf16_f32 v31, v40, v41
    ds_write_b128 v101, v[28:31] offset:28672
    s_waitcnt lgkmcnt(0)
    s_barrier
    buffer_load_dwordx4 v[128:131], v236, s[12:15], s33 offen offset:0 nt
    buffer_load_dwordx4 v[132:135], v236, s[12:15], s33 offen offset:64 nt
    buffer_load_dwordx4 v[136:139], v236, s[12:15], s33 offen offset:128 nt
    buffer_load_dwordx4 v[140:143], v236, s[12:15], s33 offen offset:192 nt
    buffer_load_dwordx4 v[144:147], v236, s[12:15], s93 offen offset:0 nt
    buffer_load_dwordx4 v[148:151], v236, s[12:15], s93 offen offset:64 nt
    buffer_load_dwordx4 v[152:155], v236, s[12:15], s93 offen offset:128 nt
    buffer_load_dwordx4 v[156:159], v236, s[12:15], s93 offen offset:192 nt
    s_waitcnt vmcnt(19)
    v_lshlrev_b32 v40, 16, v192
    v_and_b32 v41, 0xffff0000, v192
    v_mul_f32 v40, 0x3e0293ee, v40
    v_mul_f32 v41, 0x3e0293ee, v41
    v_cvt_pk_bf16_f32 v192, v40, v41
    v_lshlrev_b32 v40, 16, v193
    v_and_b32 v41, 0xffff0000, v193
    v_mul_f32 v40, 0x3e0293ee, v40
    v_mul_f32 v41, 0x3e0293ee, v41
    v_cvt_pk_bf16_f32 v193, v40, v41
    v_lshlrev_b32 v40, 16, v194
    v_and_b32 v41, 0xffff0000, v194
    v_mul_f32 v40, 0x3e0293ee, v40
    v_mul_f32 v41, 0x3e0293ee, v41
    v_cvt_pk_bf16_f32 v194, v40, v41
    v_lshlrev_b32 v40, 16, v195
    v_and_b32 v41, 0xffff0000, v195
    v_mul_f32 v40, 0x3e0293ee, v40
    v_mul_f32 v41, 0x3e0293ee, v41
    v_cvt_pk_bf16_f32 v195, v40, v41
    ds_write_b128 v101, v[192:195] offset:32768
    s_waitcnt vmcnt(18)
    v_lshlrev_b32 v40, 16, v196
    v_and_b32 v41, 0xffff0000, v196
    v_mul_f32 v40, 0x3e0293ee, v40
    v_mul_f32 v41, 0x3e0293ee, v41
    v_cvt_pk_bf16_f32 v196, v40, v41
    v_lshlrev_b32 v40, 16, v197
    v_and_b32 v41, 0xffff0000, v197
    v_mul_f32 v40, 0x3e0293ee, v40
    v_mul_f32 v41, 0x3e0293ee, v41
    v_cvt_pk_bf16_f32 v197, v40, v41
    v_lshlrev_b32 v40, 16, v198
    v_and_b32 v41, 0xffff0000, v198
    v_mul_f32 v40, 0x3e0293ee, v40
    v_mul_f32 v41, 0x3e0293ee, v41
    v_cvt_pk_bf16_f32 v198, v40, v41
    v_lshlrev_b32 v40, 16, v199
    v_and_b32 v41, 0xffff0000, v199
    v_mul_f32 v40, 0x3e0293ee, v40
    v_mul_f32 v41, 0x3e0293ee, v41
    v_cvt_pk_bf16_f32 v199, v40, v41
    ds_write_b128 v101, v[196:199] offset:36864
    s_waitcnt vmcnt(17)
    v_lshlrev_b32 v40, 16, v200
    v_and_b32 v41, 0xffff0000, v200
    v_mul_f32 v40, 0x3e0293ee, v40
    v_mul_f32 v41, 0x3e0293ee, v41
    v_cvt_pk_bf16_f32 v200, v40, v41
    v_lshlrev_b32 v40, 16, v201
    v_and_b32 v41, 0xffff0000, v201
    v_mul_f32 v40, 0x3e0293ee, v40
    v_mul_f32 v41, 0x3e0293ee, v41
    v_cvt_pk_bf16_f32 v201, v40, v41
    v_lshlrev_b32 v40, 16, v202
    v_and_b32 v41, 0xffff0000, v202
    v_mul_f32 v40, 0x3e0293ee, v40
    v_mul_f32 v41, 0x3e0293ee, v41
    v_cvt_pk_bf16_f32 v202, v40, v41
    v_lshlrev_b32 v40, 16, v203
    v_and_b32 v41, 0xffff0000, v203
    v_mul_f32 v40, 0x3e0293ee, v40
    v_mul_f32 v41, 0x3e0293ee, v41
    v_cvt_pk_bf16_f32 v203, v40, v41
    ds_write_b128 v101, v[200:203] offset:40960
    s_waitcnt vmcnt(16)
    v_lshlrev_b32 v40, 16, v204
    v_and_b32 v41, 0xffff0000, v204
    v_mul_f32 v40, 0x3e0293ee, v40
    v_mul_f32 v41, 0x3e0293ee, v41
    v_cvt_pk_bf16_f32 v204, v40, v41
    v_lshlrev_b32 v40, 16, v205
    v_and_b32 v41, 0xffff0000, v205
    v_mul_f32 v40, 0x3e0293ee, v40
    v_mul_f32 v41, 0x3e0293ee, v41
    v_cvt_pk_bf16_f32 v205, v40, v41
    v_lshlrev_b32 v40, 16, v206
    v_and_b32 v41, 0xffff0000, v206
    v_mul_f32 v40, 0x3e0293ee, v40
    v_mul_f32 v41, 0x3e0293ee, v41
    v_cvt_pk_bf16_f32 v206, v40, v41
    v_lshlrev_b32 v40, 16, v207
    v_and_b32 v41, 0xffff0000, v207
    v_mul_f32 v40, 0x3e0293ee, v40
    v_mul_f32 v41, 0x3e0293ee, v41
    v_cvt_pk_bf16_f32 v207, v40, v41
    ds_write_b128 v101, v[204:207] offset:45056
    s_waitcnt vmcnt(15)
    v_lshlrev_b32 v40, 16, v208
    v_and_b32 v41, 0xffff0000, v208
    v_mul_f32 v40, 0x3e0293ee, v40
    v_mul_f32 v41, 0x3e0293ee, v41
    v_cvt_pk_bf16_f32 v208, v40, v41
    v_lshlrev_b32 v40, 16, v209
    v_and_b32 v41, 0xffff0000, v209
    v_mul_f32 v40, 0x3e0293ee, v40
    v_mul_f32 v41, 0x3e0293ee, v41
    v_cvt_pk_bf16_f32 v209, v40, v41
    v_lshlrev_b32 v40, 16, v210
    v_and_b32 v41, 0xffff0000, v210
    v_mul_f32 v40, 0x3e0293ee, v40
    v_mul_f32 v41, 0x3e0293ee, v41
    v_cvt_pk_bf16_f32 v210, v40, v41
    v_lshlrev_b32 v40, 16, v211
    v_and_b32 v41, 0xffff0000, v211
    v_mul_f32 v40, 0x3e0293ee, v40
    v_mul_f32 v41, 0x3e0293ee, v41
    v_cvt_pk_bf16_f32 v211, v40, v41
    ds_write_b128 v101, v[208:211] offset:49152
    s_waitcnt vmcnt(14)
    v_lshlrev_b32 v40, 16, v212
    v_and_b32 v41, 0xffff0000, v212
    v_mul_f32 v40, 0x3e0293ee, v40
    v_mul_f32 v41, 0x3e0293ee, v41
    v_cvt_pk_bf16_f32 v212, v40, v41
    v_lshlrev_b32 v40, 16, v213
    v_and_b32 v41, 0xffff0000, v213
    v_mul_f32 v40, 0x3e0293ee, v40
    v_mul_f32 v41, 0x3e0293ee, v41
    v_cvt_pk_bf16_f32 v213, v40, v41
    v_lshlrev_b32 v40, 16, v214
    v_and_b32 v41, 0xffff0000, v214
    v_mul_f32 v40, 0x3e0293ee, v40
    v_mul_f32 v41, 0x3e0293ee, v41
    v_cvt_pk_bf16_f32 v214, v40, v41
    v_lshlrev_b32 v40, 16, v215
    v_and_b32 v41, 0xffff0000, v215
    v_mul_f32 v40, 0x3e0293ee, v40
    v_mul_f32 v41, 0x3e0293ee, v41
    v_cvt_pk_bf16_f32 v215, v40, v41
    ds_write_b128 v101, v[212:215] offset:53248
    s_waitcnt vmcnt(13)
    v_lshlrev_b32 v40, 16, v216
    v_and_b32 v41, 0xffff0000, v216
    v_mul_f32 v40, 0x3e0293ee, v40
    v_mul_f32 v41, 0x3e0293ee, v41
    v_cvt_pk_bf16_f32 v216, v40, v41
    v_lshlrev_b32 v40, 16, v217
    v_and_b32 v41, 0xffff0000, v217
    v_mul_f32 v40, 0x3e0293ee, v40
    v_mul_f32 v41, 0x3e0293ee, v41
    v_cvt_pk_bf16_f32 v217, v40, v41
    v_lshlrev_b32 v40, 16, v218
    v_and_b32 v41, 0xffff0000, v218
    v_mul_f32 v40, 0x3e0293ee, v40
    v_mul_f32 v41, 0x3e0293ee, v41
    v_cvt_pk_bf16_f32 v218, v40, v41
    v_lshlrev_b32 v40, 16, v219
    v_and_b32 v41, 0xffff0000, v219
    v_mul_f32 v40, 0x3e0293ee, v40
    v_mul_f32 v41, 0x3e0293ee, v41
    v_cvt_pk_bf16_f32 v219, v40, v41
    ds_write_b128 v101, v[216:219] offset:57344
    s_waitcnt vmcnt(12)
    v_lshlrev_b32 v40, 16, v220
    v_and_b32 v41, 0xffff0000, v220
    v_mul_f32 v40, 0x3e0293ee, v40
    v_mul_f32 v41, 0x3e0293ee, v41
    v_cvt_pk_bf16_f32 v220, v40, v41
    v_lshlrev_b32 v40, 16, v221
    v_and_b32 v41, 0xffff0000, v221
    v_mul_f32 v40, 0x3e0293ee, v40
    v_mul_f32 v41, 0x3e0293ee, v41
    v_cvt_pk_bf16_f32 v221, v40, v41
    v_lshlrev_b32 v40, 16, v222
    v_and_b32 v41, 0xffff0000, v222
    v_mul_f32 v40, 0x3e0293ee, v40
    v_mul_f32 v41, 0x3e0293ee, v41
    v_cvt_pk_bf16_f32 v222, v40, v41
    v_lshlrev_b32 v40, 16, v223
    v_and_b32 v41, 0xffff0000, v223
    v_mul_f32 v40, 0x3e0293ee, v40
    v_mul_f32 v41, 0x3e0293ee, v41
    v_cvt_pk_bf16_f32 v223, v40, v41
    ds_write_b128 v101, v[220:223] offset:61440
    s_waitcnt lgkmcnt(0)
    s_waitcnt vmcnt(8)
    s_barrier
    s_add_u32 s38, s87, 65536
    buffer_load_dwordx4 v[0:3], v100, s[16:19], s38 offen nt
    s_add_u32 s38, s87, 69632
    buffer_load_dwordx4 v[4:7], v100, s[16:19], s38 offen nt
    s_add_u32 s38, s87, 73728
    buffer_load_dwordx4 v[8:11], v100, s[16:19], s38 offen nt
    s_add_u32 s38, s87, 77824
    buffer_load_dwordx4 v[12:15], v100, s[16:19], s38 offen nt
    s_add_u32 s38, s87, 81920
    buffer_load_dwordx4 v[16:19], v100, s[16:19], s38 offen nt
    s_add_u32 s38, s87, 86016
    buffer_load_dwordx4 v[20:23], v100, s[16:19], s38 offen nt
    s_add_u32 s38, s87, 90112
    buffer_load_dwordx4 v[24:27], v100, s[16:19], s38 offen nt
    s_add_u32 s38, s87, 94208
    buffer_load_dwordx4 v[28:31], v100, s[16:19], s38 offen nt
    s_add_u32 m0, s36, 131072
    s_add_u32 s38, s37, 32768
    buffer_load_dwordx4 v238, s[20:23], s38 offen nt lds
    s_add_u32 m0, s36, 139264
    s_add_u32 s38, s37, 40960
    buffer_load_dwordx4 v238, s[20:23], s38 offen nt lds
    s_add_u32 m0, s36, 147456
    s_add_u32 s38, s37, 49152
    buffer_load_dwordx4 v238, s[20:23], s38 offen nt lds
    s_add_u32 m0, s36, 155648
    s_add_u32 s38, s37, 57344
    buffer_load_dwordx4 v238, s[20:23], s38 offen nt lds
    s_waitcnt vmcnt(11)
    v_lshlrev_b32 v40, 16, v0
    v_and_b32 v41, 0xffff0000, v0
    v_mul_f32 v40, 0x3e0293ee, v40
    v_mul_f32 v41, 0x3e0293ee, v41
    v_cvt_pk_bf16_f32 v0, v40, v41
    v_lshlrev_b32 v40, 16, v1
    v_and_b32 v41, 0xffff0000, v1
    v_mul_f32 v40, 0x3e0293ee, v40
    v_mul_f32 v41, 0x3e0293ee, v41
    v_cvt_pk_bf16_f32 v1, v40, v41
    v_lshlrev_b32 v40, 16, v2
    v_and_b32 v41, 0xffff0000, v2
    v_mul_f32 v40, 0x3e0293ee, v40
    v_mul_f32 v41, 0x3e0293ee, v41
    v_cvt_pk_bf16_f32 v2, v40, v41
    v_lshlrev_b32 v40, 16, v3
    v_and_b32 v41, 0xffff0000, v3
    v_mul_f32 v40, 0x3e0293ee, v40
    v_mul_f32 v41, 0x3e0293ee, v41
    v_cvt_pk_bf16_f32 v3, v40, v41
    v_add_u32 v101, 0x10000, v101
    ds_write_b128 v101, v[0:3] offset:0
    s_waitcnt vmcnt(10)
    v_lshlrev_b32 v40, 16, v4
    v_and_b32 v41, 0xffff0000, v4
    v_mul_f32 v40, 0x3e0293ee, v40
    v_mul_f32 v41, 0x3e0293ee, v41
    v_cvt_pk_bf16_f32 v4, v40, v41
    v_lshlrev_b32 v40, 16, v5
    v_and_b32 v41, 0xffff0000, v5
    v_mul_f32 v40, 0x3e0293ee, v40
    v_mul_f32 v41, 0x3e0293ee, v41
    v_cvt_pk_bf16_f32 v5, v40, v41
    v_lshlrev_b32 v40, 16, v6
    v_and_b32 v41, 0xffff0000, v6
    v_mul_f32 v40, 0x3e0293ee, v40
    v_mul_f32 v41, 0x3e0293ee, v41
    v_cvt_pk_bf16_f32 v6, v40, v41
    v_lshlrev_b32 v40, 16, v7
    v_and_b32 v41, 0xffff0000, v7
    v_mul_f32 v40, 0x3e0293ee, v40
    v_mul_f32 v41, 0x3e0293ee, v41
    v_cvt_pk_bf16_f32 v7, v40, v41
    ds_write_b128 v101, v[4:7] offset:4096
    s_waitcnt vmcnt(9)
    v_lshlrev_b32 v40, 16, v8
    v_and_b32 v41, 0xffff0000, v8
    v_mul_f32 v40, 0x3e0293ee, v40
    v_mul_f32 v41, 0x3e0293ee, v41
    v_cvt_pk_bf16_f32 v8, v40, v41
    v_lshlrev_b32 v40, 16, v9
    v_and_b32 v41, 0xffff0000, v9
    v_mul_f32 v40, 0x3e0293ee, v40
    v_mul_f32 v41, 0x3e0293ee, v41
    v_cvt_pk_bf16_f32 v9, v40, v41
    v_lshlrev_b32 v40, 16, v10
    v_and_b32 v41, 0xffff0000, v10
    v_mul_f32 v40, 0x3e0293ee, v40
    v_mul_f32 v41, 0x3e0293ee, v41
    v_cvt_pk_bf16_f32 v10, v40, v41
    v_lshlrev_b32 v40, 16, v11
    v_and_b32 v41, 0xffff0000, v11
    v_mul_f32 v40, 0x3e0293ee, v40
    v_mul_f32 v41, 0x3e0293ee, v41
    v_cvt_pk_bf16_f32 v11, v40, v41
    ds_write_b128 v101, v[8:11] offset:8192
    s_waitcnt vmcnt(8)
    v_lshlrev_b32 v40, 16, v12
    v_and_b32 v41, 0xffff0000, v12
    v_mul_f32 v40, 0x3e0293ee, v40
    v_mul_f32 v41, 0x3e0293ee, v41
    v_cvt_pk_bf16_f32 v12, v40, v41
    v_lshlrev_b32 v40, 16, v13
    v_and_b32 v41, 0xffff0000, v13
    v_mul_f32 v40, 0x3e0293ee, v40
    v_mul_f32 v41, 0x3e0293ee, v41
    v_cvt_pk_bf16_f32 v13, v40, v41
    v_lshlrev_b32 v40, 16, v14
    v_and_b32 v41, 0xffff0000, v14
    v_mul_f32 v40, 0x3e0293ee, v40
    v_mul_f32 v41, 0x3e0293ee, v41
    v_cvt_pk_bf16_f32 v14, v40, v41
    v_lshlrev_b32 v40, 16, v15
    v_and_b32 v41, 0xffff0000, v15
    v_mul_f32 v40, 0x3e0293ee, v40
    v_mul_f32 v41, 0x3e0293ee, v41
    v_cvt_pk_bf16_f32 v15, v40, v41
    ds_write_b128 v101, v[12:15] offset:12288
    s_waitcnt vmcnt(7)
    v_lshlrev_b32 v40, 16, v16
    v_and_b32 v41, 0xffff0000, v16
    v_mul_f32 v40, 0x3e0293ee, v40
    v_mul_f32 v41, 0x3e0293ee, v41
    v_cvt_pk_bf16_f32 v16, v40, v41
    v_lshlrev_b32 v40, 16, v17
    v_and_b32 v41, 0xffff0000, v17
    v_mul_f32 v40, 0x3e0293ee, v40
    v_mul_f32 v41, 0x3e0293ee, v41
    v_cvt_pk_bf16_f32 v17, v40, v41
    v_lshlrev_b32 v40, 16, v18
    v_and_b32 v41, 0xffff0000, v18
    v_mul_f32 v40, 0x3e0293ee, v40
    v_mul_f32 v41, 0x3e0293ee, v41
    v_cvt_pk_bf16_f32 v18, v40, v41
    v_lshlrev_b32 v40, 16, v19
    v_and_b32 v41, 0xffff0000, v19
    v_mul_f32 v40, 0x3e0293ee, v40
    v_mul_f32 v41, 0x3e0293ee, v41
    v_cvt_pk_bf16_f32 v19, v40, v41
    ds_write_b128 v101, v[16:19] offset:16384
    s_waitcnt vmcnt(6)
    v_lshlrev_b32 v40, 16, v20
    v_and_b32 v41, 0xffff0000, v20
    v_mul_f32 v40, 0x3e0293ee, v40
    v_mul_f32 v41, 0x3e0293ee, v41
    v_cvt_pk_bf16_f32 v20, v40, v41
    v_lshlrev_b32 v40, 16, v21
    v_and_b32 v41, 0xffff0000, v21
    v_mul_f32 v40, 0x3e0293ee, v40
    v_mul_f32 v41, 0x3e0293ee, v41
    v_cvt_pk_bf16_f32 v21, v40, v41
    v_lshlrev_b32 v40, 16, v22
    v_and_b32 v41, 0xffff0000, v22
    v_mul_f32 v40, 0x3e0293ee, v40
    v_mul_f32 v41, 0x3e0293ee, v41
    v_cvt_pk_bf16_f32 v22, v40, v41
    v_lshlrev_b32 v40, 16, v23
    v_and_b32 v41, 0xffff0000, v23
    v_mul_f32 v40, 0x3e0293ee, v40
    v_mul_f32 v41, 0x3e0293ee, v41
    v_cvt_pk_bf16_f32 v23, v40, v41
    ds_write_b128 v101, v[20:23] offset:20480
    s_waitcnt vmcnt(5)
    v_lshlrev_b32 v40, 16, v24
    v_and_b32 v41, 0xffff0000, v24
    v_mul_f32 v40, 0x3e0293ee, v40
    v_mul_f32 v41, 0x3e0293ee, v41
    v_cvt_pk_bf16_f32 v24, v40, v41
    v_lshlrev_b32 v40, 16, v25
    v_and_b32 v41, 0xffff0000, v25
    v_mul_f32 v40, 0x3e0293ee, v40
    v_mul_f32 v41, 0x3e0293ee, v41
    v_cvt_pk_bf16_f32 v25, v40, v41
    v_lshlrev_b32 v40, 16, v26
    v_and_b32 v41, 0xffff0000, v26
    v_mul_f32 v40, 0x3e0293ee, v40
    v_mul_f32 v41, 0x3e0293ee, v41
    v_cvt_pk_bf16_f32 v26, v40, v41
    v_lshlrev_b32 v40, 16, v27
    v_and_b32 v41, 0xffff0000, v27
    v_mul_f32 v40, 0x3e0293ee, v40
    v_mul_f32 v41, 0x3e0293ee, v41
    v_cvt_pk_bf16_f32 v27, v40, v41
    ds_write_b128 v101, v[24:27] offset:24576
    s_waitcnt vmcnt(4)
    v_lshlrev_b32 v40, 16, v28
    v_and_b32 v41, 0xffff0000, v28
    v_mul_f32 v40, 0x3e0293ee, v40
    v_mul_f32 v41, 0x3e0293ee, v41
    v_cvt_pk_bf16_f32 v28, v40, v41
    v_lshlrev_b32 v40, 16, v29
    v_and_b32 v41, 0xffff0000, v29
    v_mul_f32 v40, 0x3e0293ee, v40
    v_mul_f32 v41, 0x3e0293ee, v41
    v_cvt_pk_bf16_f32 v29, v40, v41
    v_lshlrev_b32 v40, 16, v30
    v_and_b32 v41, 0xffff0000, v30
    v_mul_f32 v40, 0x3e0293ee, v40
    v_mul_f32 v41, 0x3e0293ee, v41
    v_cvt_pk_bf16_f32 v30, v40, v41
    v_lshlrev_b32 v40, 16, v31
    v_and_b32 v41, 0xffff0000, v31
    v_mul_f32 v40, 0x3e0293ee, v40
    v_mul_f32 v41, 0x3e0293ee, v41
    v_cvt_pk_bf16_f32 v31, v40, v41
    ds_write_b128 v101, v[28:31] offset:28672
    s_waitcnt lgkmcnt(0)
L_common:
    ds_read_b128 v[192:195], v224 offset:0
    s_waitcnt lgkmcnt(0)
    v_mfma_f32_16x16x32_bf16 v[64:67], v[192:195], v[128:131], 0
    v_mfma_f32_16x16x32_bf16 v[72:75], v[192:195], v[144:147], 0
    ds_read_b128 v[196:199], v225 offset:0
    ds_read_b128 v[200:203], v226 offset:0
    ds_read_b128 v[204:207], v227 offset:0
    ds_read_b128 v[208:211], v224 offset:4096
    s_waitcnt lgkmcnt(3)
    v_mfma_f32_16x16x32_bf16 v[64:67], v[196:199], v[132:135], v[64:67]
    v_mfma_f32_16x16x32_bf16 v[72:75], v[196:199], v[148:151], v[72:75]
    ds_read_b128 v[212:215], v225 offset:4096
    s_waitcnt lgkmcnt(3)
    v_mfma_f32_16x16x32_bf16 v[64:67], v[200:203], v[136:139], v[64:67]
    v_mfma_f32_16x16x32_bf16 v[72:75], v[200:203], v[152:155], v[72:75]
    ds_read_b128 v[216:219], v226 offset:4096
    s_waitcnt lgkmcnt(3)
    v_mfma_f32_16x16x32_bf16 v[64:67], v[204:207], v[140:143], v[64:67]
    v_mfma_f32_16x16x32_bf16 v[72:75], v[204:207], v[156:159], v[72:75]
    ds_read_b128 v[220:223], v227 offset:4096
    s_waitcnt lgkmcnt(3)
    v_mfma_f32_16x16x32_bf16 v[68:71], v[208:211], v[128:131], 0
    v_mfma_f32_16x16x32_bf16 v[76:79], v[208:211], v[144:147], 0
    ds_read_b128 v[192:195], v224 offset:8192
    s_waitcnt lgkmcnt(3)
    v_mfma_f32_16x16x32_bf16 v[68:71], v[212:215], v[132:135], v[68:71]
    v_mfma_f32_16x16x32_bf16 v[76:79], v[212:215], v[148:151], v[76:79]
    ds_read_b128 v[196:199], v225 offset:8192
    s_waitcnt lgkmcnt(3)
    v_mfma_f32_16x16x32_bf16 v[68:71], v[216:219], v[136:139], v[68:71]
    v_mfma_f32_16x16x32_bf16 v[76:79], v[216:219], v[152:155], v[76:79]
    ds_read_b128 v[200:203], v226 offset:8192
    s_waitcnt lgkmcnt(3)
    v_mfma_f32_16x16x32_bf16 v[68:71], v[220:223], v[140:143], v[68:71]
    v_mfma_f32_16x16x32_bf16 v[76:79], v[220:223], v[156:159], v[76:79]
    ds_read_b128 v[204:207], v227 offset:8192
    s_waitcnt lgkmcnt(3)
    v_mfma_f32_16x16x32_bf16 v[80:83], v[192:195], v[128:131], 0
    v_mfma_f32_16x16x32_bf16 v[88:91], v[192:195], v[144:147], 0
    ds_read_b128 v[208:211], v224 offset:12288
    s_waitcnt lgkmcnt(3)
    v_mfma_f32_16x16x32_bf16 v[80:83], v[196:199], v[132:135], v[80:83]
    v_mfma_f32_16x16x32_bf16 v[88:91], v[196:199], v[148:151], v[88:91]
    ds_read_b128 v[212:215], v225 offset:12288
    s_waitcnt lgkmcnt(3)
    v_mfma_f32_16x16x32_bf16 v[80:83], v[200:203], v[136:139], v[80:83]
    v_mfma_f32_16x16x32_bf16 v[88:91], v[200:203], v[152:155], v[88:91]
    ds_read_b128 v[216:219], v226 offset:12288
    s_waitcnt lgkmcnt(3)
    v_mfma_f32_16x16x32_bf16 v[80:83], v[204:207], v[140:143], v[80:83]
    v_mfma_f32_16x16x32_bf16 v[88:91], v[204:207], v[156:159], v[88:91]
    ds_read_b128 v[220:223], v227 offset:12288
    s_waitcnt lgkmcnt(3)
    v_mfma_f32_16x16x32_bf16 v[84:87], v[208:211], v[128:131], 0
    v_mfma_f32_16x16x32_bf16 v[92:95], v[208:211], v[144:147], 0
    ds_read_b128 v[192:195], v224 offset:16384
    s_waitcnt lgkmcnt(3)
    v_mfma_f32_16x16x32_bf16 v[84:87], v[212:215], v[132:135], v[84:87]
    v_mfma_f32_16x16x32_bf16 v[92:95], v[212:215], v[148:151], v[92:95]
    ds_read_b128 v[196:199], v225 offset:16384
    s_waitcnt lgkmcnt(3)
    v_mfma_f32_16x16x32_bf16 v[84:87], v[216:219], v[136:139], v[84:87]
    v_mfma_f32_16x16x32_bf16 v[92:95], v[216:219], v[152:155], v[92:95]
    ds_read_b128 v[200:203], v226 offset:16384
    s_waitcnt lgkmcnt(3)
    v_mfma_f32_16x16x32_bf16 v[84:87], v[220:223], v[140:143], v[84:87]
    v_mfma_f32_16x16x32_bf16 v[92:95], v[220:223], v[156:159], v[92:95]
    ds_read_b128 v[204:207], v227 offset:16384
    v_max3_f32 v252, v64, v65, v66
    v_max3_f32 v254, v72, v73, v74
    v_max3_f32 v252, v252, v67, v68
    v_max3_f32 v254, v254, v75, v76
    v_max3_f32 v252, v252, v69, v70
    v_max3_f32 v254, v254, v77, v78
    v_max3_f32 v252, v252, v71, v80
    v_max3_f32 v254, v254, v79, v88
    v_max3_f32 v252, v252, v81, v82
    v_max3_f32 v254, v254, v89, v90
    v_max3_f32 v252, v252, v83, v84
    v_max3_f32 v254, v254, v91, v92
    v_max3_f32 v252, v252, v85, v86
    v_max3_f32 v254, v254, v93, v94
    v_max_f32 v252, v252, v87
    v_max_f32 v254, v254, v95
    v_mov_b32 v253, v252
    v_mov_b32 v255, v254
    s_nop 0
    v_permlane16_swap_b32 v252, v253
    v_permlane16_swap_b32 v254, v255
    v_max_f32 v252, v252, v253
    v_max_f32 v254, v254, v255
    v_mov_b32 v253, v252
    v_mov_b32 v255, v254
    s_nop 0
    v_permlane32_swap_b32 v252, v253
    v_permlane32_swap_b32 v254, v255
    v_max_f32 v252, v252, v253
    v_max_f32 v254, v254, v255
    v_sub_f32 v240, 0, v252
    v_sub_f32 v241, 0, v252
    v_sub_f32 v242, 0, v252
    v_sub_f32 v243, 0, v252
    v_sub_f32 v244, 0, v254
    v_sub_f32 v245, 0, v254
    v_sub_f32 v246, 0, v254
    v_sub_f32 v247, 0, v254
    s_waitcnt lgkmcnt(3)
    v_mfma_f32_16x16x32_bf16 v[96:99], v[192:195], v[128:131], v[240:243]
    v_add_f32 v64, v64, v241
    v_add_f32 v65, v65, v242
    v_exp_f32 v64, v64
    v_mfma_f32_16x16x32_bf16 v[104:107], v[192:195], v[144:147], v[244:247]
    ds_read_b128 v[208:211], v224 offset:20480
    v_add_f32 v66, v66, v243
    v_exp_f32 v65, v65
    v_add_f32 v67, v67, v240
    s_waitcnt lgkmcnt(3)
    v_mfma_f32_16x16x32_bf16 v[96:99], v[196:199], v[132:135], v[96:99]
    v_exp_f32 v66, v66
    v_add_f32 v68, v68, v241
    v_exp_f32 v67, v67
    v_add_f32 v252, v64, v65
    v_mfma_f32_16x16x32_bf16 v[104:107], v[196:199], v[148:151], v[104:107]
    ds_read_b128 v[212:215], v225 offset:20480
    v_cvt_pk_bf16_f32 v64, v64, v65
    v_add_f32 v69, v69, v242
    v_exp_f32 v68, v68
    s_waitcnt lgkmcnt(3)
    v_mfma_f32_16x16x32_bf16 v[96:99], v[200:203], v[136:139], v[96:99]
    v_add_f32 v70, v70, v243
    v_exp_f32 v69, v69
    v_add_f32 v253, v66, v67
    v_cvt_pk_bf16_f32 v65, v66, v67
    v_mfma_f32_16x16x32_bf16 v[104:107], v[200:203], v[152:155], v[104:107]
    ds_read_b128 v[216:219], v226 offset:20480
    v_add_f32 v71, v71, v240
    v_exp_f32 v70, v70
    v_add_f32 v252, v252, v68
    s_waitcnt lgkmcnt(3)
    v_mfma_f32_16x16x32_bf16 v[96:99], v[204:207], v[140:143], v[96:99]
    v_add_f32 v72, v72, v245
    v_exp_f32 v71, v71
    v_add_f32 v252, v252, v69
    v_cvt_pk_bf16_f32 v66, v68, v69
    v_mfma_f32_16x16x32_bf16 v[104:107], v[204:207], v[156:159], v[104:107]
    ds_read_b128 v[220:223], v227 offset:20480
    v_add_f32 v73, v73, v246
    v_exp_f32 v72, v72
    v_add_f32 v253, v253, v70
    s_waitcnt lgkmcnt(3)
    v_mfma_f32_16x16x32_bf16 v[100:103], v[208:211], v[128:131], v[240:243]
    v_add_f32 v74, v74, v247
    v_exp_f32 v73, v73
    v_add_f32 v253, v253, v71
    v_mfma_f32_16x16x32_bf16 v[108:111], v[208:211], v[144:147], v[244:247]
    ds_read_b128 v[192:195], v224 offset:24576
    v_cvt_pk_bf16_f32 v67, v70, v71
    v_add_f32 v75, v75, v244
    v_exp_f32 v74, v74
    v_add_f32 v76, v76, v245
    s_waitcnt lgkmcnt(3)
    v_mfma_f32_16x16x32_bf16 v[100:103], v[212:215], v[132:135], v[100:103]
    v_exp_f32 v75, v75
    v_add_f32 v254, v72, v73
    v_cvt_pk_bf16_f32 v72, v72, v73
    v_mfma_f32_16x16x32_bf16 v[108:111], v[212:215], v[148:151], v[108:111]
    ds_read_b128 v[196:199], v225 offset:24576
    v_add_f32 v77, v77, v246
    v_exp_f32 v76, v76
    v_add_f32 v78, v78, v247
    v_exp_f32 v77, v77
    s_waitcnt lgkmcnt(3)
    v_mfma_f32_16x16x32_bf16 v[100:103], v[216:219], v[136:139], v[100:103]
    v_add_f32 v255, v74, v75
    v_cvt_pk_bf16_f32 v73, v74, v75
    v_add_f32 v79, v79, v244
    v_mfma_f32_16x16x32_bf16 v[108:111], v[216:219], v[152:155], v[108:111]
    ds_read_b128 v[200:203], v226 offset:24576
    v_exp_f32 v78, v78
    v_add_f32 v254, v254, v76
    v_add_f32 v80, v80, v241
    v_exp_f32 v79, v79
    s_waitcnt lgkmcnt(3)
    v_mfma_f32_16x16x32_bf16 v[100:103], v[220:223], v[140:143], v[100:103]
    v_add_f32 v254, v254, v77
    v_cvt_pk_bf16_f32 v74, v76, v77
    v_add_f32 v81, v81, v242
    v_mfma_f32_16x16x32_bf16 v[108:111], v[220:223], v[156:159], v[108:111]
    ds_read_b128 v[204:207], v227 offset:24576
    v_exp_f32 v80, v80
    v_add_f32 v255, v255, v78
    v_add_f32 v82, v82, v243
    v_exp_f32 v81, v81
    s_waitcnt lgkmcnt(3)
    v_mfma_f32_16x16x32_bf16 v[112:115], v[192:195], v[128:131], v[240:243]
    v_add_f32 v255, v255, v79
    v_cvt_pk_bf16_f32 v75, v78, v79
    v_add_f32 v83, v83, v240
    v_mfma_f32_16x16x32_bf16 v[120:123], v[192:195], v[144:147], v[244:247]
    ds_read_b128 v[208:211], v224 offset:28672
    v_exp_f32 v82, v82
    v_add_f32 v252, v252, v80
    v_add_f32 v84, v84, v241
    s_waitcnt lgkmcnt(3)
    v_mfma_f32_16x16x32_bf16 v[112:115], v[196:199], v[132:135], v[112:115]
    v_exp_f32 v83, v83
    v_add_f32 v252, v252, v81
    v_cvt_pk_bf16_f32 v80, v80, v81
    v_add_f32 v85, v85, v242
    v_mfma_f32_16x16x32_bf16 v[120:123], v[196:199], v[148:151], v[120:123]
    ds_read_b128 v[212:215], v225 offset:28672
    v_exp_f32 v84, v84
    v_add_f32 v253, v253, v82
    v_add_f32 v86, v86, v243
    s_waitcnt lgkmcnt(3)
    v_mfma_f32_16x16x32_bf16 v[112:115], v[200:203], v[136:139], v[112:115]
    v_exp_f32 v85, v85
    v_add_f32 v253, v253, v83
    v_cvt_pk_bf16_f32 v81, v82, v83
    v_add_f32 v87, v87, v240
    v_mfma_f32_16x16x32_bf16 v[120:123], v[200:203], v[152:155], v[120:123]
    ds_read_b128 v[216:219], v226 offset:28672
    v_exp_f32 v86, v86
    v_add_f32 v252, v252, v84
    v_add_f32 v88, v88, v245
    s_waitcnt lgkmcnt(3)
    v_mfma_f32_16x16x32_bf16 v[112:115], v[204:207], v[140:143], v[112:115]
    v_exp_f32 v87, v87
    v_add_f32 v252, v252, v85
    v_cvt_pk_bf16_f32 v82, v84, v85
    v_add_f32 v89, v89, v246
    v_mfma_f32_16x16x32_bf16 v[120:123], v[204:207], v[156:159], v[120:123]
    ds_read_b128 v[220:223], v227 offset:28672
    v_exp_f32 v88, v88
    v_add_f32 v253, v253, v86
    v_add_f32 v90, v90, v247
    s_waitcnt lgkmcnt(3)
    v_mfma_f32_16x16x32_bf16 v[116:119], v[208:211], v[128:131], v[240:243]
    v_exp_f32 v89, v89
    v_add_f32 v253, v253, v87
    v_cvt_pk_bf16_f32 v83, v86, v87
    v_mfma_f32_16x16x32_bf16 v[124:127], v[208:211], v[144:147], v[244:247]
    s_waitcnt vmcnt(0)
    s_barrier
    s_add_u32 m0, s81, 0
    s_add_u32 s38, s83, 0
    buffer_load_dwordx4 v238, s[20:23], s38 offen nt lds
    s_add_u32 m0, s81, 8192
    s_add_u32 s38, s83, 8192
    buffer_load_dwordx4 v238, s[20:23], s38 offen nt lds
    s_add_u32 m0, s81, 16384
    s_add_u32 s38, s83, 16384
    buffer_load_dwordx4 v238, s[20:23], s38 offen nt lds
    s_add_u32 m0, s81, 24576
    s_add_u32 s38, s83, 24576
    buffer_load_dwordx4 v238, s[20:23], s38 offen nt lds
    ds_read_b64_tr_b16 v[192:193], v228 offset:0
    ds_read_b64_tr_b16 v[194:195], v228 offset:4096
    v_add_f32 v91, v91, v244
    v_exp_f32 v90, v90
    v_add_f32 v254, v254, v88
    v_add_f32 v92, v92, v245
    s_waitcnt lgkmcnt(4)
    v_mfma_f32_16x16x32_bf16 v[116:119], v[212:215], v[132:135], v[116:119]
    v_exp_f32 v91, v91
    v_add_f32 v254, v254, v89
    v_cvt_pk_bf16_f32 v88, v88, v89
    v_mfma_f32_16x16x32_bf16 v[124:127], v[212:215], v[148:151], v[124:127]
    ds_read_b64_tr_b16 v[196:197], v229 offset:0
    ds_read_b64_tr_b16 v[198:199], v229 offset:4096
    v_add_f32 v93, v93, v246
    v_exp_f32 v92, v92
    v_add_f32 v255, v255, v90
    v_add_f32 v94, v94, v247
    s_waitcnt lgkmcnt(5)
    v_mfma_f32_16x16x32_bf16 v[116:119], v[216:219], v[136:139], v[116:119]
    v_exp_f32 v93, v93
    v_add_f32 v255, v255, v91
    v_cvt_pk_bf16_f32 v89, v90, v91
    v_mfma_f32_16x16x32_bf16 v[124:127], v[216:219], v[152:155], v[124:127]
    ds_read_b64_tr_b16 v[200:201], v230 offset:0
    ds_read_b64_tr_b16 v[202:203], v230 offset:4096
    v_add_f32 v95, v95, v244
    v_exp_f32 v94, v94
    v_add_f32 v254, v254, v92
    v_exp_f32 v95, v95
    s_waitcnt lgkmcnt(6)
    v_mfma_f32_16x16x32_bf16 v[116:119], v[220:223], v[140:143], v[116:119]
    v_add_f32 v254, v254, v93
    v_cvt_pk_bf16_f32 v90, v92, v93
    v_add_f32 v255, v255, v94
    v_mfma_f32_16x16x32_bf16 v[124:127], v[220:223], v[156:159], v[124:127]
    ds_read_b64_tr_b16 v[204:205], v231 offset:0
    ds_read_b64_tr_b16 v[206:207], v231 offset:4096
    v_add_f32 v255, v255, v95
    v_cvt_pk_bf16_f32 v91, v94, v95
    v_add_f32 v252, v252, v253
    v_add_f32 v254, v254, v255
    v_mov_b32 v248, v252
    v_mov_b32 v249, v254
    s_waitcnt lgkmcnt(6)
    v_mfma_f32_16x16x32_bf16 v[0:3], v[192:195], v[64:67], 0
    v_exp_f32 v96, v96
    v_mfma_f32_16x16x32_bf16 v[8:11], v[192:195], v[72:75], 0
    ds_read_b64_tr_b16 v[208:209], v232 offset:0
    ds_read_b64_tr_b16 v[210:211], v232 offset:4096
    v_exp_f32 v97, v97
    s_waitcnt lgkmcnt(6)
    v_mfma_f32_16x16x32_bf16 v[4:7], v[196:199], v[64:67], 0
    v_exp_f32 v98, v98
    v_mfma_f32_16x16x32_bf16 v[12:15], v[196:199], v[72:75], 0
    ds_read_b64_tr_b16 v[212:213], v233 offset:0
    ds_read_b64_tr_b16 v[214:215], v233 offset:4096
    v_exp_f32 v99, v99
    s_waitcnt lgkmcnt(6)
    v_mfma_f32_16x16x32_bf16 v[16:19], v[200:203], v[64:67], 0
    v_add_f32 v252, v96, v97
    v_cvt_pk_bf16_f32 v96, v96, v97
    v_mfma_f32_16x16x32_bf16 v[24:27], v[200:203], v[72:75], 0
    ds_read_b64_tr_b16 v[216:217], v234 offset:0
    ds_read_b64_tr_b16 v[218:219], v234 offset:4096
    v_exp_f32 v100, v100
    s_waitcnt lgkmcnt(6)
    v_mfma_f32_16x16x32_bf16 v[20:23], v[204:207], v[64:67], 0
    v_exp_f32 v101, v101
    v_mfma_f32_16x16x32_bf16 v[28:31], v[204:207], v[72:75], 0
    ds_read_b64_tr_b16 v[220:221], v235 offset:0
    ds_read_b64_tr_b16 v[222:223], v235 offset:4096
    v_add_f32 v253, v98, v99
    s_waitcnt lgkmcnt(6)
    v_mfma_f32_16x16x32_bf16 v[32:35], v[208:211], v[64:67], 0
    v_cvt_pk_bf16_f32 v97, v98, v99
    v_mfma_f32_16x16x32_bf16 v[40:43], v[208:211], v[72:75], 0
    ds_read_b64_tr_b16 v[192:193], v228 offset:8192
    ds_read_b64_tr_b16 v[194:195], v228 offset:12288
    v_exp_f32 v102, v102
    v_add_f32 v252, v252, v100
    s_waitcnt lgkmcnt(6)
    v_mfma_f32_16x16x32_bf16 v[36:39], v[212:215], v[64:67], 0
    v_exp_f32 v103, v103
    v_mfma_f32_16x16x32_bf16 v[44:47], v[212:215], v[72:75], 0
    ds_read_b64_tr_b16 v[196:197], v229 offset:8192
    ds_read_b64_tr_b16 v[198:199], v229 offset:12288
    v_add_f32 v252, v252, v101
    s_waitcnt lgkmcnt(6)
    v_mfma_f32_16x16x32_bf16 v[48:51], v[216:219], v[64:67], 0
    v_cvt_pk_bf16_f32 v98, v100, v101
    v_mfma_f32_16x16x32_bf16 v[56:59], v[216:219], v[72:75], 0
    ds_read_b64_tr_b16 v[200:201], v230 offset:8192
    ds_read_b64_tr_b16 v[202:203], v230 offset:12288
    v_exp_f32 v104, v104
    v_add_f32 v253, v253, v102
    s_waitcnt lgkmcnt(6)
    v_mfma_f32_16x16x32_bf16 v[52:55], v[220:223], v[64:67], 0
    v_exp_f32 v105, v105
    v_mfma_f32_16x16x32_bf16 v[60:63], v[220:223], v[72:75], 0
    ds_read_b64_tr_b16 v[204:205], v231 offset:8192
    ds_read_b64_tr_b16 v[206:207], v231 offset:12288
    v_add_f32 v253, v253, v103
    s_waitcnt lgkmcnt(6)
    v_mfma_f32_16x16x32_bf16 v[0:3], v[192:195], v[80:83], v[0:3]
    v_cvt_pk_bf16_f32 v99, v102, v103
    v_mfma_f32_16x16x32_bf16 v[8:11], v[192:195], v[88:91], v[8:11]
    ds_read_b64_tr_b16 v[208:209], v232 offset:8192
    ds_read_b64_tr_b16 v[210:211], v232 offset:12288
    v_exp_f32 v106, v106
    s_waitcnt lgkmcnt(6)
    v_mfma_f32_16x16x32_bf16 v[4:7], v[196:199], v[80:83], v[4:7]
    v_exp_f32 v107, v107
    v_add_f32 v254, v104, v105
    v_mfma_f32_16x16x32_bf16 v[12:15], v[196:199], v[88:91], v[12:15]
    ds_read_b64_tr_b16 v[212:213], v233 offset:8192
    ds_read_b64_tr_b16 v[214:215], v233 offset:12288
    v_cvt_pk_bf16_f32 v104, v104, v105
    s_waitcnt lgkmcnt(6)
    v_mfma_f32_16x16x32_bf16 v[16:19], v[200:203], v[80:83], v[16:19]
    v_exp_f32 v108, v108
    v_mfma_f32_16x16x32_bf16 v[24:27], v[200:203], v[88:91], v[24:27]
    ds_read_b64_tr_b16 v[216:217], v234 offset:8192
    ds_read_b64_tr_b16 v[218:219], v234 offset:12288
    v_exp_f32 v109, v109
    s_waitcnt lgkmcnt(6)
    v_mfma_f32_16x16x32_bf16 v[20:23], v[204:207], v[80:83], v[20:23]
    v_add_f32 v255, v106, v107
    v_cvt_pk_bf16_f32 v105, v106, v107
    v_mfma_f32_16x16x32_bf16 v[28:31], v[204:207], v[88:91], v[28:31]
    ds_read_b64_tr_b16 v[220:221], v235 offset:8192
    ds_read_b64_tr_b16 v[222:223], v235 offset:12288
    v_exp_f32 v110, v110
    s_waitcnt lgkmcnt(6)
    v_mfma_f32_16x16x32_bf16 v[32:35], v[208:211], v[80:83], v[32:35]
    v_add_f32 v254, v254, v108
    v_mfma_f32_16x16x32_bf16 v[40:43], v[208:211], v[88:91], v[40:43]
    v_add_u32 v224, s45, v224
    ds_read_b128 v[192:195], v224 offset:0
    v_exp_f32 v111, v111
    s_waitcnt lgkmcnt(5)
    v_mfma_f32_16x16x32_bf16 v[36:39], v[212:215], v[80:83], v[36:39]
    v_add_f32 v254, v254, v109
    v_mfma_f32_16x16x32_bf16 v[44:47], v[212:215], v[88:91], v[44:47]
    v_add_u32 v225, s45, v225
    ds_read_b128 v[196:199], v225 offset:0
    v_cvt_pk_bf16_f32 v106, v108, v109
    v_exp_f32 v112, v112
    s_waitcnt lgkmcnt(4)
    v_mfma_f32_16x16x32_bf16 v[48:51], v[216:219], v[80:83], v[48:51]
    v_add_f32 v255, v255, v110
    v_mfma_f32_16x16x32_bf16 v[56:59], v[216:219], v[88:91], v[56:59]
    v_add_u32 v226, s45, v226
    ds_read_b128 v[200:203], v226 offset:0
    v_exp_f32 v113, v113
    s_waitcnt lgkmcnt(3)
    v_mfma_f32_16x16x32_bf16 v[52:55], v[220:223], v[80:83], v[52:55]
    v_add_f32 v255, v255, v111
    v_mfma_f32_16x16x32_bf16 v[60:63], v[220:223], v[88:91], v[60:63]
    v_add_u32 v227, s45, v227
    ds_read_b128 v[204:207], v227 offset:0
    v_cvt_pk_bf16_f32 v107, v110, v111
    v_exp_f32 v114, v114
    s_waitcnt lgkmcnt(3)
    v_mfma_f32_16x16x32_bf16 v[64:67], v[192:195], v[128:131], v[240:243]
    v_add_f32 v252, v252, v112
    v_mfma_f32_16x16x32_bf16 v[72:75], v[192:195], v[144:147], v[244:247]
    ds_read_b128 v[208:211], v224 offset:4096
    v_exp_f32 v115, v115
    s_waitcnt lgkmcnt(3)
    v_mfma_f32_16x16x32_bf16 v[64:67], v[196:199], v[132:135], v[64:67]
    v_add_f32 v252, v252, v113
    v_mfma_f32_16x16x32_bf16 v[72:75], v[196:199], v[148:151], v[72:75]
    ds_read_b128 v[212:215], v225 offset:4096
    v_cvt_pk_bf16_f32 v112, v112, v113
    s_waitcnt lgkmcnt(3)
    v_mfma_f32_16x16x32_bf16 v[64:67], v[200:203], v[136:139], v[64:67]
    v_exp_f32 v116, v116
    v_add_f32 v253, v253, v114
    v_mfma_f32_16x16x32_bf16 v[72:75], v[200:203], v[152:155], v[72:75]
    ds_read_b128 v[216:219], v226 offset:4096
    v_exp_f32 v117, v117
    s_waitcnt lgkmcnt(3)
    v_mfma_f32_16x16x32_bf16 v[64:67], v[204:207], v[140:143], v[64:67]
    v_add_f32 v253, v253, v115
    v_mfma_f32_16x16x32_bf16 v[72:75], v[204:207], v[156:159], v[72:75]
    ds_read_b128 v[220:223], v227 offset:4096
    v_cvt_pk_bf16_f32 v113, v114, v115
    s_waitcnt lgkmcnt(3)
    v_mfma_f32_16x16x32_bf16 v[68:71], v[208:211], v[128:131], v[240:243]
    v_exp_f32 v118, v118
    v_mfma_f32_16x16x32_bf16 v[76:79], v[208:211], v[144:147], v[244:247]
    ds_read_b128 v[192:195], v224 offset:8192
    v_add_f32 v252, v252, v116
    v_exp_f32 v119, v119
    s_waitcnt lgkmcnt(3)
    v_mfma_f32_16x16x32_bf16 v[68:71], v[212:215], v[132:135], v[68:71]
    v_add_f32 v252, v252, v117
    v_mfma_f32_16x16x32_bf16 v[76:79], v[212:215], v[148:151], v[76:79]
    ds_read_b128 v[196:199], v225 offset:8192
    v_cvt_pk_bf16_f32 v114, v116, v117
    s_waitcnt lgkmcnt(3)
    v_mfma_f32_16x16x32_bf16 v[68:71], v[216:219], v[136:139], v[68:71]
    v_exp_f32 v120, v120
    v_mfma_f32_16x16x32_bf16 v[76:79], v[216:219], v[152:155], v[76:79]
    ds_read_b128 v[200:203], v226 offset:8192
    v_add_f32 v253, v253, v118
    v_exp_f32 v121, v121
    s_waitcnt lgkmcnt(3)
    v_mfma_f32_16x16x32_bf16 v[68:71], v[220:223], v[140:143], v[68:71]
    v_add_f32 v253, v253, v119
    v_mfma_f32_16x16x32_bf16 v[76:79], v[220:223], v[156:159], v[76:79]
    ds_read_b128 v[204:207], v227 offset:8192
    v_cvt_pk_bf16_f32 v115, v118, v119
    s_waitcnt lgkmcnt(3)
    v_mfma_f32_16x16x32_bf16 v[80:83], v[192:195], v[128:131], v[240:243]
    v_exp_f32 v122, v122
    v_mfma_f32_16x16x32_bf16 v[88:91], v[192:195], v[144:147], v[244:247]
    ds_read_b128 v[208:211], v224 offset:12288
    v_add_f32 v254, v254, v120
    s_waitcnt lgkmcnt(3)
    v_mfma_f32_16x16x32_bf16 v[80:83], v[196:199], v[132:135], v[80:83]
    v_exp_f32 v123, v123
    v_add_f32 v254, v254, v121
    v_mfma_f32_16x16x32_bf16 v[88:91], v[196:199], v[148:151], v[88:91]
    ds_read_b128 v[212:215], v225 offset:12288
    v_cvt_pk_bf16_f32 v120, v120, v121
    s_waitcnt lgkmcnt(3)
    v_mfma_f32_16x16x32_bf16 v[80:83], v[200:203], v[136:139], v[80:83]
    v_exp_f32 v124, v124
    v_mfma_f32_16x16x32_bf16 v[88:91], v[200:203], v[152:155], v[88:91]
    ds_read_b128 v[216:219], v226 offset:12288
    v_add_f32 v255, v255, v122
    s_waitcnt lgkmcnt(3)
    v_mfma_f32_16x16x32_bf16 v[80:83], v[204:207], v[140:143], v[80:83]
    v_exp_f32 v125, v125
    v_add_f32 v255, v255, v123
    v_mfma_f32_16x16x32_bf16 v[88:91], v[204:207], v[156:159], v[88:91]
    ds_read_b128 v[220:223], v227 offset:12288
    v_cvt_pk_bf16_f32 v121, v122, v123
    s_waitcnt lgkmcnt(3)
    v_mfma_f32_16x16x32_bf16 v[84:87], v[208:211], v[128:131], v[240:243]
    v_exp_f32 v126, v126
    v_mfma_f32_16x16x32_bf16 v[92:95], v[208:211], v[144:147], v[244:247]
    ds_read_b64_tr_b16 v[192:193], v228 offset:16384
    ds_read_b64_tr_b16 v[194:195], v228 offset:20480
    v_add_f32 v254, v254, v124
    s_waitcnt lgkmcnt(4)
    v_mfma_f32_16x16x32_bf16 v[84:87], v[212:215], v[132:135], v[84:87]
    v_exp_f32 v127, v127
    v_mfma_f32_16x16x32_bf16 v[92:95], v[212:215], v[148:151], v[92:95]
    ds_read_b64_tr_b16 v[196:197], v229 offset:16384
    ds_read_b64_tr_b16 v[198:199], v229 offset:20480
    v_add_f32 v254, v254, v125
    v_cvt_pk_bf16_f32 v122, v124, v125
    s_waitcnt lgkmcnt(5)
    v_mfma_f32_16x16x32_bf16 v[84:87], v[216:219], v[136:139], v[84:87]
    v_add_f32 v255, v255, v126
    v_mfma_f32_16x16x32_bf16 v[92:95], v[216:219], v[152:155], v[92:95]
    ds_read_b64_tr_b16 v[200:201], v230 offset:16384
    ds_read_b64_tr_b16 v[202:203], v230 offset:20480
    v_add_f32 v255, v255, v127
    s_waitcnt lgkmcnt(6)
    v_mfma_f32_16x16x32_bf16 v[84:87], v[220:223], v[140:143], v[84:87]
    v_cvt_pk_bf16_f32 v123, v126, v127
    v_mfma_f32_16x16x32_bf16 v[92:95], v[220:223], v[156:159], v[92:95]
    ds_read_b64_tr_b16 v[204:205], v231 offset:16384
    ds_read_b64_tr_b16 v[206:207], v231 offset:20480
    v_add_f32 v252, v252, v253
    v_add_f32 v254, v254, v255
    v_max_f32 v239, v252, v254
    v_cmp_lt_f32 vcc, 0x46800000, v239
    s_cbranch_vccnz L_slow_0_1
L_back_0_1:
    v_add_f32 v248, v248, v252
    v_add_f32 v249, v249, v254
    buffer_load_dwordx4 v[160:163], v236, s[12:15], s34 offen offset:0 nt
    buffer_load_dwordx4 v[164:167], v236, s[12:15], s34 offen offset:64 nt
    buffer_load_dwordx4 v[168:171], v236, s[12:15], s34 offen offset:128 nt
    buffer_load_dwordx4 v[172:175], v236, s[12:15], s34 offen offset:192 nt
    s_waitcnt lgkmcnt(6)
    v_mfma_f32_16x16x32_bf16 v[0:3], v[192:195], v[96:99], v[0:3]
    v_exp_f32 v64, v64
    v_mfma_f32_16x16x32_bf16 v[8:11], v[192:195], v[104:107], v[8:11]
    ds_read_b64_tr_b16 v[208:209], v232 offset:16384
    ds_read_b64_tr_b16 v[210:211], v232 offset:20480
    v_exp_f32 v65, v65
    s_waitcnt lgkmcnt(6)
    v_mfma_f32_16x16x32_bf16 v[4:7], v[196:199], v[96:99], v[4:7]
    v_exp_f32 v66, v66
    v_mfma_f32_16x16x32_bf16 v[12:15], v[196:199], v[104:107], v[12:15]
    ds_read_b64_tr_b16 v[212:213], v233 offset:16384
    ds_read_b64_tr_b16 v[214:215], v233 offset:20480
    v_exp_f32 v67, v67
    s_waitcnt lgkmcnt(6)
    v_mfma_f32_16x16x32_bf16 v[16:19], v[200:203], v[96:99], v[16:19]
    v_add_f32 v252, v64, v65
    v_cvt_pk_bf16_f32 v64, v64, v65
    v_mfma_f32_16x16x32_bf16 v[24:27], v[200:203], v[104:107], v[24:27]
    ds_read_b64_tr_b16 v[216:217], v234 offset:16384
    ds_read_b64_tr_b16 v[218:219], v234 offset:20480
    v_exp_f32 v68, v68
    s_waitcnt lgkmcnt(6)
    v_mfma_f32_16x16x32_bf16 v[20:23], v[204:207], v[96:99], v[20:23]
    v_exp_f32 v69, v69
    v_mfma_f32_16x16x32_bf16 v[28:31], v[204:207], v[104:107], v[28:31]
    ds_read_b64_tr_b16 v[220:221], v235 offset:16384
    ds_read_b64_tr_b16 v[222:223], v235 offset:20480
    v_add_f32 v253, v66, v67
    s_waitcnt lgkmcnt(6)
    v_mfma_f32_16x16x32_bf16 v[32:35], v[208:211], v[96:99], v[32:35]
    v_cvt_pk_bf16_f32 v65, v66, v67
    v_mfma_f32_16x16x32_bf16 v[40:43], v[208:211], v[104:107], v[40:43]
    ds_read_b64_tr_b16 v[192:193], v228 offset:24576
    ds_read_b64_tr_b16 v[194:195], v228 offset:28672
    v_exp_f32 v70, v70
    v_add_f32 v252, v252, v68
    s_waitcnt lgkmcnt(6)
    v_mfma_f32_16x16x32_bf16 v[36:39], v[212:215], v[96:99], v[36:39]
    v_exp_f32 v71, v71
    v_mfma_f32_16x16x32_bf16 v[44:47], v[212:215], v[104:107], v[44:47]
    ds_read_b64_tr_b16 v[196:197], v229 offset:24576
    ds_read_b64_tr_b16 v[198:199], v229 offset:28672
    v_add_f32 v252, v252, v69
    s_waitcnt lgkmcnt(6)
    v_mfma_f32_16x16x32_bf16 v[48:51], v[216:219], v[96:99], v[48:51]
    v_cvt_pk_bf16_f32 v66, v68, v69
    v_mfma_f32_16x16x32_bf16 v[56:59], v[216:219], v[104:107], v[56:59]
    ds_read_b64_tr_b16 v[200:201], v230 offset:24576
    ds_read_b64_tr_b16 v[202:203], v230 offset:28672
    v_exp_f32 v72, v72
    v_add_f32 v253, v253, v70
    s_waitcnt lgkmcnt(6)
    v_mfma_f32_16x16x32_bf16 v[52:55], v[220:223], v[96:99], v[52:55]
    v_exp_f32 v73, v73
    v_mfma_f32_16x16x32_bf16 v[60:63], v[220:223], v[104:107], v[60:63]
    ds_read_b64_tr_b16 v[204:205], v231 offset:24576
    ds_read_b64_tr_b16 v[206:207], v231 offset:28672
    v_add_f32 v253, v253, v71
    s_waitcnt lgkmcnt(6)
    v_mfma_f32_16x16x32_bf16 v[0:3], v[192:195], v[112:115], v[0:3]
    v_cvt_pk_bf16_f32 v67, v70, v71
    v_mfma_f32_16x16x32_bf16 v[8:11], v[192:195], v[120:123], v[8:11]
    ds_read_b64_tr_b16 v[208:209], v232 offset:24576
    ds_read_b64_tr_b16 v[210:211], v232 offset:28672
    v_exp_f32 v74, v74
    s_waitcnt lgkmcnt(6)
    v_mfma_f32_16x16x32_bf16 v[4:7], v[196:199], v[112:115], v[4:7]
    v_exp_f32 v75, v75
    v_add_f32 v254, v72, v73
    v_mfma_f32_16x16x32_bf16 v[12:15], v[196:199], v[120:123], v[12:15]
    ds_read_b64_tr_b16 v[212:213], v233 offset:24576
    ds_read_b64_tr_b16 v[214:215], v233 offset:28672
    v_cvt_pk_bf16_f32 v72, v72, v73
    s_waitcnt lgkmcnt(6)
    v_mfma_f32_16x16x32_bf16 v[16:19], v[200:203], v[112:115], v[16:19]
    v_exp_f32 v76, v76
    v_mfma_f32_16x16x32_bf16 v[24:27], v[200:203], v[120:123], v[24:27]
    ds_read_b64_tr_b16 v[216:217], v234 offset:24576
    ds_read_b64_tr_b16 v[218:219], v234 offset:28672
    v_exp_f32 v77, v77
    s_waitcnt lgkmcnt(6)
    v_mfma_f32_16x16x32_bf16 v[20:23], v[204:207], v[112:115], v[20:23]
    v_add_f32 v255, v74, v75
    v_cvt_pk_bf16_f32 v73, v74, v75
    v_mfma_f32_16x16x32_bf16 v[28:31], v[204:207], v[120:123], v[28:31]
    ds_read_b64_tr_b16 v[220:221], v235 offset:24576
    ds_read_b64_tr_b16 v[222:223], v235 offset:28672
    v_exp_f32 v78, v78
    s_waitcnt lgkmcnt(6)
    v_mfma_f32_16x16x32_bf16 v[32:35], v[208:211], v[112:115], v[32:35]
    v_add_f32 v254, v254, v76
    v_mfma_f32_16x16x32_bf16 v[40:43], v[208:211], v[120:123], v[40:43]
    ds_read_b128 v[192:195], v224 offset:16384
    v_exp_f32 v79, v79
    s_waitcnt lgkmcnt(5)
    v_mfma_f32_16x16x32_bf16 v[36:39], v[212:215], v[112:115], v[36:39]
    v_add_f32 v254, v254, v77
    v_mfma_f32_16x16x32_bf16 v[44:47], v[212:215], v[120:123], v[44:47]
    ds_read_b128 v[196:199], v225 offset:16384
    v_cvt_pk_bf16_f32 v74, v76, v77
    v_exp_f32 v80, v80
    s_waitcnt lgkmcnt(4)
    v_mfma_f32_16x16x32_bf16 v[48:51], v[216:219], v[112:115], v[48:51]
    v_add_f32 v255, v255, v78
    v_mfma_f32_16x16x32_bf16 v[56:59], v[216:219], v[120:123], v[56:59]
    ds_read_b128 v[200:203], v226 offset:16384
    v_exp_f32 v81, v81
    s_waitcnt lgkmcnt(3)
    v_mfma_f32_16x16x32_bf16 v[52:55], v[220:223], v[112:115], v[52:55]
    v_add_f32 v255, v255, v79
    v_mfma_f32_16x16x32_bf16 v[60:63], v[220:223], v[120:123], v[60:63]
    ds_read_b128 v[204:207], v227 offset:16384
    v_cvt_pk_bf16_f32 v75, v78, v79
    v_exp_f32 v82, v82
    s_waitcnt lgkmcnt(3)
    v_mfma_f32_16x16x32_bf16 v[96:99], v[192:195], v[128:131], v[240:243]
    v_add_f32 v252, v252, v80
    v_mfma_f32_16x16x32_bf16 v[104:107], v[192:195], v[144:147], v[244:247]
    ds_read_b128 v[208:211], v224 offset:20480
    v_exp_f32 v83, v83
    s_waitcnt lgkmcnt(3)
    v_mfma_f32_16x16x32_bf16 v[96:99], v[196:199], v[132:135], v[96:99]
    v_add_f32 v252, v252, v81
    v_mfma_f32_16x16x32_bf16 v[104:107], v[196:199], v[148:151], v[104:107]
    ds_read_b128 v[212:215], v225 offset:20480
    v_cvt_pk_bf16_f32 v80, v80, v81
    s_waitcnt lgkmcnt(3)
    v_mfma_f32_16x16x32_bf16 v[96:99], v[200:203], v[136:139], v[96:99]
    v_exp_f32 v84, v84
    v_add_f32 v253, v253, v82
    v_mfma_f32_16x16x32_bf16 v[104:107], v[200:203], v[152:155], v[104:107]
    ds_read_b128 v[216:219], v226 offset:20480
    v_exp_f32 v85, v85
    s_waitcnt lgkmcnt(3)
    v_mfma_f32_16x16x32_bf16 v[96:99], v[204:207], v[140:143], v[96:99]
    v_add_f32 v253, v253, v83
    v_mfma_f32_16x16x32_bf16 v[104:107], v[204:207], v[156:159], v[104:107]
    ds_read_b128 v[220:223], v227 offset:20480
    v_cvt_pk_bf16_f32 v81, v82, v83
    s_waitcnt lgkmcnt(3)
    v_mfma_f32_16x16x32_bf16 v[100:103], v[208:211], v[128:131], v[240:243]
    v_exp_f32 v86, v86
    v_mfma_f32_16x16x32_bf16 v[108:111], v[208:211], v[144:147], v[244:247]
    ds_read_b128 v[192:195], v224 offset:24576
    v_add_f32 v252, v252, v84
    v_exp_f32 v87, v87
    s_waitcnt lgkmcnt(3)
    v_mfma_f32_16x16x32_bf16 v[100:103], v[212:215], v[132:135], v[100:103]
    v_add_f32 v252, v252, v85
    v_mfma_f32_16x16x32_bf16 v[108:111], v[212:215], v[148:151], v[108:111]
    ds_read_b128 v[196:199], v225 offset:24576
    v_cvt_pk_bf16_f32 v82, v84, v85
    s_waitcnt lgkmcnt(3)
    v_mfma_f32_16x16x32_bf16 v[100:103], v[216:219], v[136:139], v[100:103]
    v_exp_f32 v88, v88
    v_mfma_f32_16x16x32_bf16 v[108:111], v[216:219], v[152:155], v[108:111]
    ds_read_b128 v[200:203], v226 offset:24576
    v_add_f32 v253, v253, v86
    v_exp_f32 v89, v89
    s_waitcnt lgkmcnt(3)
    v_mfma_f32_16x16x32_bf16 v[100:103], v[220:223], v[140:143], v[100:103]
    v_add_f32 v253, v253, v87
    v_mfma_f32_16x16x32_bf16 v[108:111], v[220:223], v[156:159], v[108:111]
    ds_read_b128 v[204:207], v227 offset:24576
    v_cvt_pk_bf16_f32 v83, v86, v87
    s_waitcnt lgkmcnt(3)
    v_mfma_f32_16x16x32_bf16 v[112:115], v[192:195], v[128:131], v[240:243]
    v_exp_f32 v90, v90
    v_mfma_f32_16x16x32_bf16 v[120:123], v[192:195], v[144:147], v[244:247]
    ds_read_b128 v[208:211], v224 offset:28672
    v_add_f32 v254, v254, v88
    s_waitcnt lgkmcnt(3)
    v_mfma_f32_16x16x32_bf16 v[112:115], v[196:199], v[132:135], v[112:115]
    v_exp_f32 v91, v91
    v_add_f32 v254, v254, v89
    v_mfma_f32_16x16x32_bf16 v[120:123], v[196:199], v[148:151], v[120:123]
    ds_read_b128 v[212:215], v225 offset:28672
    v_cvt_pk_bf16_f32 v88, v88, v89
    s_waitcnt lgkmcnt(3)
    v_mfma_f32_16x16x32_bf16 v[112:115], v[200:203], v[136:139], v[112:115]
    v_exp_f32 v92, v92
    v_mfma_f32_16x16x32_bf16 v[120:123], v[200:203], v[152:155], v[120:123]
    ds_read_b128 v[216:219], v226 offset:28672
    v_add_f32 v255, v255, v90
    s_waitcnt lgkmcnt(3)
    v_mfma_f32_16x16x32_bf16 v[112:115], v[204:207], v[140:143], v[112:115]
    v_exp_f32 v93, v93
    v_add_f32 v255, v255, v91
    v_mfma_f32_16x16x32_bf16 v[120:123], v[204:207], v[156:159], v[120:123]
    ds_read_b128 v[220:223], v227 offset:28672
    v_cvt_pk_bf16_f32 v89, v90, v91
    s_waitcnt lgkmcnt(3)
    v_mfma_f32_16x16x32_bf16 v[116:119], v[208:211], v[128:131], v[240:243]
    v_exp_f32 v94, v94
    v_mfma_f32_16x16x32_bf16 v[124:127], v[208:211], v[144:147], v[244:247]
    s_waitcnt vmcnt(4)
    s_barrier
    s_add_u32 m0, s80, 0
    s_add_u32 s38, s84, 0
    buffer_load_dwordx4 v238, s[20:23], s38 offen nt lds
    s_add_u32 m0, s80, 8192
    s_add_u32 s38, s84, 8192
    buffer_load_dwordx4 v238, s[20:23], s38 offen nt lds
    s_add_u32 m0, s80, 16384
    s_add_u32 s38, s84, 16384
    buffer_load_dwordx4 v238, s[20:23], s38 offen nt lds
    s_add_u32 m0, s80, 24576
    s_add_u32 s38, s84, 24576
    buffer_load_dwordx4 v238, s[20:23], s38 offen nt lds
    v_add_u32 v228, s85, v228
    ds_read_b64_tr_b16 v[192:193], v228 offset:0
    ds_read_b64_tr_b16 v[194:195], v228 offset:4096
    v_add_f32 v254, v254, v92
    s_waitcnt lgkmcnt(4)
    v_mfma_f32_16x16x32_bf16 v[116:119], v[212:215], v[132:135], v[116:119]
    v_exp_f32 v95, v95
    v_mfma_f32_16x16x32_bf16 v[124:127], v[212:215], v[148:151], v[124:127]
    v_add_u32 v229, s85, v229
    ds_read_b64_tr_b16 v[196:197], v229 offset:0
    ds_read_b64_tr_b16 v[198:199], v229 offset:4096
    v_add_f32 v254, v254, v93
    v_cvt_pk_bf16_f32 v90, v92, v93
    s_waitcnt lgkmcnt(5)
    v_mfma_f32_16x16x32_bf16 v[116:119], v[216:219], v[136:139], v[116:119]
    v_add_f32 v255, v255, v94
    v_mfma_f32_16x16x32_bf16 v[124:127], v[216:219], v[152:155], v[124:127]
    v_add_u32 v230, s85, v230
    ds_read_b64_tr_b16 v[200:201], v230 offset:0
    ds_read_b64_tr_b16 v[202:203], v230 offset:4096
    v_add_f32 v255, v255, v95
    s_waitcnt lgkmcnt(6)
    v_mfma_f32_16x16x32_bf16 v[116:119], v[220:223], v[140:143], v[116:119]
    v_cvt_pk_bf16_f32 v91, v94, v95
    v_mfma_f32_16x16x32_bf16 v[124:127], v[220:223], v[156:159], v[124:127]
    v_add_u32 v231, s85, v231
    ds_read_b64_tr_b16 v[204:205], v231 offset:0
    ds_read_b64_tr_b16 v[206:207], v231 offset:4096
    v_add_f32 v252, v252, v253
    v_add_f32 v254, v254, v255
    v_max_f32 v239, v252, v254
    v_cmp_lt_f32 vcc, 0x46800000, v239
    s_cbranch_vccnz L_slow_0_2
L_back_0_2:
    v_add_f32 v248, v248, v252
    v_add_f32 v249, v249, v254
    buffer_load_dwordx4 v[176:179], v236, s[12:15], s94 offen offset:0 nt
    buffer_load_dwordx4 v[180:183], v236, s[12:15], s94 offen offset:64 nt
    buffer_load_dwordx4 v[184:187], v236, s[12:15], s94 offen offset:128 nt
    buffer_load_dwordx4 v[188:191], v236, s[12:15], s94 offen offset:192 nt
    s_waitcnt lgkmcnt(6)
    v_mfma_f32_16x16x32_bf16 v[0:3], v[192:195], v[64:67], v[0:3]
    v_exp_f32 v96, v96
    v_mfma_f32_16x16x32_bf16 v[8:11], v[192:195], v[72:75], v[8:11]
    v_add_u32 v232, s85, v232
    ds_read_b64_tr_b16 v[208:209], v232 offset:0
    ds_read_b64_tr_b16 v[210:211], v232 offset:4096
    v_exp_f32 v97, v97
    s_waitcnt lgkmcnt(6)
    v_mfma_f32_16x16x32_bf16 v[4:7], v[196:199], v[64:67], v[4:7]
    v_exp_f32 v98, v98
    v_mfma_f32_16x16x32_bf16 v[12:15], v[196:199], v[72:75], v[12:15]
    v_add_u32 v233, s85, v233
    ds_read_b64_tr_b16 v[212:213], v233 offset:0
    ds_read_b64_tr_b16 v[214:215], v233 offset:4096
    v_exp_f32 v99, v99
    s_waitcnt lgkmcnt(6)
    v_mfma_f32_16x16x32_bf16 v[16:19], v[200:203], v[64:67], v[16:19]
    v_add_f32 v252, v96, v97
    v_cvt_pk_bf16_f32 v96, v96, v97
    v_mfma_f32_16x16x32_bf16 v[24:27], v[200:203], v[72:75], v[24:27]
    v_add_u32 v234, s85, v234
    ds_read_b64_tr_b16 v[216:217], v234 offset:0
    ds_read_b64_tr_b16 v[218:219], v234 offset:4096
    v_exp_f32 v100, v100
    s_waitcnt lgkmcnt(6)
    v_mfma_f32_16x16x32_bf16 v[20:23], v[204:207], v[64:67], v[20:23]
    v_exp_f32 v101, v101
    v_mfma_f32_16x16x32_bf16 v[28:31], v[204:207], v[72:75], v[28:31]
    v_add_u32 v235, s85, v235
    ds_read_b64_tr_b16 v[220:221], v235 offset:0
    ds_read_b64_tr_b16 v[222:223], v235 offset:4096
    v_add_f32 v253, v98, v99
    s_waitcnt lgkmcnt(6)
    v_mfma_f32_16x16x32_bf16 v[32:35], v[208:211], v[64:67], v[32:35]
    v_cvt_pk_bf16_f32 v97, v98, v99
    v_mfma_f32_16x16x32_bf16 v[40:43], v[208:211], v[72:75], v[40:43]
    ds_read_b64_tr_b16 v[192:193], v228 offset:8192
    ds_read_b64_tr_b16 v[194:195], v228 offset:12288
    v_exp_f32 v102, v102
    v_add_f32 v252, v252, v100
    s_waitcnt lgkmcnt(6)
    v_mfma_f32_16x16x32_bf16 v[36:39], v[212:215], v[64:67], v[36:39]
    v_exp_f32 v103, v103
    v_mfma_f32_16x16x32_bf16 v[44:47], v[212:215], v[72:75], v[44:47]
    ds_read_b64_tr_b16 v[196:197], v229 offset:8192
    ds_read_b64_tr_b16 v[198:199], v229 offset:12288
    v_add_f32 v252, v252, v101
    s_waitcnt lgkmcnt(6)
    v_mfma_f32_16x16x32_bf16 v[48:51], v[216:219], v[64:67], v[48:51]
    v_cvt_pk_bf16_f32 v98, v100, v101
    v_mfma_f32_16x16x32_bf16 v[56:59], v[216:219], v[72:75], v[56:59]
    ds_read_b64_tr_b16 v[200:201], v230 offset:8192
    ds_read_b64_tr_b16 v[202:203], v230 offset:12288
    v_exp_f32 v104, v104
    v_add_f32 v253, v253, v102
    s_waitcnt lgkmcnt(6)
    v_mfma_f32_16x16x32_bf16 v[52:55], v[220:223], v[64:67], v[52:55]
    v_exp_f32 v105, v105
    v_mfma_f32_16x16x32_bf16 v[60:63], v[220:223], v[72:75], v[60:63]
    ds_read_b64_tr_b16 v[204:205], v231 offset:8192
    ds_read_b64_tr_b16 v[206:207], v231 offset:12288
    v_add_f32 v253, v253, v103
    s_waitcnt lgkmcnt(6)
    v_mfma_f32_16x16x32_bf16 v[0:3], v[192:195], v[80:83], v[0:3]
    v_cvt_pk_bf16_f32 v99, v102, v103
    v_mfma_f32_16x16x32_bf16 v[8:11], v[192:195], v[88:91], v[8:11]
    ds_read_b64_tr_b16 v[208:209], v232 offset:8192
    ds_read_b64_tr_b16 v[210:211], v232 offset:12288
    v_exp_f32 v106, v106
    s_waitcnt lgkmcnt(6)
    v_mfma_f32_16x16x32_bf16 v[4:7], v[196:199], v[80:83], v[4:7]
    v_exp_f32 v107, v107
    v_add_f32 v254, v104, v105
    v_mfma_f32_16x16x32_bf16 v[12:15], v[196:199], v[88:91], v[12:15]
    ds_read_b64_tr_b16 v[212:213], v233 offset:8192
    ds_read_b64_tr_b16 v[214:215], v233 offset:12288
    v_cvt_pk_bf16_f32 v104, v104, v105
    s_waitcnt lgkmcnt(6)
    v_mfma_f32_16x16x32_bf16 v[16:19], v[200:203], v[80:83], v[16:19]
    v_exp_f32 v108, v108
    v_mfma_f32_16x16x32_bf16 v[24:27], v[200:203], v[88:91], v[24:27]
    ds_read_b64_tr_b16 v[216:217], v234 offset:8192
    ds_read_b64_tr_b16 v[218:219], v234 offset:12288
    v_exp_f32 v109, v109
    s_waitcnt lgkmcnt(6)
    v_mfma_f32_16x16x32_bf16 v[20:23], v[204:207], v[80:83], v[20:23]
    v_add_f32 v255, v106, v107
    v_cvt_pk_bf16_f32 v105, v106, v107
    v_mfma_f32_16x16x32_bf16 v[28:31], v[204:207], v[88:91], v[28:31]
    ds_read_b64_tr_b16 v[220:221], v235 offset:8192
    ds_read_b64_tr_b16 v[222:223], v235 offset:12288
    v_exp_f32 v110, v110
    s_waitcnt lgkmcnt(6)
    v_mfma_f32_16x16x32_bf16 v[32:35], v[208:211], v[80:83], v[32:35]
    v_add_f32 v254, v254, v108
    v_mfma_f32_16x16x32_bf16 v[40:43], v[208:211], v[88:91], v[40:43]
    v_add_u32 v224, s46, v224
    ds_read_b128 v[192:195], v224 offset:0
    v_exp_f32 v111, v111
    s_waitcnt lgkmcnt(5)
    v_mfma_f32_16x16x32_bf16 v[36:39], v[212:215], v[80:83], v[36:39]
    v_add_f32 v254, v254, v109
    v_mfma_f32_16x16x32_bf16 v[44:47], v[212:215], v[88:91], v[44:47]
    v_add_u32 v225, s46, v225
    ds_read_b128 v[196:199], v225 offset:0
    v_cvt_pk_bf16_f32 v106, v108, v109
    v_exp_f32 v112, v112
    s_waitcnt lgkmcnt(4)
    v_mfma_f32_16x16x32_bf16 v[48:51], v[216:219], v[80:83], v[48:51]
    v_add_f32 v255, v255, v110
    v_mfma_f32_16x16x32_bf16 v[56:59], v[216:219], v[88:91], v[56:59]
    v_add_u32 v226, s46, v226
    ds_read_b128 v[200:203], v226 offset:0
    v_exp_f32 v113, v113
    s_waitcnt lgkmcnt(3)
    v_mfma_f32_16x16x32_bf16 v[52:55], v[220:223], v[80:83], v[52:55]
    v_add_f32 v255, v255, v111
    v_mfma_f32_16x16x32_bf16 v[60:63], v[220:223], v[88:91], v[60:63]
    v_add_u32 v227, s46, v227
    ds_read_b128 v[204:207], v227 offset:0
    v_cvt_pk_bf16_f32 v107, v110, v111
    v_exp_f32 v114, v114
    s_waitcnt lgkmcnt(3)
    v_mfma_f32_16x16x32_bf16 v[64:67], v[192:195], v[128:131], v[240:243]
    v_add_f32 v252, v252, v112
    v_mfma_f32_16x16x32_bf16 v[72:75], v[192:195], v[144:147], v[244:247]
    ds_read_b128 v[208:211], v224 offset:4096
    v_exp_f32 v115, v115
    s_waitcnt lgkmcnt(3)
    v_mfma_f32_16x16x32_bf16 v[64:67], v[196:199], v[132:135], v[64:67]
    v_add_f32 v252, v252, v113
    v_mfma_f32_16x16x32_bf16 v[72:75], v[196:199], v[148:151], v[72:75]
    ds_read_b128 v[212:215], v225 offset:4096
    v_cvt_pk_bf16_f32 v112, v112, v113
    s_waitcnt lgkmcnt(3)
    v_mfma_f32_16x16x32_bf16 v[64:67], v[200:203], v[136:139], v[64:67]
    v_exp_f32 v116, v116
    v_add_f32 v253, v253, v114
    v_mfma_f32_16x16x32_bf16 v[72:75], v[200:203], v[152:155], v[72:75]
    ds_read_b128 v[216:219], v226 offset:4096
    v_exp_f32 v117, v117
    s_waitcnt lgkmcnt(3)
    v_mfma_f32_16x16x32_bf16 v[64:67], v[204:207], v[140:143], v[64:67]
    v_add_f32 v253, v253, v115
    v_mfma_f32_16x16x32_bf16 v[72:75], v[204:207], v[156:159], v[72:75]
    ds_read_b128 v[220:223], v227 offset:4096
    v_cvt_pk_bf16_f32 v113, v114, v115
    s_waitcnt lgkmcnt(3)
    v_mfma_f32_16x16x32_bf16 v[68:71], v[208:211], v[128:131], v[240:243]
    v_exp_f32 v118, v118
    v_mfma_f32_16x16x32_bf16 v[76:79], v[208:211], v[144:147], v[244:247]
    ds_read_b128 v[192:195], v224 offset:8192
    v_add_f32 v252, v252, v116
    v_exp_f32 v119, v119
    s_waitcnt lgkmcnt(3)
    v_mfma_f32_16x16x32_bf16 v[68:71], v[212:215], v[132:135], v[68:71]
    v_add_f32 v252, v252, v117
    v_mfma_f32_16x16x32_bf16 v[76:79], v[212:215], v[148:151], v[76:79]
    ds_read_b128 v[196:199], v225 offset:8192
    v_cvt_pk_bf16_f32 v114, v116, v117
    s_waitcnt lgkmcnt(3)
    v_mfma_f32_16x16x32_bf16 v[68:71], v[216:219], v[136:139], v[68:71]
    v_exp_f32 v120, v120
    v_mfma_f32_16x16x32_bf16 v[76:79], v[216:219], v[152:155], v[76:79]
    ds_read_b128 v[200:203], v226 offset:8192
    v_add_f32 v253, v253, v118
    v_exp_f32 v121, v121
    s_waitcnt lgkmcnt(3)
    v_mfma_f32_16x16x32_bf16 v[68:71], v[220:223], v[140:143], v[68:71]
    v_add_f32 v253, v253, v119
    v_mfma_f32_16x16x32_bf16 v[76:79], v[220:223], v[156:159], v[76:79]
    ds_read_b128 v[204:207], v227 offset:8192
    v_cvt_pk_bf16_f32 v115, v118, v119
    s_waitcnt lgkmcnt(3)
    v_mfma_f32_16x16x32_bf16 v[80:83], v[192:195], v[128:131], v[240:243]
    v_exp_f32 v122, v122
    v_mfma_f32_16x16x32_bf16 v[88:91], v[192:195], v[144:147], v[244:247]
    ds_read_b128 v[208:211], v224 offset:12288
    v_add_f32 v254, v254, v120
    s_waitcnt lgkmcnt(3)
    v_mfma_f32_16x16x32_bf16 v[80:83], v[196:199], v[132:135], v[80:83]
    v_exp_f32 v123, v123
    v_add_f32 v254, v254, v121
    v_mfma_f32_16x16x32_bf16 v[88:91], v[196:199], v[148:151], v[88:91]
    ds_read_b128 v[212:215], v225 offset:12288
    v_cvt_pk_bf16_f32 v120, v120, v121
    s_waitcnt lgkmcnt(3)
    v_mfma_f32_16x16x32_bf16 v[80:83], v[200:203], v[136:139], v[80:83]
    v_exp_f32 v124, v124
    v_mfma_f32_16x16x32_bf16 v[88:91], v[200:203], v[152:155], v[88:91]
    ds_read_b128 v[216:219], v226 offset:12288
    v_add_f32 v255, v255, v122
    s_waitcnt lgkmcnt(3)
    v_mfma_f32_16x16x32_bf16 v[80:83], v[204:207], v[140:143], v[80:83]
    v_exp_f32 v125, v125
    v_add_f32 v255, v255, v123
    v_mfma_f32_16x16x32_bf16 v[88:91], v[204:207], v[156:159], v[88:91]
    ds_read_b128 v[220:223], v227 offset:12288
    v_cvt_pk_bf16_f32 v121, v122, v123
    s_waitcnt lgkmcnt(3)
    v_mfma_f32_16x16x32_bf16 v[84:87], v[208:211], v[128:131], v[240:243]
    v_exp_f32 v126, v126
    v_mfma_f32_16x16x32_bf16 v[92:95], v[208:211], v[144:147], v[244:247]
    ds_read_b64_tr_b16 v[192:193], v228 offset:16384
    ds_read_b64_tr_b16 v[194:195], v228 offset:20480
    v_add_f32 v254, v254, v124
    s_waitcnt lgkmcnt(4)
    v_mfma_f32_16x16x32_bf16 v[84:87], v[212:215], v[132:135], v[84:87]
    v_exp_f32 v127, v127
    v_mfma_f32_16x16x32_bf16 v[92:95], v[212:215], v[148:151], v[92:95]
    ds_read_b64_tr_b16 v[196:197], v229 offset:16384
    ds_read_b64_tr_b16 v[198:199], v229 offset:20480
    v_add_f32 v254, v254, v125
    v_cvt_pk_bf16_f32 v122, v124, v125
    s_waitcnt lgkmcnt(5)
    v_mfma_f32_16x16x32_bf16 v[84:87], v[216:219], v[136:139], v[84:87]
    v_add_f32 v255, v255, v126
    v_mfma_f32_16x16x32_bf16 v[92:95], v[216:219], v[152:155], v[92:95]
    ds_read_b64_tr_b16 v[200:201], v230 offset:16384
    ds_read_b64_tr_b16 v[202:203], v230 offset:20480
    v_add_f32 v255, v255, v127
    s_waitcnt lgkmcnt(6)
    v_mfma_f32_16x16x32_bf16 v[84:87], v[220:223], v[140:143], v[84:87]
    v_cvt_pk_bf16_f32 v123, v126, v127
    v_mfma_f32_16x16x32_bf16 v[92:95], v[220:223], v[156:159], v[92:95]
    ds_read_b64_tr_b16 v[204:205], v231 offset:16384
    ds_read_b64_tr_b16 v[206:207], v231 offset:20480
    v_add_f32 v252, v252, v253
    v_add_f32 v254, v254, v255
    v_max_f32 v239, v252, v254
    v_cmp_lt_f32 vcc, 0x46800000, v239
    s_cbranch_vccnz L_slow_0_3
L_back_0_3:
    v_add_f32 v248, v248, v252
    v_add_f32 v249, v249, v254
    s_waitcnt lgkmcnt(6)
    v_mfma_f32_16x16x32_bf16 v[0:3], v[192:195], v[96:99], v[0:3]
    v_exp_f32 v64, v64
    v_mfma_f32_16x16x32_bf16 v[8:11], v[192:195], v[104:107], v[8:11]
    ds_read_b64_tr_b16 v[208:209], v232 offset:16384
    ds_read_b64_tr_b16 v[210:211], v232 offset:20480
    v_exp_f32 v65, v65
    s_waitcnt lgkmcnt(6)
    v_mfma_f32_16x16x32_bf16 v[4:7], v[196:199], v[96:99], v[4:7]
    v_exp_f32 v66, v66
    v_mfma_f32_16x16x32_bf16 v[12:15], v[196:199], v[104:107], v[12:15]
    ds_read_b64_tr_b16 v[212:213], v233 offset:16384
    ds_read_b64_tr_b16 v[214:215], v233 offset:20480
    v_exp_f32 v67, v67
    s_waitcnt lgkmcnt(6)
    v_mfma_f32_16x16x32_bf16 v[16:19], v[200:203], v[96:99], v[16:19]
    v_add_f32 v252, v64, v65
    v_cvt_pk_bf16_f32 v64, v64, v65
    v_mfma_f32_16x16x32_bf16 v[24:27], v[200:203], v[104:107], v[24:27]
    ds_read_b64_tr_b16 v[216:217], v234 offset:16384
    ds_read_b64_tr_b16 v[218:219], v234 offset:20480
    v_exp_f32 v68, v68
    s_waitcnt lgkmcnt(6)
    v_mfma_f32_16x16x32_bf16 v[20:23], v[204:207], v[96:99], v[20:23]
    v_exp_f32 v69, v69
    v_mfma_f32_16x16x32_bf16 v[28:31], v[204:207], v[104:107], v[28:31]
    ds_read_b64_tr_b16 v[220:221], v235 offset:16384
    ds_read_b64_tr_b16 v[222:223], v235 offset:20480
    v_add_f32 v253, v66, v67
    s_waitcnt lgkmcnt(6)
    v_mfma_f32_16x16x32_bf16 v[32:35], v[208:211], v[96:99], v[32:35]
    v_cvt_pk_bf16_f32 v65, v66, v67
    v_mfma_f32_16x16x32_bf16 v[40:43], v[208:211], v[104:107], v[40:43]
    ds_read_b64_tr_b16 v[192:193], v228 offset:24576
    ds_read_b64_tr_b16 v[194:195], v228 offset:28672
    v_exp_f32 v70, v70
    v_add_f32 v252, v252, v68
    s_waitcnt lgkmcnt(6)
    v_mfma_f32_16x16x32_bf16 v[36:39], v[212:215], v[96:99], v[36:39]
    v_exp_f32 v71, v71
    v_mfma_f32_16x16x32_bf16 v[44:47], v[212:215], v[104:107], v[44:47]
    ds_read_b64_tr_b16 v[196:197], v229 offset:24576
    ds_read_b64_tr_b16 v[198:199], v229 offset:28672
    v_add_f32 v252, v252, v69
    s_waitcnt lgkmcnt(6)
    v_mfma_f32_16x16x32_bf16 v[48:51], v[216:219], v[96:99], v[48:51]
    v_cvt_pk_bf16_f32 v66, v68, v69
    v_mfma_f32_16x16x32_bf16 v[56:59], v[216:219], v[104:107], v[56:59]
    ds_read_b64_tr_b16 v[200:201], v230 offset:24576
    ds_read_b64_tr_b16 v[202:203], v230 offset:28672
    v_exp_f32 v72, v72
    v_add_f32 v253, v253, v70
    s_waitcnt lgkmcnt(6)
    v_mfma_f32_16x16x32_bf16 v[52:55], v[220:223], v[96:99], v[52:55]
    v_exp_f32 v73, v73
    v_mfma_f32_16x16x32_bf16 v[60:63], v[220:223], v[104:107], v[60:63]
    ds_read_b64_tr_b16 v[204:205], v231 offset:24576
    ds_read_b64_tr_b16 v[206:207], v231 offset:28672
    v_add_f32 v253, v253, v71
    s_waitcnt lgkmcnt(6)
    v_mfma_f32_16x16x32_bf16 v[0:3], v[192:195], v[112:115], v[0:3]
    v_cvt_pk_bf16_f32 v67, v70, v71
    v_mfma_f32_16x16x32_bf16 v[8:11], v[192:195], v[120:123], v[8:11]
    ds_read_b64_tr_b16 v[208:209], v232 offset:24576
    ds_read_b64_tr_b16 v[210:211], v232 offset:28672
    v_exp_f32 v74, v74
    s_waitcnt lgkmcnt(6)
    v_mfma_f32_16x16x32_bf16 v[4:7], v[196:199], v[112:115], v[4:7]
    v_exp_f32 v75, v75
    v_add_f32 v254, v72, v73
    v_mfma_f32_16x16x32_bf16 v[12:15], v[196:199], v[120:123], v[12:15]
    ds_read_b64_tr_b16 v[212:213], v233 offset:24576
    ds_read_b64_tr_b16 v[214:215], v233 offset:28672
    v_cvt_pk_bf16_f32 v72, v72, v73
    s_waitcnt lgkmcnt(6)
    v_mfma_f32_16x16x32_bf16 v[16:19], v[200:203], v[112:115], v[16:19]
    v_exp_f32 v76, v76
    v_mfma_f32_16x16x32_bf16 v[24:27], v[200:203], v[120:123], v[24:27]
    ds_read_b64_tr_b16 v[216:217], v234 offset:24576
    ds_read_b64_tr_b16 v[218:219], v234 offset:28672
    v_exp_f32 v77, v77
    s_waitcnt lgkmcnt(6)
    v_mfma_f32_16x16x32_bf16 v[20:23], v[204:207], v[112:115], v[20:23]
    v_add_f32 v255, v74, v75
    v_cvt_pk_bf16_f32 v73, v74, v75
    v_mfma_f32_16x16x32_bf16 v[28:31], v[204:207], v[120:123], v[28:31]
    ds_read_b64_tr_b16 v[220:221], v235 offset:24576
    ds_read_b64_tr_b16 v[222:223], v235 offset:28672
    v_exp_f32 v78, v78
    s_waitcnt lgkmcnt(6)
    v_mfma_f32_16x16x32_bf16 v[32:35], v[208:211], v[112:115], v[32:35]
    v_add_f32 v254, v254, v76
    v_mfma_f32_16x16x32_bf16 v[40:43], v[208:211], v[120:123], v[40:43]
    ds_read_b128 v[192:195], v224 offset:16384
    v_exp_f32 v79, v79
    s_waitcnt lgkmcnt(5)
    v_mfma_f32_16x16x32_bf16 v[36:39], v[212:215], v[112:115], v[36:39]
    v_add_f32 v254, v254, v77
    v_mfma_f32_16x16x32_bf16 v[44:47], v[212:215], v[120:123], v[44:47]
    ds_read_b128 v[196:199], v225 offset:16384
    v_cvt_pk_bf16_f32 v74, v76, v77
    v_exp_f32 v80, v80
    s_waitcnt lgkmcnt(4)
    v_mfma_f32_16x16x32_bf16 v[48:51], v[216:219], v[112:115], v[48:51]
    v_add_f32 v255, v255, v78
    v_mfma_f32_16x16x32_bf16 v[56:59], v[216:219], v[120:123], v[56:59]
    ds_read_b128 v[200:203], v226 offset:16384
    v_exp_f32 v81, v81
    s_waitcnt lgkmcnt(3)
    v_mfma_f32_16x16x32_bf16 v[52:55], v[220:223], v[112:115], v[52:55]
    v_add_f32 v255, v255, v79
    v_mfma_f32_16x16x32_bf16 v[60:63], v[220:223], v[120:123], v[60:63]
    ds_read_b128 v[204:207], v227 offset:16384
    v_cvt_pk_bf16_f32 v75, v78, v79
    v_exp_f32 v82, v82
    s_waitcnt lgkmcnt(3)
    v_mfma_f32_16x16x32_bf16 v[96:99], v[192:195], v[128:131], v[240:243]
    v_add_f32 v252, v252, v80
    v_mfma_f32_16x16x32_bf16 v[104:107], v[192:195], v[144:147], v[244:247]
    ds_read_b128 v[208:211], v224 offset:20480
    v_exp_f32 v83, v83
    s_waitcnt lgkmcnt(3)
    v_mfma_f32_16x16x32_bf16 v[96:99], v[196:199], v[132:135], v[96:99]
    v_add_f32 v252, v252, v81
    v_mfma_f32_16x16x32_bf16 v[104:107], v[196:199], v[148:151], v[104:107]
    ds_read_b128 v[212:215], v225 offset:20480
    v_cvt_pk_bf16_f32 v80, v80, v81
    s_waitcnt lgkmcnt(3)
    v_mfma_f32_16x16x32_bf16 v[96:99], v[200:203], v[136:139], v[96:99]
    v_exp_f32 v84, v84
    v_add_f32 v253, v253, v82
    v_mfma_f32_16x16x32_bf16 v[104:107], v[200:203], v[152:155], v[104:107]
    ds_read_b128 v[216:219], v226 offset:20480
    v_exp_f32 v85, v85
    s_waitcnt lgkmcnt(3)
    v_mfma_f32_16x16x32_bf16 v[96:99], v[204:207], v[140:143], v[96:99]
    v_add_f32 v253, v253, v83
    v_mfma_f32_16x16x32_bf16 v[104:107], v[204:207], v[156:159], v[104:107]
    ds_read_b128 v[220:223], v227 offset:20480
    v_cvt_pk_bf16_f32 v81, v82, v83
    s_waitcnt lgkmcnt(3)
    v_mfma_f32_16x16x32_bf16 v[100:103], v[208:211], v[128:131], v[240:243]
    v_exp_f32 v86, v86
    v_mfma_f32_16x16x32_bf16 v[108:111], v[208:211], v[144:147], v[244:247]
    ds_read_b128 v[192:195], v224 offset:24576
    v_add_f32 v252, v252, v84
    v_exp_f32 v87, v87
    s_waitcnt lgkmcnt(3)
    v_mfma_f32_16x16x32_bf16 v[100:103], v[212:215], v[132:135], v[100:103]
    v_add_f32 v252, v252, v85
    v_mfma_f32_16x16x32_bf16 v[108:111], v[212:215], v[148:151], v[108:111]
    ds_read_b128 v[196:199], v225 offset:24576
    v_cvt_pk_bf16_f32 v82, v84, v85
    s_waitcnt lgkmcnt(3)
    v_mfma_f32_16x16x32_bf16 v[100:103], v[216:219], v[136:139], v[100:103]
    v_exp_f32 v88, v88
    v_mfma_f32_16x16x32_bf16 v[108:111], v[216:219], v[152:155], v[108:111]
    ds_read_b128 v[200:203], v226 offset:24576
    v_add_f32 v253, v253, v86
    v_exp_f32 v89, v89
    s_waitcnt lgkmcnt(3)
    v_mfma_f32_16x16x32_bf16 v[100:103], v[220:223], v[140:143], v[100:103]
    v_add_f32 v253, v253, v87
    v_mfma_f32_16x16x32_bf16 v[108:111], v[220:223], v[156:159], v[108:111]
    ds_read_b128 v[204:207], v227 offset:24576
    v_cvt_pk_bf16_f32 v83, v86, v87
    s_waitcnt lgkmcnt(3)
    v_mfma_f32_16x16x32_bf16 v[112:115], v[192:195], v[128:131], v[240:243]
    v_exp_f32 v90, v90
    v_mfma_f32_16x16x32_bf16 v[120:123], v[192:195], v[144:147], v[244:247]
    ds_read_b128 v[208:211], v224 offset:28672
    v_add_f32 v254, v254, v88
    s_waitcnt lgkmcnt(3)
    v_mfma_f32_16x16x32_bf16 v[112:115], v[196:199], v[132:135], v[112:115]
    v_exp_f32 v91, v91
    v_add_f32 v254, v254, v89
    v_mfma_f32_16x16x32_bf16 v[120:123], v[196:199], v[148:151], v[120:123]
    ds_read_b128 v[212:215], v225 offset:28672
    v_cvt_pk_bf16_f32 v88, v88, v89
    s_waitcnt lgkmcnt(3)
    v_mfma_f32_16x16x32_bf16 v[112:115], v[200:203], v[136:139], v[112:115]
    v_exp_f32 v92, v92
    v_mfma_f32_16x16x32_bf16 v[120:123], v[200:203], v[152:155], v[120:123]
    ds_read_b128 v[216:219], v226 offset:28672
    v_add_f32 v255, v255, v90
    s_waitcnt lgkmcnt(3)
    v_mfma_f32_16x16x32_bf16 v[112:115], v[204:207], v[140:143], v[112:115]
    v_exp_f32 v93, v93
    v_add_f32 v255, v255, v91
    v_mfma_f32_16x16x32_bf16 v[120:123], v[204:207], v[156:159], v[120:123]
    ds_read_b128 v[220:223], v227 offset:28672
    v_cvt_pk_bf16_f32 v89, v90, v91
    s_waitcnt lgkmcnt(3)
    v_mfma_f32_16x16x32_bf16 v[116:119], v[208:211], v[128:131], v[240:243]
    v_exp_f32 v94, v94
    v_mfma_f32_16x16x32_bf16 v[124:127], v[208:211], v[144:147], v[244:247]
    s_waitcnt vmcnt(4)
    s_barrier
    s_add_u32 m0, s81, 0
    s_add_u32 s38, s82, 0
    buffer_load_dwordx4 v238, s[20:23], s38 offen nt lds
    s_add_u32 m0, s81, 8192
    s_add_u32 s38, s82, 8192
    buffer_load_dwordx4 v238, s[20:23], s38 offen nt lds
    s_add_u32 m0, s81, 16384
    s_add_u32 s38, s82, 16384
    buffer_load_dwordx4 v238, s[20:23], s38 offen nt lds
    s_add_u32 m0, s81, 24576
    s_add_u32 s38, s82, 24576
    buffer_load_dwordx4 v238, s[20:23], s38 offen nt lds
    v_add_u32 v228, s86, v228
    ds_read_b64_tr_b16 v[192:193], v228 offset:0
    ds_read_b64_tr_b16 v[194:195], v228 offset:4096
    v_add_f32 v254, v254, v92
    s_waitcnt lgkmcnt(4)
    v_mfma_f32_16x16x32_bf16 v[116:119], v[212:215], v[132:135], v[116:119]
    v_exp_f32 v95, v95
    v_mfma_f32_16x16x32_bf16 v[124:127], v[212:215], v[148:151], v[124:127]
    v_add_u32 v229, s86, v229
    ds_read_b64_tr_b16 v[196:197], v229 offset:0
    ds_read_b64_tr_b16 v[198:199], v229 offset:4096
    v_add_f32 v254, v254, v93
    v_cvt_pk_bf16_f32 v90, v92, v93
    s_waitcnt lgkmcnt(5)
    v_mfma_f32_16x16x32_bf16 v[116:119], v[216:219], v[136:139], v[116:119]
    v_add_f32 v255, v255, v94
    v_mfma_f32_16x16x32_bf16 v[124:127], v[216:219], v[152:155], v[124:127]
    v_add_u32 v230, s86, v230
    ds_read_b64_tr_b16 v[200:201], v230 offset:0
    ds_read_b64_tr_b16 v[202:203], v230 offset:4096
    v_add_f32 v255, v255, v95
    s_waitcnt lgkmcnt(6)
    v_mfma_f32_16x16x32_bf16 v[116:119], v[220:223], v[140:143], v[116:119]
    v_cvt_pk_bf16_f32 v91, v94, v95
    v_mfma_f32_16x16x32_bf16 v[124:127], v[220:223], v[156:159], v[124:127]
    v_add_u32 v231, s86, v231
    ds_read_b64_tr_b16 v[204:205], v231 offset:0
    ds_read_b64_tr_b16 v[206:207], v231 offset:4096
    v_add_f32 v252, v252, v253
    v_add_f32 v254, v254, v255
    v_max_f32 v239, v252, v254
    v_cmp_lt_f32 vcc, 0x46800000, v239
    s_cbranch_vccnz L_slow_0_4
L_back_0_4:
    v_add_f32 v248, v248, v252
    v_add_f32 v249, v249, v254
    s_waitcnt lgkmcnt(6)
    v_mfma_f32_16x16x32_bf16 v[0:3], v[192:195], v[64:67], v[0:3]
    v_exp_f32 v96, v96
    v_mfma_f32_16x16x32_bf16 v[8:11], v[192:195], v[72:75], v[8:11]
    v_add_u32 v232, s86, v232
    ds_read_b64_tr_b16 v[208:209], v232 offset:0
    ds_read_b64_tr_b16 v[210:211], v232 offset:4096
    v_exp_f32 v97, v97
    s_waitcnt lgkmcnt(6)
    v_mfma_f32_16x16x32_bf16 v[4:7], v[196:199], v[64:67], v[4:7]
    v_exp_f32 v98, v98
    v_mfma_f32_16x16x32_bf16 v[12:15], v[196:199], v[72:75], v[12:15]
    v_add_u32 v233, s86, v233
    ds_read_b64_tr_b16 v[212:213], v233 offset:0
    ds_read_b64_tr_b16 v[214:215], v233 offset:4096
    v_exp_f32 v99, v99
    s_waitcnt lgkmcnt(6)
    v_mfma_f32_16x16x32_bf16 v[16:19], v[200:203], v[64:67], v[16:19]
    v_add_f32 v252, v96, v97
    v_cvt_pk_bf16_f32 v96, v96, v97
    v_mfma_f32_16x16x32_bf16 v[24:27], v[200:203], v[72:75], v[24:27]
    v_add_u32 v234, s86, v234
    ds_read_b64_tr_b16 v[216:217], v234 offset:0
    ds_read_b64_tr_b16 v[218:219], v234 offset:4096
    v_exp_f32 v100, v100
    s_waitcnt lgkmcnt(6)
    v_mfma_f32_16x16x32_bf16 v[20:23], v[204:207], v[64:67], v[20:23]
    v_exp_f32 v101, v101
    v_mfma_f32_16x16x32_bf16 v[28:31], v[204:207], v[72:75], v[28:31]
    v_add_u32 v235, s86, v235
    ds_read_b64_tr_b16 v[220:221], v235 offset:0
    ds_read_b64_tr_b16 v[222:223], v235 offset:4096
    v_add_f32 v253, v98, v99
    s_waitcnt lgkmcnt(6)
    v_mfma_f32_16x16x32_bf16 v[32:35], v[208:211], v[64:67], v[32:35]
    v_cvt_pk_bf16_f32 v97, v98, v99
    v_mfma_f32_16x16x32_bf16 v[40:43], v[208:211], v[72:75], v[40:43]
    ds_read_b64_tr_b16 v[192:193], v228 offset:8192
    ds_read_b64_tr_b16 v[194:195], v228 offset:12288
    v_exp_f32 v102, v102
    v_add_f32 v252, v252, v100
    s_waitcnt lgkmcnt(6)
    v_mfma_f32_16x16x32_bf16 v[36:39], v[212:215], v[64:67], v[36:39]
    v_exp_f32 v103, v103
    v_mfma_f32_16x16x32_bf16 v[44:47], v[212:215], v[72:75], v[44:47]
    ds_read_b64_tr_b16 v[196:197], v229 offset:8192
    ds_read_b64_tr_b16 v[198:199], v229 offset:12288
    v_add_f32 v252, v252, v101
    s_waitcnt lgkmcnt(6)
    v_mfma_f32_16x16x32_bf16 v[48:51], v[216:219], v[64:67], v[48:51]
    v_cvt_pk_bf16_f32 v98, v100, v101
    v_mfma_f32_16x16x32_bf16 v[56:59], v[216:219], v[72:75], v[56:59]
    ds_read_b64_tr_b16 v[200:201], v230 offset:8192
    ds_read_b64_tr_b16 v[202:203], v230 offset:12288
    v_exp_f32 v104, v104
    v_add_f32 v253, v253, v102
    s_waitcnt lgkmcnt(6)
    v_mfma_f32_16x16x32_bf16 v[52:55], v[220:223], v[64:67], v[52:55]
    v_exp_f32 v105, v105
    v_mfma_f32_16x16x32_bf16 v[60:63], v[220:223], v[72:75], v[60:63]
    ds_read_b64_tr_b16 v[204:205], v231 offset:8192
    ds_read_b64_tr_b16 v[206:207], v231 offset:12288
    v_add_f32 v253, v253, v103
    s_waitcnt lgkmcnt(6)
    v_mfma_f32_16x16x32_bf16 v[0:3], v[192:195], v[80:83], v[0:3]
    v_cvt_pk_bf16_f32 v99, v102, v103
    v_mfma_f32_16x16x32_bf16 v[8:11], v[192:195], v[88:91], v[8:11]
    ds_read_b64_tr_b16 v[208:209], v232 offset:8192
    ds_read_b64_tr_b16 v[210:211], v232 offset:12288
    v_exp_f32 v106, v106
    s_waitcnt lgkmcnt(6)
    v_mfma_f32_16x16x32_bf16 v[4:7], v[196:199], v[80:83], v[4:7]
    v_exp_f32 v107, v107
    v_add_f32 v254, v104, v105
    v_mfma_f32_16x16x32_bf16 v[12:15], v[196:199], v[88:91], v[12:15]
    ds_read_b64_tr_b16 v[212:213], v233 offset:8192
    ds_read_b64_tr_b16 v[214:215], v233 offset:12288
    v_cvt_pk_bf16_f32 v104, v104, v105
    s_waitcnt lgkmcnt(6)
    v_mfma_f32_16x16x32_bf16 v[16:19], v[200:203], v[80:83], v[16:19]
    v_exp_f32 v108, v108
    v_mfma_f32_16x16x32_bf16 v[24:27], v[200:203], v[88:91], v[24:27]
    ds_read_b64_tr_b16 v[216:217], v234 offset:8192
    ds_read_b64_tr_b16 v[218:219], v234 offset:12288
    v_exp_f32 v109, v109
    s_waitcnt lgkmcnt(6)
    v_mfma_f32_16x16x32_bf16 v[20:23], v[204:207], v[80:83], v[20:23]
    v_add_f32 v255, v106, v107
    v_cvt_pk_bf16_f32 v105, v106, v107
    v_mfma_f32_16x16x32_bf16 v[28:31], v[204:207], v[88:91], v[28:31]
    ds_read_b64_tr_b16 v[220:221], v235 offset:8192
    ds_read_b64_tr_b16 v[222:223], v235 offset:12288
    v_exp_f32 v110, v110
    s_waitcnt lgkmcnt(6)
    v_mfma_f32_16x16x32_bf16 v[32:35], v[208:211], v[80:83], v[32:35]
    v_add_f32 v254, v254, v108
    v_mfma_f32_16x16x32_bf16 v[40:43], v[208:211], v[88:91], v[40:43]
    v_add_u32 v224, s47, v224
    ds_read_b128 v[192:195], v224 offset:0
    v_exp_f32 v111, v111
    s_waitcnt lgkmcnt(5)
    v_mfma_f32_16x16x32_bf16 v[36:39], v[212:215], v[80:83], v[36:39]
    v_add_f32 v254, v254, v109
    v_mfma_f32_16x16x32_bf16 v[44:47], v[212:215], v[88:91], v[44:47]
    v_add_u32 v225, s47, v225
    ds_read_b128 v[196:199], v225 offset:0
    v_cvt_pk_bf16_f32 v106, v108, v109
    v_exp_f32 v112, v112
    s_waitcnt lgkmcnt(4)
    v_mfma_f32_16x16x32_bf16 v[48:51], v[216:219], v[80:83], v[48:51]
    v_add_f32 v255, v255, v110
    v_mfma_f32_16x16x32_bf16 v[56:59], v[216:219], v[88:91], v[56:59]
    v_add_u32 v226, s47, v226
    ds_read_b128 v[200:203], v226 offset:0
    v_exp_f32 v113, v113
    s_waitcnt lgkmcnt(3)
    v_mfma_f32_16x16x32_bf16 v[52:55], v[220:223], v[80:83], v[52:55]
    v_add_f32 v255, v255, v111
    v_mfma_f32_16x16x32_bf16 v[60:63], v[220:223], v[88:91], v[60:63]
    v_add_u32 v227, s47, v227
    ds_read_b128 v[204:207], v227 offset:0
    v_cvt_pk_bf16_f32 v107, v110, v111
    v_exp_f32 v114, v114
    s_waitcnt vmcnt(4)
    s_waitcnt lgkmcnt(3)
    v_mfma_f32_16x16x32_bf16 v[64:67], v[192:195], v[160:163], 0
    v_add_f32 v252, v252, v112
    v_mfma_f32_16x16x32_bf16 v[72:75], v[192:195], v[176:179], 0
    ds_read_b128 v[208:211], v224 offset:4096
    v_exp_f32 v115, v115
    s_waitcnt lgkmcnt(3)
    v_mfma_f32_16x16x32_bf16 v[64:67], v[196:199], v[164:167], v[64:67]
    v_add_f32 v252, v252, v113
    v_mfma_f32_16x16x32_bf16 v[72:75], v[196:199], v[180:183], v[72:75]
    ds_read_b128 v[212:215], v225 offset:4096
    v_cvt_pk_bf16_f32 v112, v112, v113
    s_waitcnt lgkmcnt(3)
    v_mfma_f32_16x16x32_bf16 v[64:67], v[200:203], v[168:171], v[64:67]
    v_exp_f32 v116, v116
    v_add_f32 v253, v253, v114
    v_mfma_f32_16x16x32_bf16 v[72:75], v[200:203], v[184:187], v[72:75]
    ds_read_b128 v[216:219], v226 offset:4096
    v_exp_f32 v117, v117
    s_waitcnt lgkmcnt(3)
    v_mfma_f32_16x16x32_bf16 v[64:67], v[204:207], v[172:175], v[64:67]
    v_add_f32 v253, v253, v115
    v_mfma_f32_16x16x32_bf16 v[72:75], v[204:207], v[188:191], v[72:75]
    ds_read_b128 v[220:223], v227 offset:4096
    v_cvt_pk_bf16_f32 v113, v114, v115
    s_waitcnt lgkmcnt(3)
    v_mfma_f32_16x16x32_bf16 v[68:71], v[208:211], v[160:163], 0
    v_exp_f32 v118, v118
    v_mfma_f32_16x16x32_bf16 v[76:79], v[208:211], v[176:179], 0
    ds_read_b128 v[192:195], v224 offset:8192
    v_add_f32 v252, v252, v116
    v_exp_f32 v119, v119
    s_waitcnt lgkmcnt(3)
    v_mfma_f32_16x16x32_bf16 v[68:71], v[212:215], v[164:167], v[68:71]
    v_add_f32 v252, v252, v117
    v_mfma_f32_16x16x32_bf16 v[76:79], v[212:215], v[180:183], v[76:79]
    ds_read_b128 v[196:199], v225 offset:8192
    v_cvt_pk_bf16_f32 v114, v116, v117
    s_waitcnt lgkmcnt(3)
    v_mfma_f32_16x16x32_bf16 v[68:71], v[216:219], v[168:171], v[68:71]
    v_exp_f32 v120, v120
    v_mfma_f32_16x16x32_bf16 v[76:79], v[216:219], v[184:187], v[76:79]
    ds_read_b128 v[200:203], v226 offset:8192
    v_add_f32 v253, v253, v118
    v_exp_f32 v121, v121
    s_waitcnt lgkmcnt(3)
    v_mfma_f32_16x16x32_bf16 v[68:71], v[220:223], v[172:175], v[68:71]
    v_add_f32 v253, v253, v119
    v_mfma_f32_16x16x32_bf16 v[76:79], v[220:223], v[188:191], v[76:79]
    ds_read_b128 v[204:207], v227 offset:8192
    v_cvt_pk_bf16_f32 v115, v118, v119
    s_waitcnt lgkmcnt(3)
    v_mfma_f32_16x16x32_bf16 v[80:83], v[192:195], v[160:163], 0
    v_exp_f32 v122, v122
    v_mfma_f32_16x16x32_bf16 v[88:91], v[192:195], v[176:179], 0
    ds_read_b128 v[208:211], v224 offset:12288
    v_add_f32 v254, v254, v120
    s_waitcnt lgkmcnt(3)
    v_mfma_f32_16x16x32_bf16 v[80:83], v[196:199], v[164:167], v[80:83]
    v_exp_f32 v123, v123
    v_add_f32 v254, v254, v121
    v_mfma_f32_16x16x32_bf16 v[88:91], v[196:199], v[180:183], v[88:91]
    ds_read_b128 v[212:215], v225 offset:12288
    v_cvt_pk_bf16_f32 v120, v120, v121
    s_waitcnt lgkmcnt(3)
    v_mfma_f32_16x16x32_bf16 v[80:83], v[200:203], v[168:171], v[80:83]
    v_exp_f32 v124, v124
    v_mfma_f32_16x16x32_bf16 v[88:91], v[200:203], v[184:187], v[88:91]
    ds_read_b128 v[216:219], v226 offset:12288
    v_add_f32 v255, v255, v122
    s_waitcnt lgkmcnt(3)
    v_mfma_f32_16x16x32_bf16 v[80:83], v[204:207], v[172:175], v[80:83]
    v_exp_f32 v125, v125
    v_add_f32 v255, v255, v123
    v_mfma_f32_16x16x32_bf16 v[88:91], v[204:207], v[188:191], v[88:91]
    ds_read_b128 v[220:223], v227 offset:12288
    v_cvt_pk_bf16_f32 v121, v122, v123
    s_waitcnt lgkmcnt(3)
    v_mfma_f32_16x16x32_bf16 v[84:87], v[208:211], v[160:163], 0
    v_exp_f32 v126, v126
    v_mfma_f32_16x16x32_bf16 v[92:95], v[208:211], v[176:179], 0
    ds_read_b64_tr_b16 v[192:193], v228 offset:16384
    ds_read_b64_tr_b16 v[194:195], v228 offset:20480
    v_add_f32 v254, v254, v124
    s_waitcnt lgkmcnt(4)
    v_mfma_f32_16x16x32_bf16 v[84:87], v[212:215], v[164:167], v[84:87]
    v_exp_f32 v127, v127
    v_mfma_f32_16x16x32_bf16 v[92:95], v[212:215], v[180:183], v[92:95]
    ds_read_b64_tr_b16 v[196:197], v229 offset:16384
    ds_read_b64_tr_b16 v[198:199], v229 offset:20480
    v_add_f32 v254, v254, v125
    v_cvt_pk_bf16_f32 v122, v124, v125
    s_waitcnt lgkmcnt(5)
    v_mfma_f32_16x16x32_bf16 v[84:87], v[216:219], v[168:171], v[84:87]
    v_add_f32 v255, v255, v126
    v_mfma_f32_16x16x32_bf16 v[92:95], v[216:219], v[184:187], v[92:95]
    ds_read_b64_tr_b16 v[200:201], v230 offset:16384
    ds_read_b64_tr_b16 v[202:203], v230 offset:20480
    v_add_f32 v255, v255, v127
    s_waitcnt lgkmcnt(6)
    v_mfma_f32_16x16x32_bf16 v[84:87], v[220:223], v[172:175], v[84:87]
    v_cvt_pk_bf16_f32 v123, v126, v127
    v_mfma_f32_16x16x32_bf16 v[92:95], v[220:223], v[188:191], v[92:95]
    ds_read_b64_tr_b16 v[204:205], v231 offset:16384
    ds_read_b64_tr_b16 v[206:207], v231 offset:20480
    v_add_f32 v252, v252, v253
    v_add_f32 v254, v254, v255
    v_max_f32 v239, v252, v254
    v_cmp_lt_f32 vcc, 0x46800000, v239
    s_cbranch_vccnz L_slow_0_5
L_back_0_5:
    v_add_f32 v248, v248, v252
    v_add_f32 v249, v249, v254
    s_waitcnt lgkmcnt(6)
    v_mfma_f32_16x16x32_bf16 v[0:3], v[192:195], v[96:99], v[0:3]
    v_mov_b32 v250, v248
    v_mov_b32 v251, v249
    v_mfma_f32_16x16x32_bf16 v[8:11], v[192:195], v[104:107], v[8:11]
    ds_read_b64_tr_b16 v[208:209], v232 offset:16384
    ds_read_b64_tr_b16 v[210:211], v232 offset:20480
    v_mov_b32 v252, v250
    v_mov_b32 v253, v251
    s_nop 0
    v_permlane16_swap_b32 v250, v252
    s_waitcnt lgkmcnt(6)
    v_mfma_f32_16x16x32_bf16 v[4:7], v[196:199], v[96:99], v[4:7]
    v_permlane16_swap_b32 v251, v253
    v_add_f32 v250, v250, v252
    v_mfma_f32_16x16x32_bf16 v[12:15], v[196:199], v[104:107], v[12:15]
    ds_read_b64_tr_b16 v[212:213], v233 offset:16384
    ds_read_b64_tr_b16 v[214:215], v233 offset:20480
    v_add_f32 v251, v251, v253
    v_mov_b32 v252, v250
    v_mov_b32 v253, v251
    s_waitcnt lgkmcnt(6)
    v_mfma_f32_16x16x32_bf16 v[16:19], v[200:203], v[96:99], v[16:19]
    v_permlane32_swap_b32 v250, v252
    v_permlane32_swap_b32 v251, v253
    v_mfma_f32_16x16x32_bf16 v[24:27], v[200:203], v[104:107], v[24:27]
    ds_read_b64_tr_b16 v[216:217], v234 offset:16384
    ds_read_b64_tr_b16 v[218:219], v234 offset:20480
    v_add_f32 v250, v250, v252
    v_add_f32 v251, v251, v253
    v_rcp_f32 v250, v250
    s_waitcnt lgkmcnt(6)
    v_mfma_f32_16x16x32_bf16 v[20:23], v[204:207], v[96:99], v[20:23]
    v_rcp_f32 v251, v251
    v_max3_f32 v252, v64, v65, v66
    v_mfma_f32_16x16x32_bf16 v[28:31], v[204:207], v[104:107], v[28:31]
    ds_read_b64_tr_b16 v[220:221], v235 offset:16384
    ds_read_b64_tr_b16 v[222:223], v235 offset:20480
    v_max3_f32 v254, v72, v73, v74
    v_max3_f32 v252, v252, v67, v68
    v_max3_f32 v254, v254, v75, v76
    s_waitcnt lgkmcnt(6)
    v_mfma_f32_16x16x32_bf16 v[32:35], v[208:211], v[96:99], v[32:35]
    v_max3_f32 v252, v252, v69, v70
    v_max3_f32 v254, v254, v77, v78
    v_mfma_f32_16x16x32_bf16 v[40:43], v[208:211], v[104:107], v[40:43]
    ds_read_b64_tr_b16 v[192:193], v228 offset:24576
    ds_read_b64_tr_b16 v[194:195], v228 offset:28672
    v_max3_f32 v252, v252, v71, v80
    v_max3_f32 v254, v254, v79, v88
    v_max3_f32 v252, v252, v81, v82
    s_waitcnt lgkmcnt(6)
    v_mfma_f32_16x16x32_bf16 v[36:39], v[212:215], v[96:99], v[36:39]
    v_max3_f32 v254, v254, v89, v90
    v_max3_f32 v252, v252, v83, v84
    v_max3_f32 v254, v254, v91, v92
    v_mfma_f32_16x16x32_bf16 v[44:47], v[212:215], v[104:107], v[44:47]
    ds_read_b64_tr_b16 v[196:197], v229 offset:24576
    ds_read_b64_tr_b16 v[198:199], v229 offset:28672
    v_max3_f32 v252, v252, v85, v86
    v_max3_f32 v254, v254, v93, v94
    s_waitcnt lgkmcnt(6)
    v_mfma_f32_16x16x32_bf16 v[48:51], v[216:219], v[96:99], v[48:51]
    v_max_f32 v252, v252, v87
    v_max_f32 v254, v254, v95
    v_mov_b32 v253, v252
    v_mfma_f32_16x16x32_bf16 v[56:59], v[216:219], v[104:107], v[56:59]
    ds_read_b64_tr_b16 v[200:201], v230 offset:24576
    ds_read_b64_tr_b16 v[202:203], v230 offset:28672
    v_mov_b32 v255, v254
    v_permlane16_swap_b32 v252, v253
    s_waitcnt lgkmcnt(6)
    v_mfma_f32_16x16x32_bf16 v[52:55], v[220:223], v[96:99], v[52:55]
    v_permlane16_swap_b32 v254, v255
    v_max_f32 v252, v252, v253
    v_max_f32 v254, v254, v255
    v_mfma_f32_16x16x32_bf16 v[60:63], v[220:223], v[104:107], v[60:63]
    ds_read_b64_tr_b16 v[204:205], v231 offset:24576
    ds_read_b64_tr_b16 v[206:207], v231 offset:28672
    v_mov_b32 v253, v252
    v_mov_b32 v255, v254
    s_waitcnt lgkmcnt(6)
    v_mfma_f32_16x16x32_bf16 v[0:3], v[192:195], v[112:115], v[0:3]
    v_permlane32_swap_b32 v252, v253
    v_permlane32_swap_b32 v254, v255
    v_max_f32 v252, v252, v253
    v_mfma_f32_16x16x32_bf16 v[8:11], v[192:195], v[120:123], v[8:11]
    ds_read_b64_tr_b16 v[208:209], v232 offset:24576
    ds_read_b64_tr_b16 v[210:211], v232 offset:28672
    v_max_f32 v254, v254, v255
    v_sub_f32 v240, 0, v252
    s_waitcnt lgkmcnt(6)
    v_mfma_f32_16x16x32_bf16 v[4:7], v[196:199], v[112:115], v[4:7]
    v_sub_f32 v241, 0, v252
    v_sub_f32 v242, 0, v252
    v_sub_f32 v243, 0, v252
    v_mfma_f32_16x16x32_bf16 v[12:15], v[196:199], v[120:123], v[12:15]
    ds_read_b64_tr_b16 v[212:213], v233 offset:24576
    ds_read_b64_tr_b16 v[214:215], v233 offset:28672
    v_sub_f32 v244, 0, v254
    v_sub_f32 v245, 0, v254
    s_waitcnt lgkmcnt(6)
    v_mfma_f32_16x16x32_bf16 v[16:19], v[200:203], v[112:115], v[16:19]
    v_sub_f32 v246, 0, v254
    v_sub_f32 v247, 0, v254
    v_mfma_f32_16x16x32_bf16 v[24:27], v[200:203], v[120:123], v[24:27]
    ds_read_b64_tr_b16 v[216:217], v234 offset:24576
    ds_read_b64_tr_b16 v[218:219], v234 offset:28672
    v_add_f32 v64, v64, v241
    v_add_f32 v65, v65, v242
    v_exp_f32 v64, v64
    s_waitcnt lgkmcnt(6)
    v_mfma_f32_16x16x32_bf16 v[20:23], v[204:207], v[112:115], v[20:23]
    v_add_f32 v66, v66, v243
    v_exp_f32 v65, v65
    v_mfma_f32_16x16x32_bf16 v[28:31], v[204:207], v[120:123], v[28:31]
    ds_read_b64_tr_b16 v[220:221], v235 offset:24576
    ds_read_b64_tr_b16 v[222:223], v235 offset:28672
    v_add_f32 v67, v67, v240
    v_exp_f32 v66, v66
    v_add_f32 v68, v68, v241
    s_waitcnt lgkmcnt(6)
    v_mfma_f32_16x16x32_bf16 v[32:35], v[208:211], v[112:115], v[32:35]
    v_exp_f32 v67, v67
    v_add_f32 v252, v64, v65
    v_mfma_f32_16x16x32_bf16 v[40:43], v[208:211], v[120:123], v[40:43]
    ds_read_b128 v[192:195], v224 offset:16384
    v_cvt_pk_bf16_f32 v64, v64, v65
    v_add_f32 v69, v69, v242
    v_exp_f32 v68, v68
    s_waitcnt lgkmcnt(5)
    v_mfma_f32_16x16x32_bf16 v[36:39], v[212:215], v[112:115], v[36:39]
    v_add_f32 v70, v70, v243
    v_exp_f32 v69, v69
    v_mfma_f32_16x16x32_bf16 v[44:47], v[212:215], v[120:123], v[44:47]
    ds_read_b128 v[196:199], v225 offset:16384
    v_add_f32 v253, v66, v67
    v_cvt_pk_bf16_f32 v65, v66, v67
    v_add_f32 v71, v71, v240
    s_waitcnt lgkmcnt(4)
    v_mfma_f32_16x16x32_bf16 v[48:51], v[216:219], v[112:115], v[48:51]
    v_exp_f32 v70, v70
    v_add_f32 v252, v252, v68
    v_mfma_f32_16x16x32_bf16 v[56:59], v[216:219], v[120:123], v[56:59]
    ds_read_b128 v[200:203], v226 offset:16384
    v_add_f32 v72, v72, v245
    v_exp_f32 v71, v71
    v_add_f32 v252, v252, v69
    s_waitcnt lgkmcnt(3)
    v_mfma_f32_16x16x32_bf16 v[52:55], v[220:223], v[112:115], v[52:55]
    v_cvt_pk_bf16_f32 v66, v68, v69
    v_add_f32 v73, v73, v246
    v_mfma_f32_16x16x32_bf16 v[60:63], v[220:223], v[120:123], v[60:63]
    ds_read_b128 v[204:207], v227 offset:16384
    v_exp_f32 v72, v72
    v_add_f32 v253, v253, v70
    v_add_f32 v74, v74, v247
    s_waitcnt lgkmcnt(3)
    v_mfma_f32_16x16x32_bf16 v[96:99], v[192:195], v[160:163], v[240:243]
    v_exp_f32 v73, v73
    v_add_f32 v253, v253, v71
    v_cvt_pk_bf16_f32 v67, v70, v71
    v_mfma_f32_16x16x32_bf16 v[104:107], v[192:195], v[176:179], v[244:247]
    ds_read_b128 v[208:211], v224 offset:20480
    v_add_f32 v75, v75, v244
    v_exp_f32 v74, v74
    s_waitcnt lgkmcnt(3)
    v_mfma_f32_16x16x32_bf16 v[96:99], v[196:199], v[164:167], v[96:99]
    v_add_f32 v76, v76, v245
    v_exp_f32 v75, v75
    v_add_f32 v254, v72, v73
    v_xor_b32 v239, 64, v237
    v_mul_f32 v0, v0, v250
    v_mul_f32 v1, v1, v250
    v_mul_f32 v2, v2, v250
    v_mul_f32 v3, v3, v250
    v_mfma_f32_16x16x32_bf16 v[104:107], v[196:199], v[180:183], v[104:107]
    ds_read_b128 v[212:215], v225 offset:20480
    v_cvt_pk_bf16_f32 v72, v72, v73
    v_add_f32 v77, v77, v246
    v_mul_f32 v4, v4, v250
    v_mul_f32 v5, v5, v250
    v_mul_f32 v6, v6, v250
    v_mul_f32 v7, v7, v250
    v_cvt_pk_bf16_f32 v0, v0, v1
    v_cvt_pk_bf16_f32 v1, v2, v3
    s_waitcnt lgkmcnt(3)
    v_mfma_f32_16x16x32_bf16 v[96:99], v[200:203], v[168:171], v[96:99]
    v_exp_f32 v76, v76
    v_add_f32 v78, v78, v247
    v_exp_f32 v77, v77
    v_cvt_pk_bf16_f32 v2, v4, v5
    v_cvt_pk_bf16_f32 v3, v6, v7
    s_nop 0
    v_permlane16_swap_b32 v0, v2
    v_permlane16_swap_b32 v1, v3
    v_mul_f32 v16, v16, v250
    v_mfma_f32_16x16x32_bf16 v[104:107], v[200:203], v[184:187], v[104:107]
    ds_read_b128 v[216:219], v226 offset:20480
    v_add_f32 v255, v74, v75
    v_cvt_pk_bf16_f32 v73, v74, v75
    v_mul_f32 v17, v17, v250
    v_mul_f32 v18, v18, v250
    v_mul_f32 v19, v19, v250
    v_mul_f32 v20, v20, v250
    v_mul_f32 v21, v21, v250
    v_mul_f32 v22, v22, v250
    s_waitcnt lgkmcnt(3)
    v_mfma_f32_16x16x32_bf16 v[96:99], v[204:207], v[172:175], v[96:99]
    v_add_f32 v79, v79, v244
    v_exp_f32 v78, v78
    v_add_f32 v254, v254, v76
    v_mul_f32 v23, v23, v250
    v_cvt_pk_bf16_f32 v16, v16, v17
    v_cvt_pk_bf16_f32 v17, v18, v19
    v_cvt_pk_bf16_f32 v18, v20, v21
    v_cvt_pk_bf16_f32 v19, v22, v23
    s_nop 0
    v_permlane16_swap_b32 v16, v18
    v_mfma_f32_16x16x32_bf16 v[104:107], v[204:207], v[188:191], v[104:107]
    ds_read_b128 v[220:223], v227 offset:20480
    v_add_f32 v80, v80, v241
    v_exp_f32 v79, v79
    v_permlane16_swap_b32 v17, v19
    v_mov_b32_dpp v4, v16 row_ror:8 row_mask:0xf bank_mask:0xf
    s_nop 0
    v_mov_b32_dpp v5, v17 row_ror:8 row_mask:0xf bank_mask:0xf
    v_mov_b32_dpp v6, v18 row_ror:8 row_mask:0xf bank_mask:0xf
    v_mov_b32_dpp v7, v19 row_ror:8 row_mask:0xf bank_mask:0xf
    s_waitcnt lgkmcnt(3)
    v_mfma_f32_16x16x32_bf16 v[100:103], v[208:211], v[160:163], v[240:243]
    v_add_f32 v254, v254, v77
    v_cvt_pk_bf16_f32 v74, v76, v77
    v_add_f32 v81, v81, v242
    v_cndmask_b32 v16, v4, v0, s[96:97]
    v_cndmask_b32 v17, v5, v1, s[96:97]
    v_cndmask_b32 v18, v6, v2, s[96:97]
    v_cndmask_b32 v19, v7, v3, s[96:97]
    v_cndmask_b32 v0, v0, v4, s[96:97]
    v_cndmask_b32 v1, v1, v5, s[96:97]
    v_mfma_f32_16x16x32_bf16 v[108:111], v[208:211], v[176:179], v[244:247]
    ds_read_b128 v[192:195], v224 offset:24576
    v_exp_f32 v80, v80
    v_add_f32 v255, v255, v78
    v_cndmask_b32 v2, v2, v6, s[96:97]
    v_cndmask_b32 v3, v3, v7, s[96:97]
    buffer_store_dwordx4 v[0:3], v237, s[24:27], s33 offen offset:0 sc1
    buffer_store_dwordx4 v[16:19], v239, s[24:27], s33 offen offset:2048 sc1
    v_mul_f32 v8, v8, v251
    v_mul_f32 v9, v9, v251
    s_waitcnt lgkmcnt(3)
    v_mfma_f32_16x16x32_bf16 v[100:103], v[212:215], v[164:167], v[100:103]
    v_add_f32 v82, v82, v243
    v_exp_f32 v81, v81
    v_add_f32 v255, v255, v79
    v_mul_f32 v10, v10, v251
    v_mul_f32 v11, v11, v251
    v_mul_f32 v12, v12, v251
    v_mul_f32 v13, v13, v251
    v_mul_f32 v14, v14, v251
    v_mfma_f32_16x16x32_bf16 v[108:111], v[212:215], v[180:183], v[108:111]
    ds_read_b128 v[196:199], v225 offset:24576
    v_cvt_pk_bf16_f32 v75, v78, v79
    v_add_f32 v83, v83, v240
    v_exp_f32 v82, v82
    v_mul_f32 v15, v15, v251
    v_cvt_pk_bf16_f32 v8, v8, v9
    v_cvt_pk_bf16_f32 v9, v10, v11
    v_cvt_pk_bf16_f32 v10, v12, v13
    v_cvt_pk_bf16_f32 v11, v14, v15
    s_nop 0
    v_permlane16_swap_b32 v8, v10
    s_waitcnt lgkmcnt(3)
    v_mfma_f32_16x16x32_bf16 v[100:103], v[216:219], v[168:171], v[100:103]
    v_add_f32 v252, v252, v80
    v_add_f32 v84, v84, v241
    v_permlane16_swap_b32 v9, v11
    v_mul_f32 v24, v24, v251
    v_mul_f32 v25, v25, v251
    v_mul_f32 v26, v26, v251
    v_mul_f32 v27, v27, v251
    v_mfma_f32_16x16x32_bf16 v[108:111], v[216:219], v[184:187], v[108:111]
    ds_read_b128 v[200:203], v226 offset:24576
    v_exp_f32 v83, v83
    v_add_f32 v252, v252, v81
    v_cvt_pk_bf16_f32 v80, v80, v81
    v_mul_f32 v28, v28, v251
    v_mul_f32 v29, v29, v251
    v_mul_f32 v30, v30, v251
    v_mul_f32 v31, v31, v251
    v_cvt_pk_bf16_f32 v24, v24, v25
    v_cvt_pk_bf16_f32 v25, v26, v27
    s_waitcnt lgkmcnt(3)
    v_mfma_f32_16x16x32_bf16 v[100:103], v[220:223], v[172:175], v[100:103]
    v_add_f32 v85, v85, v242
    v_exp_f32 v84, v84
    v_cvt_pk_bf16_f32 v26, v28, v29
    v_cvt_pk_bf16_f32 v27, v30, v31
    s_nop 0
    v_permlane16_swap_b32 v24, v26
    v_permlane16_swap_b32 v25, v27
    s_nop 0
    v_mov_b32_dpp v12, v24 row_ror:8 row_mask:0xf bank_mask:0xf
    v_mov_b32_dpp v13, v25 row_ror:8 row_mask:0xf bank_mask:0xf
    v_mfma_f32_16x16x32_bf16 v[108:111], v[220:223], v[188:191], v[108:111]
    ds_read_b128 v[204:207], v227 offset:24576
    v_add_f32 v253, v253, v82
    v_add_f32 v86, v86, v243
    v_exp_f32 v85, v85
    v_mov_b32_dpp v14, v26 row_ror:8 row_mask:0xf bank_mask:0xf
    v_mov_b32_dpp v15, v27 row_ror:8 row_mask:0xf bank_mask:0xf
    v_cndmask_b32 v24, v12, v8, s[96:97]
    v_cndmask_b32 v25, v13, v9, s[96:97]
    v_cndmask_b32 v26, v14, v10, s[96:97]
    s_waitcnt lgkmcnt(3)
    v_mfma_f32_16x16x32_bf16 v[112:115], v[192:195], v[160:163], v[240:243]
    v_add_f32 v253, v253, v83
    v_cvt_pk_bf16_f32 v81, v82, v83
    v_cndmask_b32 v27, v15, v11, s[96:97]
    v_cndmask_b32 v8, v8, v12, s[96:97]
    v_cndmask_b32 v9, v9, v13, s[96:97]
    v_cndmask_b32 v10, v10, v14, s[96:97]
    v_cndmask_b32 v11, v11, v15, s[96:97]
    buffer_store_dwordx4 v[8:11], v237, s[24:27], s93 offen offset:0 sc1
    v_mfma_f32_16x16x32_bf16 v[120:123], v[192:195], v[176:179], v[244:247]
    ds_read_b128 v[208:211], v224 offset:28672
    v_add_f32 v87, v87, v240
    v_exp_f32 v86, v86
    v_add_f32 v252, v252, v84
    buffer_store_dwordx4 v[24:27], v239, s[24:27], s93 offen offset:2048 sc1
    v_mul_f32 v32, v32, v250
    v_mul_f32 v33, v33, v250
    v_mul_f32 v34, v34, v250
    v_mul_f32 v35, v35, v250
    v_mul_f32 v36, v36, v250
    s_waitcnt lgkmcnt(3)
    v_mfma_f32_16x16x32_bf16 v[112:115], v[196:199], v[164:167], v[112:115]
    v_add_f32 v88, v88, v245
    v_exp_f32 v87, v87
    v_mul_f32 v37, v37, v250
    v_mul_f32 v38, v38, v250
    v_mul_f32 v39, v39, v250
    v_cvt_pk_bf16_f32 v32, v32, v33
    v_cvt_pk_bf16_f32 v33, v34, v35
    v_mfma_f32_16x16x32_bf16 v[120:123], v[196:199], v[180:183], v[120:123]
    ds_read_b128 v[212:215], v225 offset:28672
    v_add_f32 v252, v252, v85
    v_cvt_pk_bf16_f32 v82, v84, v85
    v_add_f32 v89, v89, v246
    v_cvt_pk_bf16_f32 v34, v36, v37
    v_cvt_pk_bf16_f32 v35, v38, v39
    s_nop 0
    v_permlane16_swap_b32 v32, v34
    v_permlane16_swap_b32 v33, v35
    v_mul_f32 v48, v48, v250
    v_mul_f32 v49, v49, v250
    s_waitcnt lgkmcnt(3)
    v_mfma_f32_16x16x32_bf16 v[112:115], v[200:203], v[168:171], v[112:115]
    v_exp_f32 v88, v88
    v_add_f32 v253, v253, v86
    v_mul_f32 v50, v50, v250
    v_mul_f32 v51, v51, v250
    v_mul_f32 v52, v52, v250
    v_mul_f32 v53, v53, v250
    v_mul_f32 v54, v54, v250
    v_mul_f32 v55, v55, v250
    v_mfma_f32_16x16x32_bf16 v[120:123], v[200:203], v[184:187], v[120:123]
    ds_read_b128 v[216:219], v226 offset:28672
    v_add_f32 v90, v90, v247
    v_exp_f32 v89, v89
    v_add_f32 v253, v253, v87
    v_cvt_pk_bf16_f32 v48, v48, v49
    v_cvt_pk_bf16_f32 v49, v50, v51
    v_cvt_pk_bf16_f32 v50, v52, v53
    v_cvt_pk_bf16_f32 v51, v54, v55
    s_nop 0
    v_permlane16_swap_b32 v48, v50
    s_waitcnt lgkmcnt(3)
    v_mfma_f32_16x16x32_bf16 v[112:115], v[204:207], v[172:175], v[112:115]
    v_cvt_pk_bf16_f32 v83, v86, v87
    v_add_f32 v91, v91, v244
    v_exp_f32 v90, v90
    v_permlane16_swap_b32 v49, v51
    v_mov_b32_dpp v36, v48 row_ror:8 row_mask:0xf bank_mask:0xf
    s_nop 0
    v_mov_b32_dpp v37, v49 row_ror:8 row_mask:0xf bank_mask:0xf
    v_mov_b32_dpp v38, v50 row_ror:8 row_mask:0xf bank_mask:0xf
    v_mov_b32_dpp v39, v51 row_ror:8 row_mask:0xf bank_mask:0xf
    v_cndmask_b32 v48, v36, v32, s[96:97]
    v_mfma_f32_16x16x32_bf16 v[120:123], v[204:207], v[188:191], v[120:123]
    ds_read_b128 v[220:223], v227 offset:28672
    v_add_f32 v254, v254, v88
    v_add_f32 v92, v92, v245
    v_cndmask_b32 v49, v37, v33, s[96:97]
    v_cndmask_b32 v50, v38, v34, s[96:97]
    v_cndmask_b32 v51, v39, v35, s[96:97]
    v_cndmask_b32 v32, v32, v36, s[96:97]
    v_cndmask_b32 v33, v33, v37, s[96:97]
    s_waitcnt lgkmcnt(3)
    v_mfma_f32_16x16x32_bf16 v[116:119], v[208:211], v[160:163], v[240:243]
    v_exp_f32 v91, v91
    v_add_f32 v254, v254, v89
    v_cvt_pk_bf16_f32 v88, v88, v89
    v_cndmask_b32 v34, v34, v38, s[96:97]
    v_cndmask_b32 v35, v35, v39, s[96:97]
    buffer_store_dwordx4 v[32:35], v237, s[24:27], s33 offen offset:128 sc1
    buffer_store_dwordx4 v[48:51], v239, s[24:27], s33 offen offset:2176 sc1
    v_mul_f32 v40, v40, v251
    v_mul_f32 v41, v41, v251
    v_mfma_f32_16x16x32_bf16 v[124:127], v[208:211], v[176:179], v[244:247]
    s_waitcnt vmcnt(6)
    s_barrier
    s_add_u32 m0, s80, 0
    s_add_u32 s38, s83, 0
    buffer_load_dwordx4 v238, s[20:23], s38 offen nt lds
    s_add_u32 m0, s80, 8192
    s_add_u32 s38, s83, 8192
    buffer_load_dwordx4 v238, s[20:23], s38 offen nt lds
    s_add_u32 m0, s80, 16384
    s_add_u32 s38, s83, 16384
    buffer_load_dwordx4 v238, s[20:23], s38 offen nt lds
    s_add_u32 m0, s80, 24576
    s_add_u32 s38, s83, 24576
    buffer_load_dwordx4 v238, s[20:23], s38 offen nt lds
    v_add_u32 v228, s85, v228
    ds_read_b64_tr_b16 v[192:193], v228 offset:0
    ds_read_b64_tr_b16 v[194:195], v228 offset:4096
    v_add_f32 v93, v93, v246
    v_exp_f32 v92, v92
    v_mul_f32 v42, v42, v251
    v_mul_f32 v43, v43, v251
    v_mul_f32 v44, v44, v251
    v_mul_f32 v45, v45, v251
    v_mul_f32 v46, v46, v251
    v_mul_f32 v47, v47, v251
    s_waitcnt lgkmcnt(4)
    v_mfma_f32_16x16x32_bf16 v[116:119], v[212:215], v[164:167], v[116:119]
    v_add_f32 v255, v255, v90
    v_add_f32 v94, v94, v247
    v_exp_f32 v93, v93
    v_cvt_pk_bf16_f32 v40, v40, v41
    v_cvt_pk_bf16_f32 v41, v42, v43
    v_cvt_pk_bf16_f32 v42, v44, v45
    v_cvt_pk_bf16_f32 v43, v46, v47
    s_nop 0
    v_permlane16_swap_b32 v40, v42
    v_mfma_f32_16x16x32_bf16 v[124:127], v[212:215], v[180:183], v[124:127]
    v_add_u32 v229, s85, v229
    ds_read_b64_tr_b16 v[196:197], v229 offset:0
    ds_read_b64_tr_b16 v[198:199], v229 offset:4096
    v_add_f32 v255, v255, v91
    v_cvt_pk_bf16_f32 v89, v90, v91
    v_permlane16_swap_b32 v41, v43
    v_mul_f32 v56, v56, v251
    v_mul_f32 v57, v57, v251
    v_mul_f32 v58, v58, v251
    v_mul_f32 v59, v59, v251
    v_mul_f32 v60, v60, v251
    s_waitcnt lgkmcnt(5)
    v_mfma_f32_16x16x32_bf16 v[116:119], v[216:219], v[168:171], v[116:119]
    v_add_f32 v95, v95, v244
    v_exp_f32 v94, v94
    v_add_f32 v254, v254, v92
    v_mul_f32 v61, v61, v251
    v_mul_f32 v62, v62, v251
    v_mul_f32 v63, v63, v251
    v_cvt_pk_bf16_f32 v56, v56, v57
    v_cvt_pk_bf16_f32 v57, v58, v59
    v_cvt_pk_bf16_f32 v58, v60, v61
    v_mfma_f32_16x16x32_bf16 v[124:127], v[216:219], v[184:187], v[124:127]
    v_add_u32 v230, s85, v230
    ds_read_b64_tr_b16 v[200:201], v230 offset:0
    ds_read_b64_tr_b16 v[202:203], v230 offset:4096
    v_exp_f32 v95, v95
    v_add_f32 v254, v254, v93
    v_cvt_pk_bf16_f32 v59, v62, v63
    v_permlane16_swap_b32 v56, v58
    s_nop 0
    v_permlane16_swap_b32 v57, v59
    v_mov_b32_dpp v44, v56 row_ror:8 row_mask:0xf bank_mask:0xf
    s_nop 0
    v_mov_b32_dpp v45, v57 row_ror:8 row_mask:0xf bank_mask:0xf
    s_waitcnt lgkmcnt(6)
    v_mfma_f32_16x16x32_bf16 v[116:119], v[220:223], v[172:175], v[116:119]
    v_cvt_pk_bf16_f32 v90, v92, v93
    v_add_f32 v255, v255, v94
    v_add_f32 v255, v255, v95
    v_mov_b32_dpp v46, v58 row_ror:8 row_mask:0xf bank_mask:0xf
    v_mov_b32_dpp v47, v59 row_ror:8 row_mask:0xf bank_mask:0xf
    v_cndmask_b32 v56, v44, v40, s[96:97]
    v_cndmask_b32 v57, v45, v41, s[96:97]
    v_cndmask_b32 v58, v46, v42, s[96:97]
    v_cndmask_b32 v59, v47, v43, s[96:97]
    v_mfma_f32_16x16x32_bf16 v[124:127], v[220:223], v[188:191], v[124:127]
    v_add_u32 v231, s85, v231
    ds_read_b64_tr_b16 v[204:205], v231 offset:0
    ds_read_b64_tr_b16 v[206:207], v231 offset:4096
    v_cvt_pk_bf16_f32 v91, v94, v95
    v_add_f32 v252, v252, v253
    v_add_f32 v254, v254, v255
    v_cndmask_b32 v40, v40, v44, s[96:97]
    v_cndmask_b32 v41, v41, v45, s[96:97]
    v_cndmask_b32 v42, v42, v46, s[96:97]
    v_cndmask_b32 v43, v43, v47, s[96:97]
    buffer_store_dwordx4 v[40:43], v237, s[24:27], s93 offen offset:128 sc1
    buffer_store_dwordx4 v[56:59], v239, s[24:27], s93 offen offset:2176 sc1
    v_mov_b32 v248, v252
    v_mov_b32 v249, v254
    s_waitcnt lgkmcnt(6)
    v_mfma_f32_16x16x32_bf16 v[0:3], v[192:195], v[64:67], 0
    v_exp_f32 v96, v96
    v_mfma_f32_16x16x32_bf16 v[8:11], v[192:195], v[72:75], 0
    v_add_u32 v232, s85, v232
    ds_read_b64_tr_b16 v[208:209], v232 offset:0
    ds_read_b64_tr_b16 v[210:211], v232 offset:4096
    v_exp_f32 v97, v97
    s_waitcnt lgkmcnt(6)
    v_mfma_f32_16x16x32_bf16 v[4:7], v[196:199], v[64:67], 0
    v_exp_f32 v98, v98
    v_mfma_f32_16x16x32_bf16 v[12:15], v[196:199], v[72:75], 0
    v_add_u32 v233, s85, v233
    ds_read_b64_tr_b16 v[212:213], v233 offset:0
    ds_read_b64_tr_b16 v[214:215], v233 offset:4096
    v_exp_f32 v99, v99
    s_waitcnt lgkmcnt(6)
    v_mfma_f32_16x16x32_bf16 v[16:19], v[200:203], v[64:67], 0
    v_add_f32 v252, v96, v97
    v_cvt_pk_bf16_f32 v96, v96, v97
    v_mfma_f32_16x16x32_bf16 v[24:27], v[200:203], v[72:75], 0
    v_add_u32 v234, s85, v234
    ds_read_b64_tr_b16 v[216:217], v234 offset:0
    ds_read_b64_tr_b16 v[218:219], v234 offset:4096
    v_exp_f32 v100, v100
    s_waitcnt lgkmcnt(6)
    v_mfma_f32_16x16x32_bf16 v[20:23], v[204:207], v[64:67], 0
    v_exp_f32 v101, v101
    v_mfma_f32_16x16x32_bf16 v[28:31], v[204:207], v[72:75], 0
    v_add_u32 v235, s85, v235
    ds_read_b64_tr_b16 v[220:221], v235 offset:0
    ds_read_b64_tr_b16 v[222:223], v235 offset:4096
    v_add_f32 v253, v98, v99
    s_waitcnt lgkmcnt(6)
    v_mfma_f32_16x16x32_bf16 v[32:35], v[208:211], v[64:67], 0
    v_cvt_pk_bf16_f32 v97, v98, v99
    v_mfma_f32_16x16x32_bf16 v[40:43], v[208:211], v[72:75], 0
    ds_read_b64_tr_b16 v[192:193], v228 offset:8192
    ds_read_b64_tr_b16 v[194:195], v228 offset:12288
    v_exp_f32 v102, v102
    v_add_f32 v252, v252, v100
    s_waitcnt lgkmcnt(6)
    v_mfma_f32_16x16x32_bf16 v[36:39], v[212:215], v[64:67], 0
    v_exp_f32 v103, v103
    v_mfma_f32_16x16x32_bf16 v[44:47], v[212:215], v[72:75], 0
    ds_read_b64_tr_b16 v[196:197], v229 offset:8192
    ds_read_b64_tr_b16 v[198:199], v229 offset:12288
    v_add_f32 v252, v252, v101
    s_waitcnt lgkmcnt(6)
    v_mfma_f32_16x16x32_bf16 v[48:51], v[216:219], v[64:67], 0
    v_cvt_pk_bf16_f32 v98, v100, v101
    v_mfma_f32_16x16x32_bf16 v[56:59], v[216:219], v[72:75], 0
    ds_read_b64_tr_b16 v[200:201], v230 offset:8192
    ds_read_b64_tr_b16 v[202:203], v230 offset:12288
    v_exp_f32 v104, v104
    v_add_f32 v253, v253, v102
    s_waitcnt lgkmcnt(6)
    v_mfma_f32_16x16x32_bf16 v[52:55], v[220:223], v[64:67], 0
    v_exp_f32 v105, v105
    v_mfma_f32_16x16x32_bf16 v[60:63], v[220:223], v[72:75], 0
    ds_read_b64_tr_b16 v[204:205], v231 offset:8192
    ds_read_b64_tr_b16 v[206:207], v231 offset:12288
    v_add_f32 v253, v253, v103
    s_waitcnt lgkmcnt(6)
    v_mfma_f32_16x16x32_bf16 v[0:3], v[192:195], v[80:83], v[0:3]
    v_cvt_pk_bf16_f32 v99, v102, v103
    v_mfma_f32_16x16x32_bf16 v[8:11], v[192:195], v[88:91], v[8:11]
    ds_read_b64_tr_b16 v[208:209], v232 offset:8192
    ds_read_b64_tr_b16 v[210:211], v232 offset:12288
    v_exp_f32 v106, v106
    s_waitcnt lgkmcnt(6)
    v_mfma_f32_16x16x32_bf16 v[4:7], v[196:199], v[80:83], v[4:7]
    v_exp_f32 v107, v107
    v_add_f32 v254, v104, v105
    v_mfma_f32_16x16x32_bf16 v[12:15], v[196:199], v[88:91], v[12:15]
    ds_read_b64_tr_b16 v[212:213], v233 offset:8192
    ds_read_b64_tr_b16 v[214:215], v233 offset:12288
    v_cvt_pk_bf16_f32 v104, v104, v105
    s_waitcnt lgkmcnt(6)
    v_mfma_f32_16x16x32_bf16 v[16:19], v[200:203], v[80:83], v[16:19]
    v_exp_f32 v108, v108
    v_mfma_f32_16x16x32_bf16 v[24:27], v[200:203], v[88:91], v[24:27]
    ds_read_b64_tr_b16 v[216:217], v234 offset:8192
    ds_read_b64_tr_b16 v[218:219], v234 offset:12288
    v_exp_f32 v109, v109
    s_waitcnt lgkmcnt(6)
    v_mfma_f32_16x16x32_bf16 v[20:23], v[204:207], v[80:83], v[20:23]
    v_add_f32 v255, v106, v107
    v_cvt_pk_bf16_f32 v105, v106, v107
    v_mfma_f32_16x16x32_bf16 v[28:31], v[204:207], v[88:91], v[28:31]
    ds_read_b64_tr_b16 v[220:221], v235 offset:8192
    ds_read_b64_tr_b16 v[222:223], v235 offset:12288
    v_exp_f32 v110, v110
    s_waitcnt lgkmcnt(6)
    v_mfma_f32_16x16x32_bf16 v[32:35], v[208:211], v[80:83], v[32:35]
    v_add_f32 v254, v254, v108
    v_mfma_f32_16x16x32_bf16 v[40:43], v[208:211], v[88:91], v[40:43]
    v_add_u32 v224, s45, v224
    ds_read_b128 v[192:195], v224 offset:0
    v_exp_f32 v111, v111
    s_waitcnt lgkmcnt(5)
    v_mfma_f32_16x16x32_bf16 v[36:39], v[212:215], v[80:83], v[36:39]
    v_add_f32 v254, v254, v109
    v_mfma_f32_16x16x32_bf16 v[44:47], v[212:215], v[88:91], v[44:47]
    v_add_u32 v225, s45, v225
    ds_read_b128 v[196:199], v225 offset:0
    v_cvt_pk_bf16_f32 v106, v108, v109
    v_exp_f32 v112, v112
    s_waitcnt lgkmcnt(4)
    v_mfma_f32_16x16x32_bf16 v[48:51], v[216:219], v[80:83], v[48:51]
    v_add_f32 v255, v255, v110
    v_mfma_f32_16x16x32_bf16 v[56:59], v[216:219], v[88:91], v[56:59]
    v_add_u32 v226, s45, v226
    ds_read_b128 v[200:203], v226 offset:0
    v_exp_f32 v113, v113
    s_waitcnt lgkmcnt(3)
    v_mfma_f32_16x16x32_bf16 v[52:55], v[220:223], v[80:83], v[52:55]
    v_add_f32 v255, v255, v111
    v_mfma_f32_16x16x32_bf16 v[60:63], v[220:223], v[88:91], v[60:63]
    v_add_u32 v227, s45, v227
    ds_read_b128 v[204:207], v227 offset:0
    v_cvt_pk_bf16_f32 v107, v110, v111
    v_exp_f32 v114, v114
    s_waitcnt lgkmcnt(3)
    v_mfma_f32_16x16x32_bf16 v[64:67], v[192:195], v[160:163], v[240:243]
    v_add_f32 v252, v252, v112
    v_mfma_f32_16x16x32_bf16 v[72:75], v[192:195], v[176:179], v[244:247]
    ds_read_b128 v[208:211], v224 offset:4096
    v_exp_f32 v115, v115
    s_waitcnt lgkmcnt(3)
    v_mfma_f32_16x16x32_bf16 v[64:67], v[196:199], v[164:167], v[64:67]
    v_add_f32 v252, v252, v113
    v_mfma_f32_16x16x32_bf16 v[72:75], v[196:199], v[180:183], v[72:75]
    ds_read_b128 v[212:215], v225 offset:4096
    v_cvt_pk_bf16_f32 v112, v112, v113
    s_waitcnt lgkmcnt(3)
    v_mfma_f32_16x16x32_bf16 v[64:67], v[200:203], v[168:171], v[64:67]
    v_exp_f32 v116, v116
    v_add_f32 v253, v253, v114
    v_mfma_f32_16x16x32_bf16 v[72:75], v[200:203], v[184:187], v[72:75]
    ds_read_b128 v[216:219], v226 offset:4096
    v_exp_f32 v117, v117
    s_waitcnt lgkmcnt(3)
    v_mfma_f32_16x16x32_bf16 v[64:67], v[204:207], v[172:175], v[64:67]
    v_add_f32 v253, v253, v115
    v_mfma_f32_16x16x32_bf16 v[72:75], v[204:207], v[188:191], v[72:75]
    ds_read_b128 v[220:223], v227 offset:4096
    v_cvt_pk_bf16_f32 v113, v114, v115
    s_waitcnt lgkmcnt(3)
    v_mfma_f32_16x16x32_bf16 v[68:71], v[208:211], v[160:163], v[240:243]
    v_exp_f32 v118, v118
    v_mfma_f32_16x16x32_bf16 v[76:79], v[208:211], v[176:179], v[244:247]
    ds_read_b128 v[192:195], v224 offset:8192
    v_add_f32 v252, v252, v116
    v_exp_f32 v119, v119
    s_waitcnt lgkmcnt(3)
    v_mfma_f32_16x16x32_bf16 v[68:71], v[212:215], v[164:167], v[68:71]
    v_add_f32 v252, v252, v117
    v_mfma_f32_16x16x32_bf16 v[76:79], v[212:215], v[180:183], v[76:79]
    ds_read_b128 v[196:199], v225 offset:8192
    v_cvt_pk_bf16_f32 v114, v116, v117
    s_waitcnt lgkmcnt(3)
    v_mfma_f32_16x16x32_bf16 v[68:71], v[216:219], v[168:171], v[68:71]
    v_exp_f32 v120, v120
    v_mfma_f32_16x16x32_bf16 v[76:79], v[216:219], v[184:187], v[76:79]
    ds_read_b128 v[200:203], v226 offset:8192
    v_add_f32 v253, v253, v118
    v_exp_f32 v121, v121
    s_waitcnt lgkmcnt(3)
    v_mfma_f32_16x16x32_bf16 v[68:71], v[220:223], v[172:175], v[68:71]
    v_add_f32 v253, v253, v119
    v_mfma_f32_16x16x32_bf16 v[76:79], v[220:223], v[188:191], v[76:79]
    ds_read_b128 v[204:207], v227 offset:8192
    v_cvt_pk_bf16_f32 v115, v118, v119
    s_waitcnt lgkmcnt(3)
    v_mfma_f32_16x16x32_bf16 v[80:83], v[192:195], v[160:163], v[240:243]
    v_exp_f32 v122, v122
    v_mfma_f32_16x16x32_bf16 v[88:91], v[192:195], v[176:179], v[244:247]
    ds_read_b128 v[208:211], v224 offset:12288
    v_add_f32 v254, v254, v120
    s_waitcnt lgkmcnt(3)
    v_mfma_f32_16x16x32_bf16 v[80:83], v[196:199], v[164:167], v[80:83]
    v_exp_f32 v123, v123
    v_add_f32 v254, v254, v121
    v_mfma_f32_16x16x32_bf16 v[88:91], v[196:199], v[180:183], v[88:91]
    ds_read_b128 v[212:215], v225 offset:12288
    v_cvt_pk_bf16_f32 v120, v120, v121
    s_waitcnt lgkmcnt(3)
    v_mfma_f32_16x16x32_bf16 v[80:83], v[200:203], v[168:171], v[80:83]
    v_exp_f32 v124, v124
    v_mfma_f32_16x16x32_bf16 v[88:91], v[200:203], v[184:187], v[88:91]
    ds_read_b128 v[216:219], v226 offset:12288
    v_add_f32 v255, v255, v122
    s_waitcnt lgkmcnt(3)
    v_mfma_f32_16x16x32_bf16 v[80:83], v[204:207], v[172:175], v[80:83]
    v_exp_f32 v125, v125
    v_add_f32 v255, v255, v123
    v_mfma_f32_16x16x32_bf16 v[88:91], v[204:207], v[188:191], v[88:91]
    ds_read_b128 v[220:223], v227 offset:12288
    v_cvt_pk_bf16_f32 v121, v122, v123
    s_waitcnt lgkmcnt(3)
    v_mfma_f32_16x16x32_bf16 v[84:87], v[208:211], v[160:163], v[240:243]
    v_exp_f32 v126, v126
    v_mfma_f32_16x16x32_bf16 v[92:95], v[208:211], v[176:179], v[244:247]
    ds_read_b64_tr_b16 v[192:193], v228 offset:16384
    ds_read_b64_tr_b16 v[194:195], v228 offset:20480
    v_add_f32 v254, v254, v124
    s_waitcnt lgkmcnt(4)
    v_mfma_f32_16x16x32_bf16 v[84:87], v[212:215], v[164:167], v[84:87]
    v_exp_f32 v127, v127
    v_mfma_f32_16x16x32_bf16 v[92:95], v[212:215], v[180:183], v[92:95]
    ds_read_b64_tr_b16 v[196:197], v229 offset:16384
    ds_read_b64_tr_b16 v[198:199], v229 offset:20480
    v_add_f32 v254, v254, v125
    v_cvt_pk_bf16_f32 v122, v124, v125
    s_waitcnt lgkmcnt(5)
    v_mfma_f32_16x16x32_bf16 v[84:87], v[216:219], v[168:171], v[84:87]
    v_add_f32 v255, v255, v126
    v_mfma_f32_16x16x32_bf16 v[92:95], v[216:219], v[184:187], v[92:95]
    ds_read_b64_tr_b16 v[200:201], v230 offset:16384
    ds_read_b64_tr_b16 v[202:203], v230 offset:20480
    v_add_f32 v255, v255, v127
    s_waitcnt lgkmcnt(6)
    v_mfma_f32_16x16x32_bf16 v[84:87], v[220:223], v[172:175], v[84:87]
    v_cvt_pk_bf16_f32 v123, v126, v127
    v_mfma_f32_16x16x32_bf16 v[92:95], v[220:223], v[188:191], v[92:95]
    ds_read_b64_tr_b16 v[204:205], v231 offset:16384
    ds_read_b64_tr_b16 v[206:207], v231 offset:20480
    v_add_f32 v252, v252, v253
    v_add_f32 v254, v254, v255
    v_max_f32 v239, v252, v254
    v_cmp_lt_f32 vcc, 0x46800000, v239
    s_cbranch_vccnz L_slow_1_1
L_back_1_1:
    v_add_f32 v248, v248, v252
    v_add_f32 v249, v249, v254
    buffer_load_dwordx4 v[128:131], v236, s[12:15], s35 offen offset:0 nt
    buffer_load_dwordx4 v[132:135], v236, s[12:15], s35 offen offset:64 nt
    buffer_load_dwordx4 v[136:139], v236, s[12:15], s35 offen offset:128 nt
    buffer_load_dwordx4 v[140:143], v236, s[12:15], s35 offen offset:192 nt
    s_waitcnt lgkmcnt(6)
    v_mfma_f32_16x16x32_bf16 v[0:3], v[192:195], v[96:99], v[0:3]
    v_exp_f32 v64, v64
    v_mfma_f32_16x16x32_bf16 v[8:11], v[192:195], v[104:107], v[8:11]
    ds_read_b64_tr_b16 v[208:209], v232 offset:16384
    ds_read_b64_tr_b16 v[210:211], v232 offset:20480
    v_exp_f32 v65, v65
    s_waitcnt lgkmcnt(6)
    v_mfma_f32_16x16x32_bf16 v[4:7], v[196:199], v[96:99], v[4:7]
    v_exp_f32 v66, v66
    v_mfma_f32_16x16x32_bf16 v[12:15], v[196:199], v[104:107], v[12:15]
    ds_read_b64_tr_b16 v[212:213], v233 offset:16384
    ds_read_b64_tr_b16 v[214:215], v233 offset:20480
    v_exp_f32 v67, v67
    s_waitcnt lgkmcnt(6)
    v_mfma_f32_16x16x32_bf16 v[16:19], v[200:203], v[96:99], v[16:19]
    v_add_f32 v252, v64, v65
    v_cvt_pk_bf16_f32 v64, v64, v65
    v_mfma_f32_16x16x32_bf16 v[24:27], v[200:203], v[104:107], v[24:27]
    ds_read_b64_tr_b16 v[216:217], v234 offset:16384
    ds_read_b64_tr_b16 v[218:219], v234 offset:20480
    v_exp_f32 v68, v68
    s_waitcnt lgkmcnt(6)
    v_mfma_f32_16x16x32_bf16 v[20:23], v[204:207], v[96:99], v[20:23]
    v_exp_f32 v69, v69
    v_mfma_f32_16x16x32_bf16 v[28:31], v[204:207], v[104:107], v[28:31]
    ds_read_b64_tr_b16 v[220:221], v235 offset:16384
    ds_read_b64_tr_b16 v[222:223], v235 offset:20480
    v_add_f32 v253, v66, v67
    s_waitcnt lgkmcnt(6)
    v_mfma_f32_16x16x32_bf16 v[32:35], v[208:211], v[96:99], v[32:35]
    v_cvt_pk_bf16_f32 v65, v66, v67
    v_mfma_f32_16x16x32_bf16 v[40:43], v[208:211], v[104:107], v[40:43]
    ds_read_b64_tr_b16 v[192:193], v228 offset:24576
    ds_read_b64_tr_b16 v[194:195], v228 offset:28672
    v_exp_f32 v70, v70
    v_add_f32 v252, v252, v68
    s_waitcnt lgkmcnt(6)
    v_mfma_f32_16x16x32_bf16 v[36:39], v[212:215], v[96:99], v[36:39]
    v_exp_f32 v71, v71
    v_mfma_f32_16x16x32_bf16 v[44:47], v[212:215], v[104:107], v[44:47]
    ds_read_b64_tr_b16 v[196:197], v229 offset:24576
    ds_read_b64_tr_b16 v[198:199], v229 offset:28672
    v_add_f32 v252, v252, v69
    s_waitcnt lgkmcnt(6)
    v_mfma_f32_16x16x32_bf16 v[48:51], v[216:219], v[96:99], v[48:51]
    v_cvt_pk_bf16_f32 v66, v68, v69
    v_mfma_f32_16x16x32_bf16 v[56:59], v[216:219], v[104:107], v[56:59]
    ds_read_b64_tr_b16 v[200:201], v230 offset:24576
    ds_read_b64_tr_b16 v[202:203], v230 offset:28672
    v_exp_f32 v72, v72
    v_add_f32 v253, v253, v70
    s_waitcnt lgkmcnt(6)
    v_mfma_f32_16x16x32_bf16 v[52:55], v[220:223], v[96:99], v[52:55]
    v_exp_f32 v73, v73
    v_mfma_f32_16x16x32_bf16 v[60:63], v[220:223], v[104:107], v[60:63]
    ds_read_b64_tr_b16 v[204:205], v231 offset:24576
    ds_read_b64_tr_b16 v[206:207], v231 offset:28672
    v_add_f32 v253, v253, v71
    s_waitcnt lgkmcnt(6)
    v_mfma_f32_16x16x32_bf16 v[0:3], v[192:195], v[112:115], v[0:3]
    v_cvt_pk_bf16_f32 v67, v70, v71
    v_mfma_f32_16x16x32_bf16 v[8:11], v[192:195], v[120:123], v[8:11]
    ds_read_b64_tr_b16 v[208:209], v232 offset:24576
    ds_read_b64_tr_b16 v[210:211], v232 offset:28672
    v_exp_f32 v74, v74
    s_waitcnt lgkmcnt(6)
    v_mfma_f32_16x16x32_bf16 v[4:7], v[196:199], v[112:115], v[4:7]
    v_exp_f32 v75, v75
    v_add_f32 v254, v72, v73
    v_mfma_f32_16x16x32_bf16 v[12:15], v[196:199], v[120:123], v[12:15]
    ds_read_b64_tr_b16 v[212:213], v233 offset:24576
    ds_read_b64_tr_b16 v[214:215], v233 offset:28672
    v_cvt_pk_bf16_f32 v72, v72, v73
    s_waitcnt lgkmcnt(6)
    v_mfma_f32_16x16x32_bf16 v[16:19], v[200:203], v[112:115], v[16:19]
    v_exp_f32 v76, v76
    v_mfma_f32_16x16x32_bf16 v[24:27], v[200:203], v[120:123], v[24:27]
    ds_read_b64_tr_b16 v[216:217], v234 offset:24576
    ds_read_b64_tr_b16 v[218:219], v234 offset:28672
    v_exp_f32 v77, v77
    s_waitcnt lgkmcnt(6)
    v_mfma_f32_16x16x32_bf16 v[20:23], v[204:207], v[112:115], v[20:23]
    v_add_f32 v255, v74, v75
    v_cvt_pk_bf16_f32 v73, v74, v75
    v_mfma_f32_16x16x32_bf16 v[28:31], v[204:207], v[120:123], v[28:31]
    ds_read_b64_tr_b16 v[220:221], v235 offset:24576
    ds_read_b64_tr_b16 v[222:223], v235 offset:28672
    v_exp_f32 v78, v78
    s_waitcnt lgkmcnt(6)
    v_mfma_f32_16x16x32_bf16 v[32:35], v[208:211], v[112:115], v[32:35]
    v_add_f32 v254, v254, v76
    v_mfma_f32_16x16x32_bf16 v[40:43], v[208:211], v[120:123], v[40:43]
    ds_read_b128 v[192:195], v224 offset:16384
    v_exp_f32 v79, v79
    s_waitcnt lgkmcnt(5)
    v_mfma_f32_16x16x32_bf16 v[36:39], v[212:215], v[112:115], v[36:39]
    v_add_f32 v254, v254, v77
    v_mfma_f32_16x16x32_bf16 v[44:47], v[212:215], v[120:123], v[44:47]
    ds_read_b128 v[196:199], v225 offset:16384
    v_cvt_pk_bf16_f32 v74, v76, v77
    v_exp_f32 v80, v80
    s_waitcnt lgkmcnt(4)
    v_mfma_f32_16x16x32_bf16 v[48:51], v[216:219], v[112:115], v[48:51]
    v_add_f32 v255, v255, v78
    v_mfma_f32_16x16x32_bf16 v[56:59], v[216:219], v[120:123], v[56:59]
    ds_read_b128 v[200:203], v226 offset:16384
    v_exp_f32 v81, v81
    s_waitcnt lgkmcnt(3)
    v_mfma_f32_16x16x32_bf16 v[52:55], v[220:223], v[112:115], v[52:55]
    v_add_f32 v255, v255, v79
    v_mfma_f32_16x16x32_bf16 v[60:63], v[220:223], v[120:123], v[60:63]
    ds_read_b128 v[204:207], v227 offset:16384
    v_cvt_pk_bf16_f32 v75, v78, v79
    v_exp_f32 v82, v82
    s_waitcnt lgkmcnt(3)
    v_mfma_f32_16x16x32_bf16 v[96:99], v[192:195], v[160:163], v[240:243]
    v_add_f32 v252, v252, v80
    v_mfma_f32_16x16x32_bf16 v[104:107], v[192:195], v[176:179], v[244:247]
    ds_read_b128 v[208:211], v224 offset:20480
    v_exp_f32 v83, v83
    s_waitcnt lgkmcnt(3)
    v_mfma_f32_16x16x32_bf16 v[96:99], v[196:199], v[164:167], v[96:99]
    v_add_f32 v252, v252, v81
    v_mfma_f32_16x16x32_bf16 v[104:107], v[196:199], v[180:183], v[104:107]
    ds_read_b128 v[212:215], v225 offset:20480
    v_cvt_pk_bf16_f32 v80, v80, v81
    s_waitcnt lgkmcnt(3)
    v_mfma_f32_16x16x32_bf16 v[96:99], v[200:203], v[168:171], v[96:99]
    v_exp_f32 v84, v84
    v_add_f32 v253, v253, v82
    v_mfma_f32_16x16x32_bf16 v[104:107], v[200:203], v[184:187], v[104:107]
    ds_read_b128 v[216:219], v226 offset:20480
    v_exp_f32 v85, v85
    s_waitcnt lgkmcnt(3)
    v_mfma_f32_16x16x32_bf16 v[96:99], v[204:207], v[172:175], v[96:99]
    v_add_f32 v253, v253, v83
    v_mfma_f32_16x16x32_bf16 v[104:107], v[204:207], v[188:191], v[104:107]
    ds_read_b128 v[220:223], v227 offset:20480
    v_cvt_pk_bf16_f32 v81, v82, v83
    s_waitcnt lgkmcnt(3)
    v_mfma_f32_16x16x32_bf16 v[100:103], v[208:211], v[160:163], v[240:243]
    v_exp_f32 v86, v86
    v_mfma_f32_16x16x32_bf16 v[108:111], v[208:211], v[176:179], v[244:247]
    ds_read_b128 v[192:195], v224 offset:24576
    v_add_f32 v252, v252, v84
    v_exp_f32 v87, v87
    s_waitcnt lgkmcnt(3)
    v_mfma_f32_16x16x32_bf16 v[100:103], v[212:215], v[164:167], v[100:103]
    v_add_f32 v252, v252, v85
    v_mfma_f32_16x16x32_bf16 v[108:111], v[212:215], v[180:183], v[108:111]
    ds_read_b128 v[196:199], v225 offset:24576
    v_cvt_pk_bf16_f32 v82, v84, v85
    s_waitcnt lgkmcnt(3)
    v_mfma_f32_16x16x32_bf16 v[100:103], v[216:219], v[168:171], v[100:103]
    v_exp_f32 v88, v88
    v_mfma_f32_16x16x32_bf16 v[108:111], v[216:219], v[184:187], v[108:111]
    ds_read_b128 v[200:203], v226 offset:24576
    v_add_f32 v253, v253, v86
    v_exp_f32 v89, v89
    s_waitcnt lgkmcnt(3)
    v_mfma_f32_16x16x32_bf16 v[100:103], v[220:223], v[172:175], v[100:103]
    v_add_f32 v253, v253, v87
    v_mfma_f32_16x16x32_bf16 v[108:111], v[220:223], v[188:191], v[108:111]
    ds_read_b128 v[204:207], v227 offset:24576
    v_cvt_pk_bf16_f32 v83, v86, v87
    s_waitcnt lgkmcnt(3)
    v_mfma_f32_16x16x32_bf16 v[112:115], v[192:195], v[160:163], v[240:243]
    v_exp_f32 v90, v90
    v_mfma_f32_16x16x32_bf16 v[120:123], v[192:195], v[176:179], v[244:247]
    ds_read_b128 v[208:211], v224 offset:28672
    v_add_f32 v254, v254, v88
    s_waitcnt lgkmcnt(3)
    v_mfma_f32_16x16x32_bf16 v[112:115], v[196:199], v[164:167], v[112:115]
    v_exp_f32 v91, v91
    v_add_f32 v254, v254, v89
    v_mfma_f32_16x16x32_bf16 v[120:123], v[196:199], v[180:183], v[120:123]
    ds_read_b128 v[212:215], v225 offset:28672
    v_cvt_pk_bf16_f32 v88, v88, v89
    s_waitcnt lgkmcnt(3)
    v_mfma_f32_16x16x32_bf16 v[112:115], v[200:203], v[168:171], v[112:115]
    v_exp_f32 v92, v92
    v_mfma_f32_16x16x32_bf16 v[120:123], v[200:203], v[184:187], v[120:123]
    ds_read_b128 v[216:219], v226 offset:28672
    v_add_f32 v255, v255, v90
    s_waitcnt lgkmcnt(3)
    v_mfma_f32_16x16x32_bf16 v[112:115], v[204:207], v[172:175], v[112:115]
    v_exp_f32 v93, v93
    v_add_f32 v255, v255, v91
    v_mfma_f32_16x16x32_bf16 v[120:123], v[204:207], v[188:191], v[120:123]
    ds_read_b128 v[220:223], v227 offset:28672
    v_cvt_pk_bf16_f32 v89, v90, v91
    s_waitcnt lgkmcnt(3)
    v_mfma_f32_16x16x32_bf16 v[116:119], v[208:211], v[160:163], v[240:243]
    v_exp_f32 v94, v94
    v_mfma_f32_16x16x32_bf16 v[124:127], v[208:211], v[176:179], v[244:247]
    s_waitcnt vmcnt(6)
    s_barrier
    s_add_u32 m0, s81, 0
    s_add_u32 s38, s84, 0
    buffer_load_dwordx4 v238, s[20:23], s38 offen nt lds
    s_add_u32 m0, s81, 8192
    s_add_u32 s38, s84, 8192
    buffer_load_dwordx4 v238, s[20:23], s38 offen nt lds
    s_add_u32 m0, s81, 16384
    s_add_u32 s38, s84, 16384
    buffer_load_dwordx4 v238, s[20:23], s38 offen nt lds
    s_add_u32 m0, s81, 24576
    s_add_u32 s38, s84, 24576
    buffer_load_dwordx4 v238, s[20:23], s38 offen nt lds
    v_add_u32 v228, s86, v228
    ds_read_b64_tr_b16 v[192:193], v228 offset:0
    ds_read_b64_tr_b16 v[194:195], v228 offset:4096
    v_add_f32 v254, v254, v92
    s_waitcnt lgkmcnt(4)
    v_mfma_f32_16x16x32_bf16 v[116:119], v[212:215], v[164:167], v[116:119]
    v_exp_f32 v95, v95
    v_mfma_f32_16x16x32_bf16 v[124:127], v[212:215], v[180:183], v[124:127]
    v_add_u32 v229, s86, v229
    ds_read_b64_tr_b16 v[196:197], v229 offset:0
    ds_read_b64_tr_b16 v[198:199], v229 offset:4096
    v_add_f32 v254, v254, v93
    v_cvt_pk_bf16_f32 v90, v92, v93
    s_waitcnt lgkmcnt(5)
    v_mfma_f32_16x16x32_bf16 v[116:119], v[216:219], v[168:171], v[116:119]
    v_add_f32 v255, v255, v94
    v_mfma_f32_16x16x32_bf16 v[124:127], v[216:219], v[184:187], v[124:127]
    v_add_u32 v230, s86, v230
    ds_read_b64_tr_b16 v[200:201], v230 offset:0
    ds_read_b64_tr_b16 v[202:203], v230 offset:4096
    v_add_f32 v255, v255, v95
    s_waitcnt lgkmcnt(6)
    v_mfma_f32_16x16x32_bf16 v[116:119], v[220:223], v[172:175], v[116:119]
    v_cvt_pk_bf16_f32 v91, v94, v95
    v_mfma_f32_16x16x32_bf16 v[124:127], v[220:223], v[188:191], v[124:127]
    v_add_u32 v231, s86, v231
    ds_read_b64_tr_b16 v[204:205], v231 offset:0
    ds_read_b64_tr_b16 v[206:207], v231 offset:4096
    v_add_f32 v252, v252, v253
    v_add_f32 v254, v254, v255
    v_max_f32 v239, v252, v254
    v_cmp_lt_f32 vcc, 0x46800000, v239
    s_cbranch_vccnz L_slow_1_2
L_back_1_2:
    v_add_f32 v248, v248, v252
    v_add_f32 v249, v249, v254
    buffer_load_dwordx4 v[144:147], v236, s[12:15], s95 offen offset:0 nt
    buffer_load_dwordx4 v[148:151], v236, s[12:15], s95 offen offset:64 nt
    buffer_load_dwordx4 v[152:155], v236, s[12:15], s95 offen offset:128 nt
    buffer_load_dwordx4 v[156:159], v236, s[12:15], s95 offen offset:192 nt
    s_waitcnt lgkmcnt(6)
    v_mfma_f32_16x16x32_bf16 v[0:3], v[192:195], v[64:67], v[0:3]
    v_exp_f32 v96, v96
    v_mfma_f32_16x16x32_bf16 v[8:11], v[192:195], v[72:75], v[8:11]
    v_add_u32 v232, s86, v232
    ds_read_b64_tr_b16 v[208:209], v232 offset:0
    ds_read_b64_tr_b16 v[210:211], v232 offset:4096
    v_exp_f32 v97, v97
    s_waitcnt lgkmcnt(6)
    v_mfma_f32_16x16x32_bf16 v[4:7], v[196:199], v[64:67], v[4:7]
    v_exp_f32 v98, v98
    v_mfma_f32_16x16x32_bf16 v[12:15], v[196:199], v[72:75], v[12:15]
    v_add_u32 v233, s86, v233
    ds_read_b64_tr_b16 v[212:213], v233 offset:0
    ds_read_b64_tr_b16 v[214:215], v233 offset:4096
    v_exp_f32 v99, v99
    s_waitcnt lgkmcnt(6)
    v_mfma_f32_16x16x32_bf16 v[16:19], v[200:203], v[64:67], v[16:19]
    v_add_f32 v252, v96, v97
    v_cvt_pk_bf16_f32 v96, v96, v97
    v_mfma_f32_16x16x32_bf16 v[24:27], v[200:203], v[72:75], v[24:27]
    v_add_u32 v234, s86, v234
    ds_read_b64_tr_b16 v[216:217], v234 offset:0
    ds_read_b64_tr_b16 v[218:219], v234 offset:4096
    v_exp_f32 v100, v100
    s_waitcnt lgkmcnt(6)
    v_mfma_f32_16x16x32_bf16 v[20:23], v[204:207], v[64:67], v[20:23]
    v_exp_f32 v101, v101
    v_mfma_f32_16x16x32_bf16 v[28:31], v[204:207], v[72:75], v[28:31]
    v_add_u32 v235, s86, v235
    ds_read_b64_tr_b16 v[220:221], v235 offset:0
    ds_read_b64_tr_b16 v[222:223], v235 offset:4096
    v_add_f32 v253, v98, v99
    s_waitcnt lgkmcnt(6)
    v_mfma_f32_16x16x32_bf16 v[32:35], v[208:211], v[64:67], v[32:35]
    v_cvt_pk_bf16_f32 v97, v98, v99
    v_mfma_f32_16x16x32_bf16 v[40:43], v[208:211], v[72:75], v[40:43]
    ds_read_b64_tr_b16 v[192:193], v228 offset:8192
    ds_read_b64_tr_b16 v[194:195], v228 offset:12288
    v_exp_f32 v102, v102
    v_add_f32 v252, v252, v100
    s_waitcnt lgkmcnt(6)
    v_mfma_f32_16x16x32_bf16 v[36:39], v[212:215], v[64:67], v[36:39]
    v_exp_f32 v103, v103
    v_mfma_f32_16x16x32_bf16 v[44:47], v[212:215], v[72:75], v[44:47]
    ds_read_b64_tr_b16 v[196:197], v229 offset:8192
    ds_read_b64_tr_b16 v[198:199], v229 offset:12288
    v_add_f32 v252, v252, v101
    s_waitcnt lgkmcnt(6)
    v_mfma_f32_16x16x32_bf16 v[48:51], v[216:219], v[64:67], v[48:51]
    v_cvt_pk_bf16_f32 v98, v100, v101
    v_mfma_f32_16x16x32_bf16 v[56:59], v[216:219], v[72:75], v[56:59]
    ds_read_b64_tr_b16 v[200:201], v230 offset:8192
    ds_read_b64_tr_b16 v[202:203], v230 offset:12288
    v_exp_f32 v104, v104
    v_add_f32 v253, v253, v102
    s_waitcnt lgkmcnt(6)
    v_mfma_f32_16x16x32_bf16 v[52:55], v[220:223], v[64:67], v[52:55]
    v_exp_f32 v105, v105
    v_mfma_f32_16x16x32_bf16 v[60:63], v[220:223], v[72:75], v[60:63]
    ds_read_b64_tr_b16 v[204:205], v231 offset:8192
    ds_read_b64_tr_b16 v[206:207], v231 offset:12288
    v_add_f32 v253, v253, v103
    s_waitcnt lgkmcnt(6)
    v_mfma_f32_16x16x32_bf16 v[0:3], v[192:195], v[80:83], v[0:3]
    v_cvt_pk_bf16_f32 v99, v102, v103
    v_mfma_f32_16x16x32_bf16 v[8:11], v[192:195], v[88:91], v[8:11]
    ds_read_b64_tr_b16 v[208:209], v232 offset:8192
    ds_read_b64_tr_b16 v[210:211], v232 offset:12288
    v_exp_f32 v106, v106
    s_waitcnt lgkmcnt(6)
    v_mfma_f32_16x16x32_bf16 v[4:7], v[196:199], v[80:83], v[4:7]
    v_exp_f32 v107, v107
    v_add_f32 v254, v104, v105
    v_mfma_f32_16x16x32_bf16 v[12:15], v[196:199], v[88:91], v[12:15]
    ds_read_b64_tr_b16 v[212:213], v233 offset:8192
    ds_read_b64_tr_b16 v[214:215], v233 offset:12288
    v_cvt_pk_bf16_f32 v104, v104, v105
    s_waitcnt lgkmcnt(6)
    v_mfma_f32_16x16x32_bf16 v[16:19], v[200:203], v[80:83], v[16:19]
    v_exp_f32 v108, v108
    v_mfma_f32_16x16x32_bf16 v[24:27], v[200:203], v[88:91], v[24:27]
    ds_read_b64_tr_b16 v[216:217], v234 offset:8192
    ds_read_b64_tr_b16 v[218:219], v234 offset:12288
    v_exp_f32 v109, v109
    s_waitcnt lgkmcnt(6)
    v_mfma_f32_16x16x32_bf16 v[20:23], v[204:207], v[80:83], v[20:23]
    v_add_f32 v255, v106, v107
    v_cvt_pk_bf16_f32 v105, v106, v107
    v_mfma_f32_16x16x32_bf16 v[28:31], v[204:207], v[88:91], v[28:31]
    ds_read_b64_tr_b16 v[220:221], v235 offset:8192
    ds_read_b64_tr_b16 v[222:223], v235 offset:12288
    v_exp_f32 v110, v110
    s_waitcnt lgkmcnt(6)
    v_mfma_f32_16x16x32_bf16 v[32:35], v[208:211], v[80:83], v[32:35]
    v_add_f32 v254, v254, v108
    v_mfma_f32_16x16x32_bf16 v[40:43], v[208:211], v[88:91], v[40:43]
    v_add_u32 v224, s46, v224
    ds_read_b128 v[192:195], v224 offset:0
    v_exp_f32 v111, v111
    s_waitcnt lgkmcnt(5)
    v_mfma_f32_16x16x32_bf16 v[36:39], v[212:215], v[80:83], v[36:39]
    v_add_f32 v254, v254, v109
    v_mfma_f32_16x16x32_bf16 v[44:47], v[212:215], v[88:91], v[44:47]
    v_add_u32 v225, s46, v225
    ds_read_b128 v[196:199], v225 offset:0
    v_cvt_pk_bf16_f32 v106, v108, v109
    v_exp_f32 v112, v112
    s_waitcnt lgkmcnt(4)
    v_mfma_f32_16x16x32_bf16 v[48:51], v[216:219], v[80:83], v[48:51]
    v_add_f32 v255, v255, v110
    v_mfma_f32_16x16x32_bf16 v[56:59], v[216:219], v[88:91], v[56:59]
    v_add_u32 v226, s46, v226
    ds_read_b128 v[200:203], v226 offset:0
    v_exp_f32 v113, v113
    s_waitcnt lgkmcnt(3)
    v_mfma_f32_16x16x32_bf16 v[52:55], v[220:223], v[80:83], v[52:55]
    v_add_f32 v255, v255, v111
    v_mfma_f32_16x16x32_bf16 v[60:63], v[220:223], v[88:91], v[60:63]
    v_add_u32 v227, s46, v227
    ds_read_b128 v[204:207], v227 offset:0
    v_cvt_pk_bf16_f32 v107, v110, v111
    v_exp_f32 v114, v114
    s_waitcnt lgkmcnt(3)
    v_mfma_f32_16x16x32_bf16 v[64:67], v[192:195], v[160:163], v[240:243]
    v_add_f32 v252, v252, v112
    v_mfma_f32_16x16x32_bf16 v[72:75], v[192:195], v[176:179], v[244:247]
    ds_read_b128 v[208:211], v224 offset:4096
    v_exp_f32 v115, v115
    s_waitcnt lgkmcnt(3)
    v_mfma_f32_16x16x32_bf16 v[64:67], v[196:199], v[164:167], v[64:67]
    v_add_f32 v252, v252, v113
    v_mfma_f32_16x16x32_bf16 v[72:75], v[196:199], v[180:183], v[72:75]
    ds_read_b128 v[212:215], v225 offset:4096
    v_cvt_pk_bf16_f32 v112, v112, v113
    s_waitcnt lgkmcnt(3)
    v_mfma_f32_16x16x32_bf16 v[64:67], v[200:203], v[168:171], v[64:67]
    v_exp_f32 v116, v116
    v_add_f32 v253, v253, v114
    v_mfma_f32_16x16x32_bf16 v[72:75], v[200:203], v[184:187], v[72:75]
    ds_read_b128 v[216:219], v226 offset:4096
    v_exp_f32 v117, v117
    s_waitcnt lgkmcnt(3)
    v_mfma_f32_16x16x32_bf16 v[64:67], v[204:207], v[172:175], v[64:67]
    v_add_f32 v253, v253, v115
    v_mfma_f32_16x16x32_bf16 v[72:75], v[204:207], v[188:191], v[72:75]
    ds_read_b128 v[220:223], v227 offset:4096
    v_cvt_pk_bf16_f32 v113, v114, v115
    s_waitcnt lgkmcnt(3)
    v_mfma_f32_16x16x32_bf16 v[68:71], v[208:211], v[160:163], v[240:243]
    v_exp_f32 v118, v118
    v_mfma_f32_16x16x32_bf16 v[76:79], v[208:211], v[176:179], v[244:247]
    ds_read_b128 v[192:195], v224 offset:8192
    v_add_f32 v252, v252, v116
    v_exp_f32 v119, v119
    s_waitcnt lgkmcnt(3)
    v_mfma_f32_16x16x32_bf16 v[68:71], v[212:215], v[164:167], v[68:71]
    v_add_f32 v252, v252, v117
    v_mfma_f32_16x16x32_bf16 v[76:79], v[212:215], v[180:183], v[76:79]
    ds_read_b128 v[196:199], v225 offset:8192
    v_cvt_pk_bf16_f32 v114, v116, v117
    s_waitcnt lgkmcnt(3)
    v_mfma_f32_16x16x32_bf16 v[68:71], v[216:219], v[168:171], v[68:71]
    v_exp_f32 v120, v120
    v_mfma_f32_16x16x32_bf16 v[76:79], v[216:219], v[184:187], v[76:79]
    ds_read_b128 v[200:203], v226 offset:8192
    v_add_f32 v253, v253, v118
    v_exp_f32 v121, v121
    s_waitcnt lgkmcnt(3)
    v_mfma_f32_16x16x32_bf16 v[68:71], v[220:223], v[172:175], v[68:71]
    v_add_f32 v253, v253, v119
    v_mfma_f32_16x16x32_bf16 v[76:79], v[220:223], v[188:191], v[76:79]
    ds_read_b128 v[204:207], v227 offset:8192
    v_cvt_pk_bf16_f32 v115, v118, v119
    s_waitcnt lgkmcnt(3)
    v_mfma_f32_16x16x32_bf16 v[80:83], v[192:195], v[160:163], v[240:243]
    v_exp_f32 v122, v122
    v_mfma_f32_16x16x32_bf16 v[88:91], v[192:195], v[176:179], v[244:247]
    ds_read_b128 v[208:211], v224 offset:12288
    v_add_f32 v254, v254, v120
    s_waitcnt lgkmcnt(3)
    v_mfma_f32_16x16x32_bf16 v[80:83], v[196:199], v[164:167], v[80:83]
    v_exp_f32 v123, v123
    v_add_f32 v254, v254, v121
    v_mfma_f32_16x16x32_bf16 v[88:91], v[196:199], v[180:183], v[88:91]
    ds_read_b128 v[212:215], v225 offset:12288
    v_cvt_pk_bf16_f32 v120, v120, v121
    s_waitcnt lgkmcnt(3)
    v_mfma_f32_16x16x32_bf16 v[80:83], v[200:203], v[168:171], v[80:83]
    v_exp_f32 v124, v124
    v_mfma_f32_16x16x32_bf16 v[88:91], v[200:203], v[184:187], v[88:91]
    ds_read_b128 v[216:219], v226 offset:12288
    v_add_f32 v255, v255, v122
    s_waitcnt lgkmcnt(3)
    v_mfma_f32_16x16x32_bf16 v[80:83], v[204:207], v[172:175], v[80:83]
    v_exp_f32 v125, v125
    v_add_f32 v255, v255, v123
    v_mfma_f32_16x16x32_bf16 v[88:91], v[204:207], v[188:191], v[88:91]
    ds_read_b128 v[220:223], v227 offset:12288
    v_cvt_pk_bf16_f32 v121, v122, v123
    s_waitcnt lgkmcnt(3)
    v_mfma_f32_16x16x32_bf16 v[84:87], v[208:211], v[160:163], v[240:243]
    v_exp_f32 v126, v126
    v_mfma_f32_16x16x32_bf16 v[92:95], v[208:211], v[176:179], v[244:247]
    ds_read_b64_tr_b16 v[192:193], v228 offset:16384
    ds_read_b64_tr_b16 v[194:195], v228 offset:20480
    v_add_f32 v254, v254, v124
    s_waitcnt lgkmcnt(4)
    v_mfma_f32_16x16x32_bf16 v[84:87], v[212:215], v[164:167], v[84:87]
    v_exp_f32 v127, v127
    v_mfma_f32_16x16x32_bf16 v[92:95], v[212:215], v[180:183], v[92:95]
    ds_read_b64_tr_b16 v[196:197], v229 offset:16384
    ds_read_b64_tr_b16 v[198:199], v229 offset:20480
    v_add_f32 v254, v254, v125
    v_cvt_pk_bf16_f32 v122, v124, v125
    s_waitcnt lgkmcnt(5)
    v_mfma_f32_16x16x32_bf16 v[84:87], v[216:219], v[168:171], v[84:87]
    v_add_f32 v255, v255, v126
    v_mfma_f32_16x16x32_bf16 v[92:95], v[216:219], v[184:187], v[92:95]
    ds_read_b64_tr_b16 v[200:201], v230 offset:16384
    ds_read_b64_tr_b16 v[202:203], v230 offset:20480
    v_add_f32 v255, v255, v127
    s_waitcnt lgkmcnt(6)
    v_mfma_f32_16x16x32_bf16 v[84:87], v[220:223], v[172:175], v[84:87]
    v_cvt_pk_bf16_f32 v123, v126, v127
    v_mfma_f32_16x16x32_bf16 v[92:95], v[220:223], v[188:191], v[92:95]
    ds_read_b64_tr_b16 v[204:205], v231 offset:16384
    ds_read_b64_tr_b16 v[206:207], v231 offset:20480
    v_add_f32 v252, v252, v253
    v_add_f32 v254, v254, v255
    v_max_f32 v239, v252, v254
    v_cmp_lt_f32 vcc, 0x46800000, v239
    s_cbranch_vccnz L_slow_1_3
L_back_1_3:
    v_add_f32 v248, v248, v252
    v_add_f32 v249, v249, v254
    s_waitcnt lgkmcnt(6)
    v_mfma_f32_16x16x32_bf16 v[0:3], v[192:195], v[96:99], v[0:3]
    v_exp_f32 v64, v64
    v_mfma_f32_16x16x32_bf16 v[8:11], v[192:195], v[104:107], v[8:11]
    ds_read_b64_tr_b16 v[208:209], v232 offset:16384
    ds_read_b64_tr_b16 v[210:211], v232 offset:20480
    v_exp_f32 v65, v65
    s_waitcnt lgkmcnt(6)
    v_mfma_f32_16x16x32_bf16 v[4:7], v[196:199], v[96:99], v[4:7]
    v_exp_f32 v66, v66
    v_mfma_f32_16x16x32_bf16 v[12:15], v[196:199], v[104:107], v[12:15]
    ds_read_b64_tr_b16 v[212:213], v233 offset:16384
    ds_read_b64_tr_b16 v[214:215], v233 offset:20480
    v_exp_f32 v67, v67
    s_waitcnt lgkmcnt(6)
    v_mfma_f32_16x16x32_bf16 v[16:19], v[200:203], v[96:99], v[16:19]
    v_add_f32 v252, v64, v65
    v_cvt_pk_bf16_f32 v64, v64, v65
    v_mfma_f32_16x16x32_bf16 v[24:27], v[200:203], v[104:107], v[24:27]
    ds_read_b64_tr_b16 v[216:217], v234 offset:16384
    ds_read_b64_tr_b16 v[218:219], v234 offset:20480
    v_exp_f32 v68, v68
    s_waitcnt lgkmcnt(6)
    v_mfma_f32_16x16x32_bf16 v[20:23], v[204:207], v[96:99], v[20:23]
    v_exp_f32 v69, v69
    v_mfma_f32_16x16x32_bf16 v[28:31], v[204:207], v[104:107], v[28:31]
    ds_read_b64_tr_b16 v[220:221], v235 offset:16384
    ds_read_b64_tr_b16 v[222:223], v235 offset:20480
    v_add_f32 v253, v66, v67
    s_waitcnt lgkmcnt(6)
    v_mfma_f32_16x16x32_bf16 v[32:35], v[208:211], v[96:99], v[32:35]
    v_cvt_pk_bf16_f32 v65, v66, v67
    v_mfma_f32_16x16x32_bf16 v[40:43], v[208:211], v[104:107], v[40:43]
    ds_read_b64_tr_b16 v[192:193], v228 offset:24576
    ds_read_b64_tr_b16 v[194:195], v228 offset:28672
    v_exp_f32 v70, v70
    v_add_f32 v252, v252, v68
    s_waitcnt lgkmcnt(6)
    v_mfma_f32_16x16x32_bf16 v[36:39], v[212:215], v[96:99], v[36:39]
    v_exp_f32 v71, v71
    v_mfma_f32_16x16x32_bf16 v[44:47], v[212:215], v[104:107], v[44:47]
    ds_read_b64_tr_b16 v[196:197], v229 offset:24576
    ds_read_b64_tr_b16 v[198:199], v229 offset:28672
    v_add_f32 v252, v252, v69
    s_waitcnt lgkmcnt(6)
    v_mfma_f32_16x16x32_bf16 v[48:51], v[216:219], v[96:99], v[48:51]
    v_cvt_pk_bf16_f32 v66, v68, v69
    v_mfma_f32_16x16x32_bf16 v[56:59], v[216:219], v[104:107], v[56:59]
    ds_read_b64_tr_b16 v[200:201], v230 offset:24576
    ds_read_b64_tr_b16 v[202:203], v230 offset:28672
    v_exp_f32 v72, v72
    v_add_f32 v253, v253, v70
    s_waitcnt lgkmcnt(6)
    v_mfma_f32_16x16x32_bf16 v[52:55], v[220:223], v[96:99], v[52:55]
    v_exp_f32 v73, v73
    v_mfma_f32_16x16x32_bf16 v[60:63], v[220:223], v[104:107], v[60:63]
    ds_read_b64_tr_b16 v[204:205], v231 offset:24576
    ds_read_b64_tr_b16 v[206:207], v231 offset:28672
    v_add_f32 v253, v253, v71
    s_waitcnt lgkmcnt(6)
    v_mfma_f32_16x16x32_bf16 v[0:3], v[192:195], v[112:115], v[0:3]
    v_cvt_pk_bf16_f32 v67, v70, v71
    v_mfma_f32_16x16x32_bf16 v[8:11], v[192:195], v[120:123], v[8:11]
    ds_read_b64_tr_b16 v[208:209], v232 offset:24576
    ds_read_b64_tr_b16 v[210:211], v232 offset:28672
    v_exp_f32 v74, v74
    s_waitcnt lgkmcnt(6)
    v_mfma_f32_16x16x32_bf16 v[4:7], v[196:199], v[112:115], v[4:7]
    v_exp_f32 v75, v75
    v_add_f32 v254, v72, v73
    v_mfma_f32_16x16x32_bf16 v[12:15], v[196:199], v[120:123], v[12:15]
    ds_read_b64_tr_b16 v[212:213], v233 offset:24576
    ds_read_b64_tr_b16 v[214:215], v233 offset:28672
    v_cvt_pk_bf16_f32 v72, v72, v73
    s_waitcnt lgkmcnt(6)
    v_mfma_f32_16x16x32_bf16 v[16:19], v[200:203], v[112:115], v[16:19]
    v_exp_f32 v76, v76
    v_mfma_f32_16x16x32_bf16 v[24:27], v[200:203], v[120:123], v[24:27]
    ds_read_b64_tr_b16 v[216:217], v234 offset:24576
    ds_read_b64_tr_b16 v[218:219], v234 offset:28672
    v_exp_f32 v77, v77
    s_waitcnt lgkmcnt(6)
    v_mfma_f32_16x16x32_bf16 v[20:23], v[204:207], v[112:115], v[20:23]
    v_add_f32 v255, v74, v75
    v_cvt_pk_bf16_f32 v73, v74, v75
    v_mfma_f32_16x16x32_bf16 v[28:31], v[204:207], v[120:123], v[28:31]
    ds_read_b64_tr_b16 v[220:221], v235 offset:24576
    ds_read_b64_tr_b16 v[222:223], v235 offset:28672
    v_exp_f32 v78, v78
    s_waitcnt lgkmcnt(6)
    v_mfma_f32_16x16x32_bf16 v[32:35], v[208:211], v[112:115], v[32:35]
    v_add_f32 v254, v254, v76
    v_mfma_f32_16x16x32_bf16 v[40:43], v[208:211], v[120:123], v[40:43]
    ds_read_b128 v[192:195], v224 offset:16384
    v_exp_f32 v79, v79
    s_waitcnt lgkmcnt(5)
    v_mfma_f32_16x16x32_bf16 v[36:39], v[212:215], v[112:115], v[36:39]
    v_add_f32 v254, v254, v77
    v_mfma_f32_16x16x32_bf16 v[44:47], v[212:215], v[120:123], v[44:47]
    ds_read_b128 v[196:199], v225 offset:16384
    v_cvt_pk_bf16_f32 v74, v76, v77
    v_exp_f32 v80, v80
    s_waitcnt lgkmcnt(4)
    v_mfma_f32_16x16x32_bf16 v[48:51], v[216:219], v[112:115], v[48:51]
    v_add_f32 v255, v255, v78
    v_mfma_f32_16x16x32_bf16 v[56:59], v[216:219], v[120:123], v[56:59]
    ds_read_b128 v[200:203], v226 offset:16384
    v_exp_f32 v81, v81
    s_waitcnt lgkmcnt(3)
    v_mfma_f32_16x16x32_bf16 v[52:55], v[220:223], v[112:115], v[52:55]
    v_add_f32 v255, v255, v79
    v_mfma_f32_16x16x32_bf16 v[60:63], v[220:223], v[120:123], v[60:63]
    ds_read_b128 v[204:207], v227 offset:16384
    v_cvt_pk_bf16_f32 v75, v78, v79
    v_exp_f32 v82, v82
    s_waitcnt lgkmcnt(3)
    v_mfma_f32_16x16x32_bf16 v[96:99], v[192:195], v[160:163], v[240:243]
    v_add_f32 v252, v252, v80
    v_mfma_f32_16x16x32_bf16 v[104:107], v[192:195], v[176:179], v[244:247]
    ds_read_b128 v[208:211], v224 offset:20480
    v_exp_f32 v83, v83
    s_waitcnt lgkmcnt(3)
    v_mfma_f32_16x16x32_bf16 v[96:99], v[196:199], v[164:167], v[96:99]
    v_add_f32 v252, v252, v81
    v_mfma_f32_16x16x32_bf16 v[104:107], v[196:199], v[180:183], v[104:107]
    ds_read_b128 v[212:215], v225 offset:20480
    v_cvt_pk_bf16_f32 v80, v80, v81
    s_waitcnt lgkmcnt(3)
    v_mfma_f32_16x16x32_bf16 v[96:99], v[200:203], v[168:171], v[96:99]
    v_exp_f32 v84, v84
    v_add_f32 v253, v253, v82
    v_mfma_f32_16x16x32_bf16 v[104:107], v[200:203], v[184:187], v[104:107]
    ds_read_b128 v[216:219], v226 offset:20480
    v_exp_f32 v85, v85
    s_waitcnt lgkmcnt(3)
    v_mfma_f32_16x16x32_bf16 v[96:99], v[204:207], v[172:175], v[96:99]
    v_add_f32 v253, v253, v83
    v_mfma_f32_16x16x32_bf16 v[104:107], v[204:207], v[188:191], v[104:107]
    ds_read_b128 v[220:223], v227 offset:20480
    v_cvt_pk_bf16_f32 v81, v82, v83
    s_waitcnt lgkmcnt(3)
    v_mfma_f32_16x16x32_bf16 v[100:103], v[208:211], v[160:163], v[240:243]
    v_exp_f32 v86, v86
    v_mfma_f32_16x16x32_bf16 v[108:111], v[208:211], v[176:179], v[244:247]
    ds_read_b128 v[192:195], v224 offset:24576
    v_add_f32 v252, v252, v84
    v_exp_f32 v87, v87
    s_waitcnt lgkmcnt(3)
    v_mfma_f32_16x16x32_bf16 v[100:103], v[212:215], v[164:167], v[100:103]
    v_add_f32 v252, v252, v85
    v_mfma_f32_16x16x32_bf16 v[108:111], v[212:215], v[180:183], v[108:111]
    ds_read_b128 v[196:199], v225 offset:24576
    v_cvt_pk_bf16_f32 v82, v84, v85
    s_waitcnt lgkmcnt(3)
    v_mfma_f32_16x16x32_bf16 v[100:103], v[216:219], v[168:171], v[100:103]
    v_exp_f32 v88, v88
    v_mfma_f32_16x16x32_bf16 v[108:111], v[216:219], v[184:187], v[108:111]
    ds_read_b128 v[200:203], v226 offset:24576
    v_add_f32 v253, v253, v86
    v_exp_f32 v89, v89
    s_waitcnt lgkmcnt(3)
    v_mfma_f32_16x16x32_bf16 v[100:103], v[220:223], v[172:175], v[100:103]
    v_add_f32 v253, v253, v87
    v_mfma_f32_16x16x32_bf16 v[108:111], v[220:223], v[188:191], v[108:111]
    ds_read_b128 v[204:207], v227 offset:24576
    v_cvt_pk_bf16_f32 v83, v86, v87
    s_waitcnt lgkmcnt(3)
    v_mfma_f32_16x16x32_bf16 v[112:115], v[192:195], v[160:163], v[240:243]
    v_exp_f32 v90, v90
    v_mfma_f32_16x16x32_bf16 v[120:123], v[192:195], v[176:179], v[244:247]
    ds_read_b128 v[208:211], v224 offset:28672
    v_add_f32 v254, v254, v88
    s_waitcnt lgkmcnt(3)
    v_mfma_f32_16x16x32_bf16 v[112:115], v[196:199], v[164:167], v[112:115]
    v_exp_f32 v91, v91
    v_add_f32 v254, v254, v89
    v_mfma_f32_16x16x32_bf16 v[120:123], v[196:199], v[180:183], v[120:123]
    ds_read_b128 v[212:215], v225 offset:28672
    v_cvt_pk_bf16_f32 v88, v88, v89
    s_waitcnt lgkmcnt(3)
    v_mfma_f32_16x16x32_bf16 v[112:115], v[200:203], v[168:171], v[112:115]
    v_exp_f32 v92, v92
    v_mfma_f32_16x16x32_bf16 v[120:123], v[200:203], v[184:187], v[120:123]
    ds_read_b128 v[216:219], v226 offset:28672
    v_add_f32 v255, v255, v90
    s_waitcnt lgkmcnt(3)
    v_mfma_f32_16x16x32_bf16 v[112:115], v[204:207], v[172:175], v[112:115]
    v_exp_f32 v93, v93
    v_add_f32 v255, v255, v91
    v_mfma_f32_16x16x32_bf16 v[120:123], v[204:207], v[188:191], v[120:123]
    ds_read_b128 v[220:223], v227 offset:28672
    v_cvt_pk_bf16_f32 v89, v90, v91
    s_waitcnt lgkmcnt(3)
    v_mfma_f32_16x16x32_bf16 v[116:119], v[208:211], v[160:163], v[240:243]
    v_exp_f32 v94, v94
    v_mfma_f32_16x16x32_bf16 v[124:127], v[208:211], v[176:179], v[244:247]
    s_waitcnt vmcnt(4)
    s_barrier
    s_add_u32 m0, s80, 0
    s_add_u32 s38, s82, 0
    buffer_load_dwordx4 v238, s[20:23], s38 offen nt lds
    s_add_u32 m0, s80, 8192
    s_add_u32 s38, s82, 8192
    buffer_load_dwordx4 v238, s[20:23], s38 offen nt lds
    s_add_u32 m0, s80, 16384
    s_add_u32 s38, s82, 16384
    buffer_load_dwordx4 v238, s[20:23], s38 offen nt lds
    s_add_u32 m0, s80, 24576
    s_add_u32 s38, s82, 24576
    buffer_load_dwordx4 v238, s[20:23], s38 offen nt lds
    v_add_u32 v228, s85, v228
    ds_read_b64_tr_b16 v[192:193], v228 offset:0
    ds_read_b64_tr_b16 v[194:195], v228 offset:4096
    v_add_f32 v254, v254, v92
    s_waitcnt lgkmcnt(4)
    v_mfma_f32_16x16x32_bf16 v[116:119], v[212:215], v[164:167], v[116:119]
    v_exp_f32 v95, v95
    v_mfma_f32_16x16x32_bf16 v[124:127], v[212:215], v[180:183], v[124:127]
    v_add_u32 v229, s85, v229
    ds_read_b64_tr_b16 v[196:197], v229 offset:0
    ds_read_b64_tr_b16 v[198:199], v229 offset:4096
    v_add_f32 v254, v254, v93
    v_cvt_pk_bf16_f32 v90, v92, v93
    s_waitcnt lgkmcnt(5)
    v_mfma_f32_16x16x32_bf16 v[116:119], v[216:219], v[168:171], v[116:119]
    v_add_f32 v255, v255, v94
    v_mfma_f32_16x16x32_bf16 v[124:127], v[216:219], v[184:187], v[124:127]
    v_add_u32 v230, s85, v230
    ds_read_b64_tr_b16 v[200:201], v230 offset:0
    ds_read_b64_tr_b16 v[202:203], v230 offset:4096
    v_add_f32 v255, v255, v95
    s_waitcnt lgkmcnt(6)
    v_mfma_f32_16x16x32_bf16 v[116:119], v[220:223], v[172:175], v[116:119]
    v_cvt_pk_bf16_f32 v91, v94, v95
    v_mfma_f32_16x16x32_bf16 v[124:127], v[220:223], v[188:191], v[124:127]
    v_add_u32 v231, s85, v231
    ds_read_b64_tr_b16 v[204:205], v231 offset:0
    ds_read_b64_tr_b16 v[206:207], v231 offset:4096
    v_add_f32 v252, v252, v253
    v_add_f32 v254, v254, v255
    v_max_f32 v239, v252, v254
    v_cmp_lt_f32 vcc, 0x46800000, v239
    s_cbranch_vccnz L_slow_1_4
L_back_1_4:
    v_add_f32 v248, v248, v252
    v_add_f32 v249, v249, v254
    s_waitcnt lgkmcnt(6)
    v_mfma_f32_16x16x32_bf16 v[0:3], v[192:195], v[64:67], v[0:3]
    v_exp_f32 v96, v96
    v_mfma_f32_16x16x32_bf16 v[8:11], v[192:195], v[72:75], v[8:11]
    v_add_u32 v232, s85, v232
    ds_read_b64_tr_b16 v[208:209], v232 offset:0
    ds_read_b64_tr_b16 v[210:211], v232 offset:4096
    v_exp_f32 v97, v97
    s_waitcnt lgkmcnt(6)
    v_mfma_f32_16x16x32_bf16 v[4:7], v[196:199], v[64:67], v[4:7]
    v_exp_f32 v98, v98
    v_mfma_f32_16x16x32_bf16 v[12:15], v[196:199], v[72:75], v[12:15]
    v_add_u32 v233, s85, v233
    ds_read_b64_tr_b16 v[212:213], v233 offset:0
    ds_read_b64_tr_b16 v[214:215], v233 offset:4096
    v_exp_f32 v99, v99
    s_waitcnt lgkmcnt(6)
    v_mfma_f32_16x16x32_bf16 v[16:19], v[200:203], v[64:67], v[16:19]
    v_add_f32 v252, v96, v97
    v_cvt_pk_bf16_f32 v96, v96, v97
    v_mfma_f32_16x16x32_bf16 v[24:27], v[200:203], v[72:75], v[24:27]
    v_add_u32 v234, s85, v234
    ds_read_b64_tr_b16 v[216:217], v234 offset:0
    ds_read_b64_tr_b16 v[218:219], v234 offset:4096
    v_exp_f32 v100, v100
    s_waitcnt lgkmcnt(6)
    v_mfma_f32_16x16x32_bf16 v[20:23], v[204:207], v[64:67], v[20:23]
    v_exp_f32 v101, v101
    v_mfma_f32_16x16x32_bf16 v[28:31], v[204:207], v[72:75], v[28:31]
    v_add_u32 v235, s85, v235
    ds_read_b64_tr_b16 v[220:221], v235 offset:0
    ds_read_b64_tr_b16 v[222:223], v235 offset:4096
    v_add_f32 v253, v98, v99
    s_waitcnt lgkmcnt(6)
    v_mfma_f32_16x16x32_bf16 v[32:35], v[208:211], v[64:67], v[32:35]
    v_cvt_pk_bf16_f32 v97, v98, v99
    v_mfma_f32_16x16x32_bf16 v[40:43], v[208:211], v[72:75], v[40:43]
    ds_read_b64_tr_b16 v[192:193], v228 offset:8192
    ds_read_b64_tr_b16 v[194:195], v228 offset:12288
    v_exp_f32 v102, v102
    v_add_f32 v252, v252, v100
    s_waitcnt lgkmcnt(6)
    v_mfma_f32_16x16x32_bf16 v[36:39], v[212:215], v[64:67], v[36:39]
    v_exp_f32 v103, v103
    v_mfma_f32_16x16x32_bf16 v[44:47], v[212:215], v[72:75], v[44:47]
    ds_read_b64_tr_b16 v[196:197], v229 offset:8192
    ds_read_b64_tr_b16 v[198:199], v229 offset:12288
    v_add_f32 v252, v252, v101
    s_waitcnt lgkmcnt(6)
    v_mfma_f32_16x16x32_bf16 v[48:51], v[216:219], v[64:67], v[48:51]
    v_cvt_pk_bf16_f32 v98, v100, v101
    v_mfma_f32_16x16x32_bf16 v[56:59], v[216:219], v[72:75], v[56:59]
    ds_read_b64_tr_b16 v[200:201], v230 offset:8192
    ds_read_b64_tr_b16 v[202:203], v230 offset:12288
    v_exp_f32 v104, v104
    v_add_f32 v253, v253, v102
    s_waitcnt lgkmcnt(6)
    v_mfma_f32_16x16x32_bf16 v[52:55], v[220:223], v[64:67], v[52:55]
    v_exp_f32 v105, v105
    v_mfma_f32_16x16x32_bf16 v[60:63], v[220:223], v[72:75], v[60:63]
    ds_read_b64_tr_b16 v[204:205], v231 offset:8192
    ds_read_b64_tr_b16 v[206:207], v231 offset:12288
    v_add_f32 v253, v253, v103
    s_waitcnt lgkmcnt(6)
    v_mfma_f32_16x16x32_bf16 v[0:3], v[192:195], v[80:83], v[0:3]
    v_cvt_pk_bf16_f32 v99, v102, v103
    v_mfma_f32_16x16x32_bf16 v[8:11], v[192:195], v[88:91], v[8:11]
    ds_read_b64_tr_b16 v[208:209], v232 offset:8192
    ds_read_b64_tr_b16 v[210:211], v232 offset:12288
    v_exp_f32 v106, v106
    s_waitcnt lgkmcnt(6)
    v_mfma_f32_16x16x32_bf16 v[4:7], v[196:199], v[80:83], v[4:7]
    v_exp_f32 v107, v107
    v_add_f32 v254, v104, v105
    v_mfma_f32_16x16x32_bf16 v[12:15], v[196:199], v[88:91], v[12:15]
    ds_read_b64_tr_b16 v[212:213], v233 offset:8192
    ds_read_b64_tr_b16 v[214:215], v233 offset:12288
    v_cvt_pk_bf16_f32 v104, v104, v105
    s_waitcnt lgkmcnt(6)
    v_mfma_f32_16x16x32_bf16 v[16:19], v[200:203], v[80:83], v[16:19]
    v_exp_f32 v108, v108
    v_mfma_f32_16x16x32_bf16 v[24:27], v[200:203], v[88:91], v[24:27]
    ds_read_b64_tr_b16 v[216:217], v234 offset:8192
    ds_read_b64_tr_b16 v[218:219], v234 offset:12288
    v_exp_f32 v109, v109
    s_waitcnt lgkmcnt(6)
    v_mfma_f32_16x16x32_bf16 v[20:23], v[204:207], v[80:83], v[20:23]
    v_add_f32 v255, v106, v107
    v_cvt_pk_bf16_f32 v105, v106, v107
    v_mfma_f32_16x16x32_bf16 v[28:31], v[204:207], v[88:91], v[28:31]
    ds_read_b64_tr_b16 v[220:221], v235 offset:8192
    ds_read_b64_tr_b16 v[222:223], v235 offset:12288
    v_exp_f32 v110, v110
    s_waitcnt lgkmcnt(6)
    v_mfma_f32_16x16x32_bf16 v[32:35], v[208:211], v[80:83], v[32:35]
    v_add_f32 v254, v254, v108
    v_mfma_f32_16x16x32_bf16 v[40:43], v[208:211], v[88:91], v[40:43]
    v_add_u32 v224, s47, v224
    ds_read_b128 v[192:195], v224 offset:0
    v_exp_f32 v111, v111
    s_waitcnt lgkmcnt(5)
    v_mfma_f32_16x16x32_bf16 v[36:39], v[212:215], v[80:83], v[36:39]
    v_add_f32 v254, v254, v109
    v_mfma_f32_16x16x32_bf16 v[44:47], v[212:215], v[88:91], v[44:47]
    v_add_u32 v225, s47, v225
    ds_read_b128 v[196:199], v225 offset:0
    v_cvt_pk_bf16_f32 v106, v108, v109
    v_exp_f32 v112, v112
    s_waitcnt lgkmcnt(4)
    v_mfma_f32_16x16x32_bf16 v[48:51], v[216:219], v[80:83], v[48:51]
    v_add_f32 v255, v255, v110
    v_mfma_f32_16x16x32_bf16 v[56:59], v[216:219], v[88:91], v[56:59]
    v_add_u32 v226, s47, v226
    ds_read_b128 v[200:203], v226 offset:0
    v_exp_f32 v113, v113
    s_waitcnt lgkmcnt(3)
    v_mfma_f32_16x16x32_bf16 v[52:55], v[220:223], v[80:83], v[52:55]
    v_add_f32 v255, v255, v111
    v_mfma_f32_16x16x32_bf16 v[60:63], v[220:223], v[88:91], v[60:63]
    v_add_u32 v227, s47, v227
    ds_read_b128 v[204:207], v227 offset:0
    v_cvt_pk_bf16_f32 v107, v110, v111
    v_exp_f32 v114, v114
    s_waitcnt vmcnt(4)
    s_waitcnt lgkmcnt(3)
    v_mfma_f32_16x16x32_bf16 v[64:67], v[192:195], v[128:131], 0
    v_add_f32 v252, v252, v112
    v_mfma_f32_16x16x32_bf16 v[72:75], v[192:195], v[144:147], 0
    ds_read_b128 v[208:211], v224 offset:4096
    v_exp_f32 v115, v115
    s_waitcnt lgkmcnt(3)
    v_mfma_f32_16x16x32_bf16 v[64:67], v[196:199], v[132:135], v[64:67]
    v_add_f32 v252, v252, v113
    v_mfma_f32_16x16x32_bf16 v[72:75], v[196:199], v[148:151], v[72:75]
    ds_read_b128 v[212:215], v225 offset:4096
    v_cvt_pk_bf16_f32 v112, v112, v113
    s_waitcnt lgkmcnt(3)
    v_mfma_f32_16x16x32_bf16 v[64:67], v[200:203], v[136:139], v[64:67]
    v_exp_f32 v116, v116
    v_add_f32 v253, v253, v114
    v_mfma_f32_16x16x32_bf16 v[72:75], v[200:203], v[152:155], v[72:75]
    ds_read_b128 v[216:219], v226 offset:4096
    v_exp_f32 v117, v117
    s_waitcnt lgkmcnt(3)
    v_mfma_f32_16x16x32_bf16 v[64:67], v[204:207], v[140:143], v[64:67]
    v_add_f32 v253, v253, v115
    v_mfma_f32_16x16x32_bf16 v[72:75], v[204:207], v[156:159], v[72:75]
    ds_read_b128 v[220:223], v227 offset:4096
    v_cvt_pk_bf16_f32 v113, v114, v115
    s_waitcnt lgkmcnt(3)
    v_mfma_f32_16x16x32_bf16 v[68:71], v[208:211], v[128:131], 0
    v_exp_f32 v118, v118
    v_mfma_f32_16x16x32_bf16 v[76:79], v[208:211], v[144:147], 0
    ds_read_b128 v[192:195], v224 offset:8192
    v_add_f32 v252, v252, v116
    v_exp_f32 v119, v119
    s_waitcnt lgkmcnt(3)
    v_mfma_f32_16x16x32_bf16 v[68:71], v[212:215], v[132:135], v[68:71]
    v_add_f32 v252, v252, v117
    v_mfma_f32_16x16x32_bf16 v[76:79], v[212:215], v[148:151], v[76:79]
    ds_read_b128 v[196:199], v225 offset:8192
    v_cvt_pk_bf16_f32 v114, v116, v117
    s_waitcnt lgkmcnt(3)
    v_mfma_f32_16x16x32_bf16 v[68:71], v[216:219], v[136:139], v[68:71]
    v_exp_f32 v120, v120
    v_mfma_f32_16x16x32_bf16 v[76:79], v[216:219], v[152:155], v[76:79]
    ds_read_b128 v[200:203], v226 offset:8192
    v_add_f32 v253, v253, v118
    v_exp_f32 v121, v121
    s_waitcnt lgkmcnt(3)
    v_mfma_f32_16x16x32_bf16 v[68:71], v[220:223], v[140:143], v[68:71]
    v_add_f32 v253, v253, v119
    v_mfma_f32_16x16x32_bf16 v[76:79], v[220:223], v[156:159], v[76:79]
    ds_read_b128 v[204:207], v227 offset:8192
    v_cvt_pk_bf16_f32 v115, v118, v119
    s_waitcnt lgkmcnt(3)
    v_mfma_f32_16x16x32_bf16 v[80:83], v[192:195], v[128:131], 0
    v_exp_f32 v122, v122
    v_mfma_f32_16x16x32_bf16 v[88:91], v[192:195], v[144:147], 0
    ds_read_b128 v[208:211], v224 offset:12288
    v_add_f32 v254, v254, v120
    s_waitcnt lgkmcnt(3)
    v_mfma_f32_16x16x32_bf16 v[80:83], v[196:199], v[132:135], v[80:83]
    v_exp_f32 v123, v123
    v_add_f32 v254, v254, v121
    v_mfma_f32_16x16x32_bf16 v[88:91], v[196:199], v[148:151], v[88:91]
    ds_read_b128 v[212:215], v225 offset:12288
    v_cvt_pk_bf16_f32 v120, v120, v121
    s_waitcnt lgkmcnt(3)
    v_mfma_f32_16x16x32_bf16 v[80:83], v[200:203], v[136:139], v[80:83]
    v_exp_f32 v124, v124
    v_mfma_f32_16x16x32_bf16 v[88:91], v[200:203], v[152:155], v[88:91]
    ds_read_b128 v[216:219], v226 offset:12288
    v_add_f32 v255, v255, v122
    s_waitcnt lgkmcnt(3)
    v_mfma_f32_16x16x32_bf16 v[80:83], v[204:207], v[140:143], v[80:83]
    v_exp_f32 v125, v125
    v_add_f32 v255, v255, v123
    v_mfma_f32_16x16x32_bf16 v[88:91], v[204:207], v[156:159], v[88:91]
    ds_read_b128 v[220:223], v227 offset:12288
    v_cvt_pk_bf16_f32 v121, v122, v123
    s_waitcnt lgkmcnt(3)
    v_mfma_f32_16x16x32_bf16 v[84:87], v[208:211], v[128:131], 0
    v_exp_f32 v126, v126
    v_mfma_f32_16x16x32_bf16 v[92:95], v[208:211], v[144:147], 0
    ds_read_b64_tr_b16 v[192:193], v228 offset:16384
    ds_read_b64_tr_b16 v[194:195], v228 offset:20480
    v_add_f32 v254, v254, v124
    s_waitcnt lgkmcnt(4)
    v_mfma_f32_16x16x32_bf16 v[84:87], v[212:215], v[132:135], v[84:87]
    v_exp_f32 v127, v127
    v_mfma_f32_16x16x32_bf16 v[92:95], v[212:215], v[148:151], v[92:95]
    ds_read_b64_tr_b16 v[196:197], v229 offset:16384
    ds_read_b64_tr_b16 v[198:199], v229 offset:20480
    v_add_f32 v254, v254, v125
    v_cvt_pk_bf16_f32 v122, v124, v125
    s_waitcnt lgkmcnt(5)
    v_mfma_f32_16x16x32_bf16 v[84:87], v[216:219], v[136:139], v[84:87]
    v_add_f32 v255, v255, v126
    v_mfma_f32_16x16x32_bf16 v[92:95], v[216:219], v[152:155], v[92:95]
    ds_read_b64_tr_b16 v[200:201], v230 offset:16384
    ds_read_b64_tr_b16 v[202:203], v230 offset:20480
    v_add_f32 v255, v255, v127
    s_waitcnt lgkmcnt(6)
    v_mfma_f32_16x16x32_bf16 v[84:87], v[220:223], v[140:143], v[84:87]
    v_cvt_pk_bf16_f32 v123, v126, v127
    v_mfma_f32_16x16x32_bf16 v[92:95], v[220:223], v[156:159], v[92:95]
    ds_read_b64_tr_b16 v[204:205], v231 offset:16384
    ds_read_b64_tr_b16 v[206:207], v231 offset:20480
    v_add_f32 v252, v252, v253
    v_add_f32 v254, v254, v255
    v_max_f32 v239, v252, v254
    v_cmp_lt_f32 vcc, 0x46800000, v239
    s_cbranch_vccnz L_slow_1_5
L_back_1_5:
    v_add_f32 v248, v248, v252
    v_add_f32 v249, v249, v254
    s_waitcnt lgkmcnt(6)
    v_mfma_f32_16x16x32_bf16 v[0:3], v[192:195], v[96:99], v[0:3]
    v_mov_b32 v250, v248
    v_mov_b32 v251, v249
    v_mfma_f32_16x16x32_bf16 v[8:11], v[192:195], v[104:107], v[8:11]
    ds_read_b64_tr_b16 v[208:209], v232 offset:16384
    ds_read_b64_tr_b16 v[210:211], v232 offset:20480
    v_mov_b32 v252, v250
    v_mov_b32 v253, v251
    s_nop 0
    v_permlane16_swap_b32 v250, v252
    s_waitcnt lgkmcnt(6)
    v_mfma_f32_16x16x32_bf16 v[4:7], v[196:199], v[96:99], v[4:7]
    v_permlane16_swap_b32 v251, v253
    v_add_f32 v250, v250, v252
    v_mfma_f32_16x16x32_bf16 v[12:15], v[196:199], v[104:107], v[12:15]
    ds_read_b64_tr_b16 v[212:213], v233 offset:16384
    ds_read_b64_tr_b16 v[214:215], v233 offset:20480
    v_add_f32 v251, v251, v253
    v_mov_b32 v252, v250
    v_mov_b32 v253, v251
    s_waitcnt lgkmcnt(6)
    v_mfma_f32_16x16x32_bf16 v[16:19], v[200:203], v[96:99], v[16:19]
    v_permlane32_swap_b32 v250, v252
    v_permlane32_swap_b32 v251, v253
    v_mfma_f32_16x16x32_bf16 v[24:27], v[200:203], v[104:107], v[24:27]
    ds_read_b64_tr_b16 v[216:217], v234 offset:16384
    ds_read_b64_tr_b16 v[218:219], v234 offset:20480
    v_add_f32 v250, v250, v252
    v_add_f32 v251, v251, v253
    v_rcp_f32 v250, v250
    s_waitcnt lgkmcnt(6)
    v_mfma_f32_16x16x32_bf16 v[20:23], v[204:207], v[96:99], v[20:23]
    v_rcp_f32 v251, v251
    v_max3_f32 v252, v64, v65, v66
    v_mfma_f32_16x16x32_bf16 v[28:31], v[204:207], v[104:107], v[28:31]
    ds_read_b64_tr_b16 v[220:221], v235 offset:16384
    ds_read_b64_tr_b16 v[222:223], v235 offset:20480
    v_max3_f32 v254, v72, v73, v74
    v_max3_f32 v252, v252, v67, v68
    v_max3_f32 v254, v254, v75, v76
    s_waitcnt lgkmcnt(6)
    v_mfma_f32_16x16x32_bf16 v[32:35], v[208:211], v[96:99], v[32:35]
    v_max3_f32 v252, v252, v69, v70
    v_max3_f32 v254, v254, v77, v78
    v_mfma_f32_16x16x32_bf16 v[40:43], v[208:211], v[104:107], v[40:43]
    ds_read_b64_tr_b16 v[192:193], v228 offset:24576
    ds_read_b64_tr_b16 v[194:195], v228 offset:28672
    v_max3_f32 v252, v252, v71, v80
    v_max3_f32 v254, v254, v79, v88
    v_max3_f32 v252, v252, v81, v82
    s_waitcnt lgkmcnt(6)
    v_mfma_f32_16x16x32_bf16 v[36:39], v[212:215], v[96:99], v[36:39]
    v_max3_f32 v254, v254, v89, v90
    v_max3_f32 v252, v252, v83, v84
    v_max3_f32 v254, v254, v91, v92
    v_mfma_f32_16x16x32_bf16 v[44:47], v[212:215], v[104:107], v[44:47]
    ds_read_b64_tr_b16 v[196:197], v229 offset:24576
    ds_read_b64_tr_b16 v[198:199], v229 offset:28672
    v_max3_f32 v252, v252, v85, v86
    v_max3_f32 v254, v254, v93, v94
    s_waitcnt lgkmcnt(6)
    v_mfma_f32_16x16x32_bf16 v[48:51], v[216:219], v[96:99], v[48:51]
    v_max_f32 v252, v252, v87
    v_max_f32 v254, v254, v95
    v_mov_b32 v253, v252
    v_mfma_f32_16x16x32_bf16 v[56:59], v[216:219], v[104:107], v[56:59]
    ds_read_b64_tr_b16 v[200:201], v230 offset:24576
    ds_read_b64_tr_b16 v[202:203], v230 offset:28672
    v_mov_b32 v255, v254
    v_permlane16_swap_b32 v252, v253
    s_waitcnt lgkmcnt(6)
    v_mfma_f32_16x16x32_bf16 v[52:55], v[220:223], v[96:99], v[52:55]
    v_permlane16_swap_b32 v254, v255
    v_max_f32 v252, v252, v253
    v_max_f32 v254, v254, v255
    v_mfma_f32_16x16x32_bf16 v[60:63], v[220:223], v[104:107], v[60:63]
    ds_read_b64_tr_b16 v[204:205], v231 offset:24576
    ds_read_b64_tr_b16 v[206:207], v231 offset:28672
    v_mov_b32 v253, v252
    v_mov_b32 v255, v254
    s_waitcnt lgkmcnt(6)
    v_mfma_f32_16x16x32_bf16 v[0:3], v[192:195], v[112:115], v[0:3]
    v_permlane32_swap_b32 v252, v253
    v_permlane32_swap_b32 v254, v255
    v_max_f32 v252, v252, v253
    v_mfma_f32_16x16x32_bf16 v[8:11], v[192:195], v[120:123], v[8:11]
    ds_read_b64_tr_b16 v[208:209], v232 offset:24576
    ds_read_b64_tr_b16 v[210:211], v232 offset:28672
    v_max_f32 v254, v254, v255
    v_sub_f32 v240, 0, v252
    s_waitcnt lgkmcnt(6)
    v_mfma_f32_16x16x32_bf16 v[4:7], v[196:199], v[112:115], v[4:7]
    v_sub_f32 v241, 0, v252
    v_sub_f32 v242, 0, v252
    v_sub_f32 v243, 0, v252
    v_mfma_f32_16x16x32_bf16 v[12:15], v[196:199], v[120:123], v[12:15]
    ds_read_b64_tr_b16 v[212:213], v233 offset:24576
    ds_read_b64_tr_b16 v[214:215], v233 offset:28672
    v_sub_f32 v244, 0, v254
    v_sub_f32 v245, 0, v254
    s_waitcnt lgkmcnt(6)
    v_mfma_f32_16x16x32_bf16 v[16:19], v[200:203], v[112:115], v[16:19]
    v_sub_f32 v246, 0, v254
    v_sub_f32 v247, 0, v254
    v_mfma_f32_16x16x32_bf16 v[24:27], v[200:203], v[120:123], v[24:27]
    ds_read_b64_tr_b16 v[216:217], v234 offset:24576
    ds_read_b64_tr_b16 v[218:219], v234 offset:28672
    v_add_f32 v64, v64, v241
    v_add_f32 v65, v65, v242
    v_exp_f32 v64, v64
    s_waitcnt lgkmcnt(6)
    v_mfma_f32_16x16x32_bf16 v[20:23], v[204:207], v[112:115], v[20:23]
    v_add_f32 v66, v66, v243
    v_exp_f32 v65, v65
    v_mfma_f32_16x16x32_bf16 v[28:31], v[204:207], v[120:123], v[28:31]
    ds_read_b64_tr_b16 v[220:221], v235 offset:24576
    ds_read_b64_tr_b16 v[222:223], v235 offset:28672
    v_add_f32 v67, v67, v240
    v_exp_f32 v66, v66
    v_add_f32 v68, v68, v241
    s_waitcnt lgkmcnt(6)
    v_mfma_f32_16x16x32_bf16 v[32:35], v[208:211], v[112:115], v[32:35]
    v_exp_f32 v67, v67
    v_add_f32 v252, v64, v65
    v_mfma_f32_16x16x32_bf16 v[40:43], v[208:211], v[120:123], v[40:43]
    ds_read_b128 v[192:195], v224 offset:16384
    v_cvt_pk_bf16_f32 v64, v64, v65
    v_add_f32 v69, v69, v242
    v_exp_f32 v68, v68
    s_waitcnt lgkmcnt(5)
    v_mfma_f32_16x16x32_bf16 v[36:39], v[212:215], v[112:115], v[36:39]
    v_add_f32 v70, v70, v243
    v_exp_f32 v69, v69
    v_mfma_f32_16x16x32_bf16 v[44:47], v[212:215], v[120:123], v[44:47]
    ds_read_b128 v[196:199], v225 offset:16384
    v_add_f32 v253, v66, v67
    v_cvt_pk_bf16_f32 v65, v66, v67
    v_add_f32 v71, v71, v240
    s_waitcnt lgkmcnt(4)
    v_mfma_f32_16x16x32_bf16 v[48:51], v[216:219], v[112:115], v[48:51]
    v_exp_f32 v70, v70
    v_add_f32 v252, v252, v68
    v_mfma_f32_16x16x32_bf16 v[56:59], v[216:219], v[120:123], v[56:59]
    ds_read_b128 v[200:203], v226 offset:16384
    v_add_f32 v72, v72, v245
    v_exp_f32 v71, v71
    v_add_f32 v252, v252, v69
    s_waitcnt lgkmcnt(3)
    v_mfma_f32_16x16x32_bf16 v[52:55], v[220:223], v[112:115], v[52:55]
    v_cvt_pk_bf16_f32 v66, v68, v69
    v_add_f32 v73, v73, v246
    v_mfma_f32_16x16x32_bf16 v[60:63], v[220:223], v[120:123], v[60:63]
    ds_read_b128 v[204:207], v227 offset:16384
    v_exp_f32 v72, v72
    v_add_f32 v253, v253, v70
    v_add_f32 v74, v74, v247
    s_waitcnt lgkmcnt(3)
    v_mfma_f32_16x16x32_bf16 v[96:99], v[192:195], v[128:131], v[240:243]
    v_exp_f32 v73, v73
    v_add_f32 v253, v253, v71
    v_cvt_pk_bf16_f32 v67, v70, v71
    v_mfma_f32_16x16x32_bf16 v[104:107], v[192:195], v[144:147], v[244:247]
    ds_read_b128 v[208:211], v224 offset:20480
    v_add_f32 v75, v75, v244
    v_exp_f32 v74, v74
    s_waitcnt lgkmcnt(3)
    v_mfma_f32_16x16x32_bf16 v[96:99], v[196:199], v[132:135], v[96:99]
    v_add_f32 v76, v76, v245
    v_exp_f32 v75, v75
    v_add_f32 v254, v72, v73
    v_xor_b32 v239, 64, v237
    v_mul_f32 v0, v0, v250
    v_mul_f32 v1, v1, v250
    v_mul_f32 v2, v2, v250
    v_mul_f32 v3, v3, v250
    v_mfma_f32_16x16x32_bf16 v[104:107], v[196:199], v[148:151], v[104:107]
    ds_read_b128 v[212:215], v225 offset:20480
    v_cvt_pk_bf16_f32 v72, v72, v73
    v_add_f32 v77, v77, v246
    v_mul_f32 v4, v4, v250
    v_mul_f32 v5, v5, v250
    v_mul_f32 v6, v6, v250
    v_mul_f32 v7, v7, v250
    v_cvt_pk_bf16_f32 v0, v0, v1
    v_cvt_pk_bf16_f32 v1, v2, v3
    s_waitcnt lgkmcnt(3)
    v_mfma_f32_16x16x32_bf16 v[96:99], v[200:203], v[136:139], v[96:99]
    v_exp_f32 v76, v76
    v_add_f32 v78, v78, v247
    v_exp_f32 v77, v77
    v_cvt_pk_bf16_f32 v2, v4, v5
    v_cvt_pk_bf16_f32 v3, v6, v7
    s_nop 0
    v_permlane16_swap_b32 v0, v2
    v_permlane16_swap_b32 v1, v3
    v_mul_f32 v16, v16, v250
    v_mfma_f32_16x16x32_bf16 v[104:107], v[200:203], v[152:155], v[104:107]
    ds_read_b128 v[216:219], v226 offset:20480
    v_add_f32 v255, v74, v75
    v_cvt_pk_bf16_f32 v73, v74, v75
    v_mul_f32 v17, v17, v250
    v_mul_f32 v18, v18, v250
    v_mul_f32 v19, v19, v250
    v_mul_f32 v20, v20, v250
    v_mul_f32 v21, v21, v250
    v_mul_f32 v22, v22, v250
    s_waitcnt lgkmcnt(3)
    v_mfma_f32_16x16x32_bf16 v[96:99], v[204:207], v[140:143], v[96:99]
    v_add_f32 v79, v79, v244
    v_exp_f32 v78, v78
    v_add_f32 v254, v254, v76
    v_mul_f32 v23, v23, v250
    v_cvt_pk_bf16_f32 v16, v16, v17
    v_cvt_pk_bf16_f32 v17, v18, v19
    v_cvt_pk_bf16_f32 v18, v20, v21
    v_cvt_pk_bf16_f32 v19, v22, v23
    s_nop 0
    v_permlane16_swap_b32 v16, v18
    v_mfma_f32_16x16x32_bf16 v[104:107], v[204:207], v[156:159], v[104:107]
    ds_read_b128 v[220:223], v227 offset:20480
    v_add_f32 v80, v80, v241
    v_exp_f32 v79, v79
    v_permlane16_swap_b32 v17, v19
    v_mov_b32_dpp v4, v16 row_ror:8 row_mask:0xf bank_mask:0xf
    s_nop 0
    v_mov_b32_dpp v5, v17 row_ror:8 row_mask:0xf bank_mask:0xf
    v_mov_b32_dpp v6, v18 row_ror:8 row_mask:0xf bank_mask:0xf
    v_mov_b32_dpp v7, v19 row_ror:8 row_mask:0xf bank_mask:0xf
    s_waitcnt lgkmcnt(3)
    v_mfma_f32_16x16x32_bf16 v[100:103], v[208:211], v[128:131], v[240:243]
    v_add_f32 v254, v254, v77
    v_cvt_pk_bf16_f32 v74, v76, v77
    v_add_f32 v81, v81, v242
    v_cndmask_b32 v16, v4, v0, s[96:97]
    v_cndmask_b32 v17, v5, v1, s[96:97]
    v_cndmask_b32 v18, v6, v2, s[96:97]
    v_cndmask_b32 v19, v7, v3, s[96:97]
    v_cndmask_b32 v0, v0, v4, s[96:97]
    v_cndmask_b32 v1, v1, v5, s[96:97]
    v_mfma_f32_16x16x32_bf16 v[108:111], v[208:211], v[144:147], v[244:247]
    ds_read_b128 v[192:195], v224 offset:24576
    v_exp_f32 v80, v80
    v_add_f32 v255, v255, v78
    v_cndmask_b32 v2, v2, v6, s[96:97]
    v_cndmask_b32 v3, v3, v7, s[96:97]
    buffer_store_dwordx4 v[0:3], v237, s[24:27], s34 offen offset:0 sc1
    buffer_store_dwordx4 v[16:19], v239, s[24:27], s34 offen offset:2048 sc1
    v_mul_f32 v8, v8, v251
    v_mul_f32 v9, v9, v251
    s_waitcnt lgkmcnt(3)
    v_mfma_f32_16x16x32_bf16 v[100:103], v[212:215], v[132:135], v[100:103]
    v_add_f32 v82, v82, v243
    v_exp_f32 v81, v81
    v_add_f32 v255, v255, v79
    v_mul_f32 v10, v10, v251
    v_mul_f32 v11, v11, v251
    v_mul_f32 v12, v12, v251
    v_mul_f32 v13, v13, v251
    v_mul_f32 v14, v14, v251
    v_mfma_f32_16x16x32_bf16 v[108:111], v[212:215], v[148:151], v[108:111]
    ds_read_b128 v[196:199], v225 offset:24576
    v_cvt_pk_bf16_f32 v75, v78, v79
    v_add_f32 v83, v83, v240
    v_exp_f32 v82, v82
    v_mul_f32 v15, v15, v251
    v_cvt_pk_bf16_f32 v8, v8, v9
    v_cvt_pk_bf16_f32 v9, v10, v11
    v_cvt_pk_bf16_f32 v10, v12, v13
    v_cvt_pk_bf16_f32 v11, v14, v15
    s_nop 0
    v_permlane16_swap_b32 v8, v10
    s_waitcnt lgkmcnt(3)
    v_mfma_f32_16x16x32_bf16 v[100:103], v[216:219], v[136:139], v[100:103]
    v_add_f32 v252, v252, v80
    v_add_f32 v84, v84, v241
    v_permlane16_swap_b32 v9, v11
    v_mul_f32 v24, v24, v251
    v_mul_f32 v25, v25, v251
    v_mul_f32 v26, v26, v251
    v_mul_f32 v27, v27, v251
    v_mfma_f32_16x16x32_bf16 v[108:111], v[216:219], v[152:155], v[108:111]
    ds_read_b128 v[200:203], v226 offset:24576
    v_exp_f32 v83, v83
    v_add_f32 v252, v252, v81
    v_cvt_pk_bf16_f32 v80, v80, v81
    v_mul_f32 v28, v28, v251
    v_mul_f32 v29, v29, v251
    v_mul_f32 v30, v30, v251
    v_mul_f32 v31, v31, v251
    v_cvt_pk_bf16_f32 v24, v24, v25
    v_cvt_pk_bf16_f32 v25, v26, v27
    s_waitcnt lgkmcnt(3)
    v_mfma_f32_16x16x32_bf16 v[100:103], v[220:223], v[140:143], v[100:103]
    v_add_f32 v85, v85, v242
    v_exp_f32 v84, v84
    v_cvt_pk_bf16_f32 v26, v28, v29
    v_cvt_pk_bf16_f32 v27, v30, v31
    s_nop 0
    v_permlane16_swap_b32 v24, v26
    v_permlane16_swap_b32 v25, v27
    s_nop 0
    v_mov_b32_dpp v12, v24 row_ror:8 row_mask:0xf bank_mask:0xf
    v_mov_b32_dpp v13, v25 row_ror:8 row_mask:0xf bank_mask:0xf
    v_mfma_f32_16x16x32_bf16 v[108:111], v[220:223], v[156:159], v[108:111]
    ds_read_b128 v[204:207], v227 offset:24576
    v_add_f32 v253, v253, v82
    v_add_f32 v86, v86, v243
    v_exp_f32 v85, v85
    v_mov_b32_dpp v14, v26 row_ror:8 row_mask:0xf bank_mask:0xf
    v_mov_b32_dpp v15, v27 row_ror:8 row_mask:0xf bank_mask:0xf
    v_cndmask_b32 v24, v12, v8, s[96:97]
    v_cndmask_b32 v25, v13, v9, s[96:97]
    v_cndmask_b32 v26, v14, v10, s[96:97]
    s_waitcnt lgkmcnt(3)
    v_mfma_f32_16x16x32_bf16 v[112:115], v[192:195], v[128:131], v[240:243]
    v_add_f32 v253, v253, v83
    v_cvt_pk_bf16_f32 v81, v82, v83
    v_cndmask_b32 v27, v15, v11, s[96:97]
    v_cndmask_b32 v8, v8, v12, s[96:97]
    v_cndmask_b32 v9, v9, v13, s[96:97]
    v_cndmask_b32 v10, v10, v14, s[96:97]
    v_cndmask_b32 v11, v11, v15, s[96:97]
    buffer_store_dwordx4 v[8:11], v237, s[24:27], s94 offen offset:0 sc1
    v_mfma_f32_16x16x32_bf16 v[120:123], v[192:195], v[144:147], v[244:247]
    ds_read_b128 v[208:211], v224 offset:28672
    v_add_f32 v87, v87, v240
    v_exp_f32 v86, v86
    v_add_f32 v252, v252, v84
    buffer_store_dwordx4 v[24:27], v239, s[24:27], s94 offen offset:2048 sc1
    v_mul_f32 v32, v32, v250
    v_mul_f32 v33, v33, v250
    v_mul_f32 v34, v34, v250
    v_mul_f32 v35, v35, v250
    v_mul_f32 v36, v36, v250
    s_waitcnt lgkmcnt(3)
    v_mfma_f32_16x16x32_bf16 v[112:115], v[196:199], v[132:135], v[112:115]
    v_add_f32 v88, v88, v245
    v_exp_f32 v87, v87
    v_mul_f32 v37, v37, v250
    v_mul_f32 v38, v38, v250
    v_mul_f32 v39, v39, v250
    v_cvt_pk_bf16_f32 v32, v32, v33
    v_cvt_pk_bf16_f32 v33, v34, v35
    v_mfma_f32_16x16x32_bf16 v[120:123], v[196:199], v[148:151], v[120:123]
    ds_read_b128 v[212:215], v225 offset:28672
    v_add_f32 v252, v252, v85
    v_cvt_pk_bf16_f32 v82, v84, v85
    v_add_f32 v89, v89, v246
    v_cvt_pk_bf16_f32 v34, v36, v37
    v_cvt_pk_bf16_f32 v35, v38, v39
    s_nop 0
    v_permlane16_swap_b32 v32, v34
    v_permlane16_swap_b32 v33, v35
    v_mul_f32 v48, v48, v250
    v_mul_f32 v49, v49, v250
    s_waitcnt lgkmcnt(3)
    v_mfma_f32_16x16x32_bf16 v[112:115], v[200:203], v[136:139], v[112:115]
    v_exp_f32 v88, v88
    v_add_f32 v253, v253, v86
    v_mul_f32 v50, v50, v250
    v_mul_f32 v51, v51, v250
    v_mul_f32 v52, v52, v250
    v_mul_f32 v53, v53, v250
    v_mul_f32 v54, v54, v250
    v_mul_f32 v55, v55, v250
    v_mfma_f32_16x16x32_bf16 v[120:123], v[200:203], v[152:155], v[120:123]
    ds_read_b128 v[216:219], v226 offset:28672
    v_add_f32 v90, v90, v247
    v_exp_f32 v89, v89
    v_add_f32 v253, v253, v87
    v_cvt_pk_bf16_f32 v48, v48, v49
    v_cvt_pk_bf16_f32 v49, v50, v51
    v_cvt_pk_bf16_f32 v50, v52, v53
    v_cvt_pk_bf16_f32 v51, v54, v55
    s_nop 0
    v_permlane16_swap_b32 v48, v50
    s_waitcnt lgkmcnt(3)
    v_mfma_f32_16x16x32_bf16 v[112:115], v[204:207], v[140:143], v[112:115]
    v_cvt_pk_bf16_f32 v83, v86, v87
    v_add_f32 v91, v91, v244
    v_exp_f32 v90, v90
    v_permlane16_swap_b32 v49, v51
    v_mov_b32_dpp v36, v48 row_ror:8 row_mask:0xf bank_mask:0xf
    s_nop 0
    v_mov_b32_dpp v37, v49 row_ror:8 row_mask:0xf bank_mask:0xf
    v_mov_b32_dpp v38, v50 row_ror:8 row_mask:0xf bank_mask:0xf
    v_mov_b32_dpp v39, v51 row_ror:8 row_mask:0xf bank_mask:0xf
    v_cndmask_b32 v48, v36, v32, s[96:97]
    v_mfma_f32_16x16x32_bf16 v[120:123], v[204:207], v[156:159], v[120:123]
    ds_read_b128 v[220:223], v227 offset:28672
    v_add_f32 v254, v254, v88
    v_add_f32 v92, v92, v245
    v_cndmask_b32 v49, v37, v33, s[96:97]
    v_cndmask_b32 v50, v38, v34, s[96:97]
    v_cndmask_b32 v51, v39, v35, s[96:97]
    v_cndmask_b32 v32, v32, v36, s[96:97]
    v_cndmask_b32 v33, v33, v37, s[96:97]
    s_waitcnt lgkmcnt(3)
    v_mfma_f32_16x16x32_bf16 v[116:119], v[208:211], v[128:131], v[240:243]
    v_exp_f32 v91, v91
    v_add_f32 v254, v254, v89
    v_cvt_pk_bf16_f32 v88, v88, v89
    v_cndmask_b32 v34, v34, v38, s[96:97]
    v_cndmask_b32 v35, v35, v39, s[96:97]
    buffer_store_dwordx4 v[32:35], v237, s[24:27], s34 offen offset:128 sc1
    buffer_store_dwordx4 v[48:51], v239, s[24:27], s34 offen offset:2176 sc1
    v_mul_f32 v40, v40, v251
    v_mul_f32 v41, v41, v251
    v_mfma_f32_16x16x32_bf16 v[124:127], v[208:211], v[144:147], v[244:247]
    s_waitcnt vmcnt(6)
    s_barrier
    s_add_u32 m0, s81, 0
    s_add_u32 s38, s83, 0
    buffer_load_dwordx4 v238, s[20:23], s38 offen nt lds
    s_add_u32 m0, s81, 8192
    s_add_u32 s38, s83, 8192
    buffer_load_dwordx4 v238, s[20:23], s38 offen nt lds
    s_add_u32 m0, s81, 16384
    s_add_u32 s38, s83, 16384
    buffer_load_dwordx4 v238, s[20:23], s38 offen nt lds
    s_add_u32 m0, s81, 24576
    s_add_u32 s38, s83, 24576
    buffer_load_dwordx4 v238, s[20:23], s38 offen nt lds
    v_add_u32 v228, s86, v228
    ds_read_b64_tr_b16 v[192:193], v228 offset:0
    ds_read_b64_tr_b16 v[194:195], v228 offset:4096
    v_add_f32 v93, v93, v246
    v_exp_f32 v92, v92
    v_mul_f32 v42, v42, v251
    v_mul_f32 v43, v43, v251
    v_mul_f32 v44, v44, v251
    v_mul_f32 v45, v45, v251
    v_mul_f32 v46, v46, v251
    v_mul_f32 v47, v47, v251
    s_waitcnt lgkmcnt(4)
    v_mfma_f32_16x16x32_bf16 v[116:119], v[212:215], v[132:135], v[116:119]
    v_add_f32 v255, v255, v90
    v_add_f32 v94, v94, v247
    v_exp_f32 v93, v93
    v_cvt_pk_bf16_f32 v40, v40, v41
    v_cvt_pk_bf16_f32 v41, v42, v43
    v_cvt_pk_bf16_f32 v42, v44, v45
    v_cvt_pk_bf16_f32 v43, v46, v47
    s_nop 0
    v_permlane16_swap_b32 v40, v42
    v_mfma_f32_16x16x32_bf16 v[124:127], v[212:215], v[148:151], v[124:127]
    v_add_u32 v229, s86, v229
    ds_read_b64_tr_b16 v[196:197], v229 offset:0
    ds_read_b64_tr_b16 v[198:199], v229 offset:4096
    v_add_f32 v255, v255, v91
    v_cvt_pk_bf16_f32 v89, v90, v91
    v_permlane16_swap_b32 v41, v43
    v_mul_f32 v56, v56, v251
    v_mul_f32 v57, v57, v251
    v_mul_f32 v58, v58, v251
    v_mul_f32 v59, v59, v251
    v_mul_f32 v60, v60, v251
    s_waitcnt lgkmcnt(5)
    v_mfma_f32_16x16x32_bf16 v[116:119], v[216:219], v[136:139], v[116:119]
    v_add_f32 v95, v95, v244
    v_exp_f32 v94, v94
    v_add_f32 v254, v254, v92
    v_mul_f32 v61, v61, v251
    v_mul_f32 v62, v62, v251
    v_mul_f32 v63, v63, v251
    v_cvt_pk_bf16_f32 v56, v56, v57
    v_cvt_pk_bf16_f32 v57, v58, v59
    v_cvt_pk_bf16_f32 v58, v60, v61
    v_mfma_f32_16x16x32_bf16 v[124:127], v[216:219], v[152:155], v[124:127]
    v_add_u32 v230, s86, v230
    ds_read_b64_tr_b16 v[200:201], v230 offset:0
    ds_read_b64_tr_b16 v[202:203], v230 offset:4096
    v_exp_f32 v95, v95
    v_add_f32 v254, v254, v93
    v_cvt_pk_bf16_f32 v59, v62, v63
    v_permlane16_swap_b32 v56, v58
    s_nop 0
    v_permlane16_swap_b32 v57, v59
    v_mov_b32_dpp v44, v56 row_ror:8 row_mask:0xf bank_mask:0xf
    s_nop 0
    v_mov_b32_dpp v45, v57 row_ror:8 row_mask:0xf bank_mask:0xf
    s_waitcnt lgkmcnt(6)
    v_mfma_f32_16x16x32_bf16 v[116:119], v[220:223], v[140:143], v[116:119]
    v_cvt_pk_bf16_f32 v90, v92, v93
    v_add_f32 v255, v255, v94
    v_add_f32 v255, v255, v95
    v_mov_b32_dpp v46, v58 row_ror:8 row_mask:0xf bank_mask:0xf
    v_mov_b32_dpp v47, v59 row_ror:8 row_mask:0xf bank_mask:0xf
    v_cndmask_b32 v56, v44, v40, s[96:97]
    v_cndmask_b32 v57, v45, v41, s[96:97]
    v_cndmask_b32 v58, v46, v42, s[96:97]
    v_cndmask_b32 v59, v47, v43, s[96:97]
    v_mfma_f32_16x16x32_bf16 v[124:127], v[220:223], v[156:159], v[124:127]
    v_add_u32 v231, s86, v231
    ds_read_b64_tr_b16 v[204:205], v231 offset:0
    ds_read_b64_tr_b16 v[206:207], v231 offset:4096
    v_cvt_pk_bf16_f32 v91, v94, v95
    v_add_f32 v252, v252, v253
    v_add_f32 v254, v254, v255
    v_cndmask_b32 v40, v40, v44, s[96:97]
    v_cndmask_b32 v41, v41, v45, s[96:97]
    v_cndmask_b32 v42, v42, v46, s[96:97]
    v_cndmask_b32 v43, v43, v47, s[96:97]
    buffer_store_dwordx4 v[40:43], v237, s[24:27], s94 offen offset:128 sc1
    buffer_store_dwordx4 v[56:59], v239, s[24:27], s94 offen offset:2176 sc1
    v_mov_b32 v248, v252
    v_mov_b32 v249, v254
    s_waitcnt lgkmcnt(6)
    v_mfma_f32_16x16x32_bf16 v[0:3], v[192:195], v[64:67], 0
    v_exp_f32 v96, v96
    v_mfma_f32_16x16x32_bf16 v[8:11], v[192:195], v[72:75], 0
    v_add_u32 v232, s86, v232
    ds_read_b64_tr_b16 v[208:209], v232 offset:0
    ds_read_b64_tr_b16 v[210:211], v232 offset:4096
    v_exp_f32 v97, v97
    s_waitcnt lgkmcnt(6)
    v_mfma_f32_16x16x32_bf16 v[4:7], v[196:199], v[64:67], 0
    v_exp_f32 v98, v98
    v_mfma_f32_16x16x32_bf16 v[12:15], v[196:199], v[72:75], 0
    v_add_u32 v233, s86, v233
    ds_read_b64_tr_b16 v[212:213], v233 offset:0
    ds_read_b64_tr_b16 v[214:215], v233 offset:4096
    v_exp_f32 v99, v99
    s_waitcnt lgkmcnt(6)
    v_mfma_f32_16x16x32_bf16 v[16:19], v[200:203], v[64:67], 0
    v_add_f32 v252, v96, v97
    v_cvt_pk_bf16_f32 v96, v96, v97
    v_mfma_f32_16x16x32_bf16 v[24:27], v[200:203], v[72:75], 0
    v_add_u32 v234, s86, v234
    ds_read_b64_tr_b16 v[216:217], v234 offset:0
    ds_read_b64_tr_b16 v[218:219], v234 offset:4096
    v_exp_f32 v100, v100
    s_waitcnt lgkmcnt(6)
    v_mfma_f32_16x16x32_bf16 v[20:23], v[204:207], v[64:67], 0
    v_exp_f32 v101, v101
    v_mfma_f32_16x16x32_bf16 v[28:31], v[204:207], v[72:75], 0
    v_add_u32 v235, s86, v235
    ds_read_b64_tr_b16 v[220:221], v235 offset:0
    ds_read_b64_tr_b16 v[222:223], v235 offset:4096
    v_add_f32 v253, v98, v99
    s_waitcnt lgkmcnt(6)
    v_mfma_f32_16x16x32_bf16 v[32:35], v[208:211], v[64:67], 0
    v_cvt_pk_bf16_f32 v97, v98, v99
    v_mfma_f32_16x16x32_bf16 v[40:43], v[208:211], v[72:75], 0
    ds_read_b64_tr_b16 v[192:193], v228 offset:8192
    ds_read_b64_tr_b16 v[194:195], v228 offset:12288
    v_exp_f32 v102, v102
    v_add_f32 v252, v252, v100
    s_waitcnt lgkmcnt(6)
    v_mfma_f32_16x16x32_bf16 v[36:39], v[212:215], v[64:67], 0
    v_exp_f32 v103, v103
    v_mfma_f32_16x16x32_bf16 v[44:47], v[212:215], v[72:75], 0
    ds_read_b64_tr_b16 v[196:197], v229 offset:8192
    ds_read_b64_tr_b16 v[198:199], v229 offset:12288
    v_add_f32 v252, v252, v101
    s_waitcnt lgkmcnt(6)
    v_mfma_f32_16x16x32_bf16 v[48:51], v[216:219], v[64:67], 0
    v_cvt_pk_bf16_f32 v98, v100, v101
    v_mfma_f32_16x16x32_bf16 v[56:59], v[216:219], v[72:75], 0
    ds_read_b64_tr_b16 v[200:201], v230 offset:8192
    ds_read_b64_tr_b16 v[202:203], v230 offset:12288
    v_exp_f32 v104, v104
    v_add_f32 v253, v253, v102
    s_waitcnt lgkmcnt(6)
    v_mfma_f32_16x16x32_bf16 v[52:55], v[220:223], v[64:67], 0
    v_exp_f32 v105, v105
    v_mfma_f32_16x16x32_bf16 v[60:63], v[220:223], v[72:75], 0
    ds_read_b64_tr_b16 v[204:205], v231 offset:8192
    ds_read_b64_tr_b16 v[206:207], v231 offset:12288
    v_add_f32 v253, v253, v103
    s_waitcnt lgkmcnt(6)
    v_mfma_f32_16x16x32_bf16 v[0:3], v[192:195], v[80:83], v[0:3]
    v_cvt_pk_bf16_f32 v99, v102, v103
    v_mfma_f32_16x16x32_bf16 v[8:11], v[192:195], v[88:91], v[8:11]
    ds_read_b64_tr_b16 v[208:209], v232 offset:8192
    ds_read_b64_tr_b16 v[210:211], v232 offset:12288
    v_exp_f32 v106, v106
    s_waitcnt lgkmcnt(6)
    v_mfma_f32_16x16x32_bf16 v[4:7], v[196:199], v[80:83], v[4:7]
    v_exp_f32 v107, v107
    v_add_f32 v254, v104, v105
    v_mfma_f32_16x16x32_bf16 v[12:15], v[196:199], v[88:91], v[12:15]
    ds_read_b64_tr_b16 v[212:213], v233 offset:8192
    ds_read_b64_tr_b16 v[214:215], v233 offset:12288
    v_cvt_pk_bf16_f32 v104, v104, v105
    s_waitcnt lgkmcnt(6)
    v_mfma_f32_16x16x32_bf16 v[16:19], v[200:203], v[80:83], v[16:19]
    v_exp_f32 v108, v108
    v_mfma_f32_16x16x32_bf16 v[24:27], v[200:203], v[88:91], v[24:27]
    ds_read_b64_tr_b16 v[216:217], v234 offset:8192
    ds_read_b64_tr_b16 v[218:219], v234 offset:12288
    v_exp_f32 v109, v109
    s_waitcnt lgkmcnt(6)
    v_mfma_f32_16x16x32_bf16 v[20:23], v[204:207], v[80:83], v[20:23]
    v_add_f32 v255, v106, v107
    v_cvt_pk_bf16_f32 v105, v106, v107
    v_mfma_f32_16x16x32_bf16 v[28:31], v[204:207], v[88:91], v[28:31]
    ds_read_b64_tr_b16 v[220:221], v235 offset:8192
    ds_read_b64_tr_b16 v[222:223], v235 offset:12288
    v_exp_f32 v110, v110
    s_waitcnt lgkmcnt(6)
    v_mfma_f32_16x16x32_bf16 v[32:35], v[208:211], v[80:83], v[32:35]
    v_add_f32 v254, v254, v108
    v_mfma_f32_16x16x32_bf16 v[40:43], v[208:211], v[88:91], v[40:43]
    v_add_u32 v224, s45, v224
    ds_read_b128 v[192:195], v224 offset:0
    v_exp_f32 v111, v111
    s_waitcnt lgkmcnt(5)
    v_mfma_f32_16x16x32_bf16 v[36:39], v[212:215], v[80:83], v[36:39]
    v_add_f32 v254, v254, v109
    v_mfma_f32_16x16x32_bf16 v[44:47], v[212:215], v[88:91], v[44:47]
    v_add_u32 v225, s45, v225
    ds_read_b128 v[196:199], v225 offset:0
    v_cvt_pk_bf16_f32 v106, v108, v109
    v_exp_f32 v112, v112
    s_waitcnt lgkmcnt(4)
    v_mfma_f32_16x16x32_bf16 v[48:51], v[216:219], v[80:83], v[48:51]
    v_add_f32 v255, v255, v110
    v_mfma_f32_16x16x32_bf16 v[56:59], v[216:219], v[88:91], v[56:59]
    v_add_u32 v226, s45, v226
    ds_read_b128 v[200:203], v226 offset:0
    v_exp_f32 v113, v113
    s_waitcnt lgkmcnt(3)
    v_mfma_f32_16x16x32_bf16 v[52:55], v[220:223], v[80:83], v[52:55]
    v_add_f32 v255, v255, v111
    v_mfma_f32_16x16x32_bf16 v[60:63], v[220:223], v[88:91], v[60:63]
    v_add_u32 v227, s45, v227
    ds_read_b128 v[204:207], v227 offset:0
    v_cvt_pk_bf16_f32 v107, v110, v111
    v_exp_f32 v114, v114
    s_waitcnt lgkmcnt(3)
    v_mfma_f32_16x16x32_bf16 v[64:67], v[192:195], v[128:131], v[240:243]
    v_add_f32 v252, v252, v112
    v_mfma_f32_16x16x32_bf16 v[72:75], v[192:195], v[144:147], v[244:247]
    ds_read_b128 v[208:211], v224 offset:4096
    v_exp_f32 v115, v115
    s_waitcnt lgkmcnt(3)
    v_mfma_f32_16x16x32_bf16 v[64:67], v[196:199], v[132:135], v[64:67]
    v_add_f32 v252, v252, v113
    v_mfma_f32_16x16x32_bf16 v[72:75], v[196:199], v[148:151], v[72:75]
    ds_read_b128 v[212:215], v225 offset:4096
    v_cvt_pk_bf16_f32 v112, v112, v113
    s_waitcnt lgkmcnt(3)
    v_mfma_f32_16x16x32_bf16 v[64:67], v[200:203], v[136:139], v[64:67]
    v_exp_f32 v116, v116
    v_add_f32 v253, v253, v114
    v_mfma_f32_16x16x32_bf16 v[72:75], v[200:203], v[152:155], v[72:75]
    ds_read_b128 v[216:219], v226 offset:4096
    v_exp_f32 v117, v117
    s_waitcnt lgkmcnt(3)
    v_mfma_f32_16x16x32_bf16 v[64:67], v[204:207], v[140:143], v[64:67]
    v_add_f32 v253, v253, v115
    v_mfma_f32_16x16x32_bf16 v[72:75], v[204:207], v[156:159], v[72:75]
    ds_read_b128 v[220:223], v227 offset:4096
    v_cvt_pk_bf16_f32 v113, v114, v115
    s_waitcnt lgkmcnt(3)
    v_mfma_f32_16x16x32_bf16 v[68:71], v[208:211], v[128:131], v[240:243]
    v_exp_f32 v118, v118
    v_mfma_f32_16x16x32_bf16 v[76:79], v[208:211], v[144:147], v[244:247]
    ds_read_b128 v[192:195], v224 offset:8192
    v_add_f32 v252, v252, v116
    v_exp_f32 v119, v119
    s_waitcnt lgkmcnt(3)
    v_mfma_f32_16x16x32_bf16 v[68:71], v[212:215], v[132:135], v[68:71]
    v_add_f32 v252, v252, v117
    v_mfma_f32_16x16x32_bf16 v[76:79], v[212:215], v[148:151], v[76:79]
    ds_read_b128 v[196:199], v225 offset:8192
    v_cvt_pk_bf16_f32 v114, v116, v117
    s_waitcnt lgkmcnt(3)
    v_mfma_f32_16x16x32_bf16 v[68:71], v[216:219], v[136:139], v[68:71]
    v_exp_f32 v120, v120
    v_mfma_f32_16x16x32_bf16 v[76:79], v[216:219], v[152:155], v[76:79]
    ds_read_b128 v[200:203], v226 offset:8192
    v_add_f32 v253, v253, v118
    v_exp_f32 v121, v121
    s_waitcnt lgkmcnt(3)
    v_mfma_f32_16x16x32_bf16 v[68:71], v[220:223], v[140:143], v[68:71]
    v_add_f32 v253, v253, v119
    v_mfma_f32_16x16x32_bf16 v[76:79], v[220:223], v[156:159], v[76:79]
    ds_read_b128 v[204:207], v227 offset:8192
    v_cvt_pk_bf16_f32 v115, v118, v119
    s_waitcnt lgkmcnt(3)
    v_mfma_f32_16x16x32_bf16 v[80:83], v[192:195], v[128:131], v[240:243]
    v_exp_f32 v122, v122
    v_mfma_f32_16x16x32_bf16 v[88:91], v[192:195], v[144:147], v[244:247]
    ds_read_b128 v[208:211], v224 offset:12288
    v_add_f32 v254, v254, v120
    s_waitcnt lgkmcnt(3)
    v_mfma_f32_16x16x32_bf16 v[80:83], v[196:199], v[132:135], v[80:83]
    v_exp_f32 v123, v123
    v_add_f32 v254, v254, v121
    v_mfma_f32_16x16x32_bf16 v[88:91], v[196:199], v[148:151], v[88:91]
    ds_read_b128 v[212:215], v225 offset:12288
    v_cvt_pk_bf16_f32 v120, v120, v121
    s_waitcnt lgkmcnt(3)
    v_mfma_f32_16x16x32_bf16 v[80:83], v[200:203], v[136:139], v[80:83]
    v_exp_f32 v124, v124
    v_mfma_f32_16x16x32_bf16 v[88:91], v[200:203], v[152:155], v[88:91]
    ds_read_b128 v[216:219], v226 offset:12288
    v_add_f32 v255, v255, v122
    s_waitcnt lgkmcnt(3)
    v_mfma_f32_16x16x32_bf16 v[80:83], v[204:207], v[140:143], v[80:83]
    v_exp_f32 v125, v125
    v_add_f32 v255, v255, v123
    v_mfma_f32_16x16x32_bf16 v[88:91], v[204:207], v[156:159], v[88:91]
    ds_read_b128 v[220:223], v227 offset:12288
    v_cvt_pk_bf16_f32 v121, v122, v123
    s_waitcnt lgkmcnt(3)
    v_mfma_f32_16x16x32_bf16 v[84:87], v[208:211], v[128:131], v[240:243]
    v_exp_f32 v126, v126
    v_mfma_f32_16x16x32_bf16 v[92:95], v[208:211], v[144:147], v[244:247]
    ds_read_b64_tr_b16 v[192:193], v228 offset:16384
    ds_read_b64_tr_b16 v[194:195], v228 offset:20480
    v_add_f32 v254, v254, v124
    s_waitcnt lgkmcnt(4)
    v_mfma_f32_16x16x32_bf16 v[84:87], v[212:215], v[132:135], v[84:87]
    v_exp_f32 v127, v127
    v_mfma_f32_16x16x32_bf16 v[92:95], v[212:215], v[148:151], v[92:95]
    ds_read_b64_tr_b16 v[196:197], v229 offset:16384
    ds_read_b64_tr_b16 v[198:199], v229 offset:20480
    v_add_f32 v254, v254, v125
    v_cvt_pk_bf16_f32 v122, v124, v125
    s_waitcnt lgkmcnt(5)
    v_mfma_f32_16x16x32_bf16 v[84:87], v[216:219], v[136:139], v[84:87]
    v_add_f32 v255, v255, v126
    v_mfma_f32_16x16x32_bf16 v[92:95], v[216:219], v[152:155], v[92:95]
    ds_read_b64_tr_b16 v[200:201], v230 offset:16384
    ds_read_b64_tr_b16 v[202:203], v230 offset:20480
    v_add_f32 v255, v255, v127
    s_waitcnt lgkmcnt(6)
    v_mfma_f32_16x16x32_bf16 v[84:87], v[220:223], v[140:143], v[84:87]
    v_cvt_pk_bf16_f32 v123, v126, v127
    v_mfma_f32_16x16x32_bf16 v[92:95], v[220:223], v[156:159], v[92:95]
    ds_read_b64_tr_b16 v[204:205], v231 offset:16384
    ds_read_b64_tr_b16 v[206:207], v231 offset:20480
    v_add_f32 v252, v252, v253
    v_add_f32 v254, v254, v255
    v_max_f32 v239, v252, v254
    v_cmp_lt_f32 vcc, 0x46800000, v239
    s_cbranch_vccnz L_slow_2_1
L_back_2_1:
    v_add_f32 v248, v248, v252
    v_add_f32 v249, v249, v254
    s_waitcnt lgkmcnt(6)
    v_mfma_f32_16x16x32_bf16 v[0:3], v[192:195], v[96:99], v[0:3]
    v_exp_f32 v64, v64
    v_mfma_f32_16x16x32_bf16 v[8:11], v[192:195], v[104:107], v[8:11]
    ds_read_b64_tr_b16 v[208:209], v232 offset:16384
    ds_read_b64_tr_b16 v[210:211], v232 offset:20480
    v_exp_f32 v65, v65
    s_waitcnt lgkmcnt(6)
    v_mfma_f32_16x16x32_bf16 v[4:7], v[196:199], v[96:99], v[4:7]
    v_exp_f32 v66, v66
    v_mfma_f32_16x16x32_bf16 v[12:15], v[196:199], v[104:107], v[12:15]
    ds_read_b64_tr_b16 v[212:213], v233 offset:16384
    ds_read_b64_tr_b16 v[214:215], v233 offset:20480
    v_exp_f32 v67, v67
    s_waitcnt lgkmcnt(6)
    v_mfma_f32_16x16x32_bf16 v[16:19], v[200:203], v[96:99], v[16:19]
    v_add_f32 v252, v64, v65
    v_cvt_pk_bf16_f32 v64, v64, v65
    v_mfma_f32_16x16x32_bf16 v[24:27], v[200:203], v[104:107], v[24:27]
    ds_read_b64_tr_b16 v[216:217], v234 offset:16384
    ds_read_b64_tr_b16 v[218:219], v234 offset:20480
    v_exp_f32 v68, v68
    s_waitcnt lgkmcnt(6)
    v_mfma_f32_16x16x32_bf16 v[20:23], v[204:207], v[96:99], v[20:23]
    v_exp_f32 v69, v69
    v_mfma_f32_16x16x32_bf16 v[28:31], v[204:207], v[104:107], v[28:31]
    ds_read_b64_tr_b16 v[220:221], v235 offset:16384
    ds_read_b64_tr_b16 v[222:223], v235 offset:20480
    v_add_f32 v253, v66, v67
    s_waitcnt lgkmcnt(6)
    v_mfma_f32_16x16x32_bf16 v[32:35], v[208:211], v[96:99], v[32:35]
    v_cvt_pk_bf16_f32 v65, v66, v67
    v_mfma_f32_16x16x32_bf16 v[40:43], v[208:211], v[104:107], v[40:43]
    ds_read_b64_tr_b16 v[192:193], v228 offset:24576
    ds_read_b64_tr_b16 v[194:195], v228 offset:28672
    v_exp_f32 v70, v70
    v_add_f32 v252, v252, v68
    s_waitcnt lgkmcnt(6)
    v_mfma_f32_16x16x32_bf16 v[36:39], v[212:215], v[96:99], v[36:39]
    v_exp_f32 v71, v71
    v_mfma_f32_16x16x32_bf16 v[44:47], v[212:215], v[104:107], v[44:47]
    ds_read_b64_tr_b16 v[196:197], v229 offset:24576
    ds_read_b64_tr_b16 v[198:199], v229 offset:28672
    v_add_f32 v252, v252, v69
    s_waitcnt lgkmcnt(6)
    v_mfma_f32_16x16x32_bf16 v[48:51], v[216:219], v[96:99], v[48:51]
    v_cvt_pk_bf16_f32 v66, v68, v69
    v_mfma_f32_16x16x32_bf16 v[56:59], v[216:219], v[104:107], v[56:59]
    ds_read_b64_tr_b16 v[200:201], v230 offset:24576
    ds_read_b64_tr_b16 v[202:203], v230 offset:28672
    v_exp_f32 v72, v72
    v_add_f32 v253, v253, v70
    s_waitcnt lgkmcnt(6)
    v_mfma_f32_16x16x32_bf16 v[52:55], v[220:223], v[96:99], v[52:55]
    v_exp_f32 v73, v73
    v_mfma_f32_16x16x32_bf16 v[60:63], v[220:223], v[104:107], v[60:63]
    ds_read_b64_tr_b16 v[204:205], v231 offset:24576
    ds_read_b64_tr_b16 v[206:207], v231 offset:28672
    v_add_f32 v253, v253, v71
    s_waitcnt lgkmcnt(6)
    v_mfma_f32_16x16x32_bf16 v[0:3], v[192:195], v[112:115], v[0:3]
    v_cvt_pk_bf16_f32 v67, v70, v71
    v_mfma_f32_16x16x32_bf16 v[8:11], v[192:195], v[120:123], v[8:11]
    ds_read_b64_tr_b16 v[208:209], v232 offset:24576
    ds_read_b64_tr_b16 v[210:211], v232 offset:28672
    v_exp_f32 v74, v74
    s_waitcnt lgkmcnt(6)
    v_mfma_f32_16x16x32_bf16 v[4:7], v[196:199], v[112:115], v[4:7]
    v_exp_f32 v75, v75
    v_add_f32 v254, v72, v73
    v_mfma_f32_16x16x32_bf16 v[12:15], v[196:199], v[120:123], v[12:15]
    ds_read_b64_tr_b16 v[212:213], v233 offset:24576
    ds_read_b64_tr_b16 v[214:215], v233 offset:28672
    v_cvt_pk_bf16_f32 v72, v72, v73
    s_waitcnt lgkmcnt(6)
    v_mfma_f32_16x16x32_bf16 v[16:19], v[200:203], v[112:115], v[16:19]
    v_exp_f32 v76, v76
    v_mfma_f32_16x16x32_bf16 v[24:27], v[200:203], v[120:123], v[24:27]
    ds_read_b64_tr_b16 v[216:217], v234 offset:24576
    ds_read_b64_tr_b16 v[218:219], v234 offset:28672
    v_exp_f32 v77, v77
    s_waitcnt lgkmcnt(6)
    v_mfma_f32_16x16x32_bf16 v[20:23], v[204:207], v[112:115], v[20:23]
    v_add_f32 v255, v74, v75
    v_cvt_pk_bf16_f32 v73, v74, v75
    v_mfma_f32_16x16x32_bf16 v[28:31], v[204:207], v[120:123], v[28:31]
    ds_read_b64_tr_b16 v[220:221], v235 offset:24576
    ds_read_b64_tr_b16 v[222:223], v235 offset:28672
    v_exp_f32 v78, v78
    s_waitcnt lgkmcnt(6)
    v_mfma_f32_16x16x32_bf16 v[32:35], v[208:211], v[112:115], v[32:35]
    v_add_f32 v254, v254, v76
    v_mfma_f32_16x16x32_bf16 v[40:43], v[208:211], v[120:123], v[40:43]
    ds_read_b128 v[192:195], v224 offset:16384
    v_exp_f32 v79, v79
    s_waitcnt lgkmcnt(5)
    v_mfma_f32_16x16x32_bf16 v[36:39], v[212:215], v[112:115], v[36:39]
    v_add_f32 v254, v254, v77
    v_mfma_f32_16x16x32_bf16 v[44:47], v[212:215], v[120:123], v[44:47]
    ds_read_b128 v[196:199], v225 offset:16384
    v_cvt_pk_bf16_f32 v74, v76, v77
    v_exp_f32 v80, v80
    s_waitcnt lgkmcnt(4)
    v_mfma_f32_16x16x32_bf16 v[48:51], v[216:219], v[112:115], v[48:51]
    v_add_f32 v255, v255, v78
    v_mfma_f32_16x16x32_bf16 v[56:59], v[216:219], v[120:123], v[56:59]
    ds_read_b128 v[200:203], v226 offset:16384
    v_exp_f32 v81, v81
    s_waitcnt lgkmcnt(3)
    v_mfma_f32_16x16x32_bf16 v[52:55], v[220:223], v[112:115], v[52:55]
    v_add_f32 v255, v255, v79
    v_mfma_f32_16x16x32_bf16 v[60:63], v[220:223], v[120:123], v[60:63]
    ds_read_b128 v[204:207], v227 offset:16384
    v_cvt_pk_bf16_f32 v75, v78, v79
    v_exp_f32 v82, v82
    s_waitcnt lgkmcnt(3)
    v_mfma_f32_16x16x32_bf16 v[96:99], v[192:195], v[128:131], v[240:243]
    v_add_f32 v252, v252, v80
    v_mfma_f32_16x16x32_bf16 v[104:107], v[192:195], v[144:147], v[244:247]
    ds_read_b128 v[208:211], v224 offset:20480
    v_exp_f32 v83, v83
    s_waitcnt lgkmcnt(3)
    v_mfma_f32_16x16x32_bf16 v[96:99], v[196:199], v[132:135], v[96:99]
    v_add_f32 v252, v252, v81
    v_mfma_f32_16x16x32_bf16 v[104:107], v[196:199], v[148:151], v[104:107]
    ds_read_b128 v[212:215], v225 offset:20480
    v_cvt_pk_bf16_f32 v80, v80, v81
    s_waitcnt lgkmcnt(3)
    v_mfma_f32_16x16x32_bf16 v[96:99], v[200:203], v[136:139], v[96:99]
    v_exp_f32 v84, v84
    v_add_f32 v253, v253, v82
    v_mfma_f32_16x16x32_bf16 v[104:107], v[200:203], v[152:155], v[104:107]
    ds_read_b128 v[216:219], v226 offset:20480
    v_exp_f32 v85, v85
    s_waitcnt lgkmcnt(3)
    v_mfma_f32_16x16x32_bf16 v[96:99], v[204:207], v[140:143], v[96:99]
    v_add_f32 v253, v253, v83
    v_mfma_f32_16x16x32_bf16 v[104:107], v[204:207], v[156:159], v[104:107]
    ds_read_b128 v[220:223], v227 offset:20480
    v_cvt_pk_bf16_f32 v81, v82, v83
    s_waitcnt lgkmcnt(3)
    v_mfma_f32_16x16x32_bf16 v[100:103], v[208:211], v[128:131], v[240:243]
    v_exp_f32 v86, v86
    v_mfma_f32_16x16x32_bf16 v[108:111], v[208:211], v[144:147], v[244:247]
    ds_read_b128 v[192:195], v224 offset:24576
    v_add_f32 v252, v252, v84
    v_exp_f32 v87, v87
    s_waitcnt lgkmcnt(3)
    v_mfma_f32_16x16x32_bf16 v[100:103], v[212:215], v[132:135], v[100:103]
    v_add_f32 v252, v252, v85
    v_mfma_f32_16x16x32_bf16 v[108:111], v[212:215], v[148:151], v[108:111]
    ds_read_b128 v[196:199], v225 offset:24576
    v_cvt_pk_bf16_f32 v82, v84, v85
    s_waitcnt lgkmcnt(3)
    v_mfma_f32_16x16x32_bf16 v[100:103], v[216:219], v[136:139], v[100:103]
    v_exp_f32 v88, v88
    v_mfma_f32_16x16x32_bf16 v[108:111], v[216:219], v[152:155], v[108:111]
    ds_read_b128 v[200:203], v226 offset:24576
    v_add_f32 v253, v253, v86
    v_exp_f32 v89, v89
    s_waitcnt lgkmcnt(3)
    v_mfma_f32_16x16x32_bf16 v[100:103], v[220:223], v[140:143], v[100:103]
    v_add_f32 v253, v253, v87
    v_mfma_f32_16x16x32_bf16 v[108:111], v[220:223], v[156:159], v[108:111]
    ds_read_b128 v[204:207], v227 offset:24576
    v_cvt_pk_bf16_f32 v83, v86, v87
    s_waitcnt lgkmcnt(3)
    v_mfma_f32_16x16x32_bf16 v[112:115], v[192:195], v[128:131], v[240:243]
    v_exp_f32 v90, v90
    v_mfma_f32_16x16x32_bf16 v[120:123], v[192:195], v[144:147], v[244:247]
    ds_read_b128 v[208:211], v224 offset:28672
    v_add_f32 v254, v254, v88
    s_waitcnt lgkmcnt(3)
    v_mfma_f32_16x16x32_bf16 v[112:115], v[196:199], v[132:135], v[112:115]
    v_exp_f32 v91, v91
    v_add_f32 v254, v254, v89
    v_mfma_f32_16x16x32_bf16 v[120:123], v[196:199], v[148:151], v[120:123]
    ds_read_b128 v[212:215], v225 offset:28672
    v_cvt_pk_bf16_f32 v88, v88, v89
    s_waitcnt lgkmcnt(3)
    v_mfma_f32_16x16x32_bf16 v[112:115], v[200:203], v[136:139], v[112:115]
    v_exp_f32 v92, v92
    v_mfma_f32_16x16x32_bf16 v[120:123], v[200:203], v[152:155], v[120:123]
    ds_read_b128 v[216:219], v226 offset:28672
    v_add_f32 v255, v255, v90
    s_waitcnt lgkmcnt(3)
    v_mfma_f32_16x16x32_bf16 v[112:115], v[204:207], v[140:143], v[112:115]
    v_exp_f32 v93, v93
    v_add_f32 v255, v255, v91
    v_mfma_f32_16x16x32_bf16 v[120:123], v[204:207], v[156:159], v[120:123]
    ds_read_b128 v[220:223], v227 offset:28672
    v_cvt_pk_bf16_f32 v89, v90, v91
    s_waitcnt lgkmcnt(3)
    v_mfma_f32_16x16x32_bf16 v[116:119], v[208:211], v[128:131], v[240:243]
    v_exp_f32 v94, v94
    v_mfma_f32_16x16x32_bf16 v[124:127], v[208:211], v[144:147], v[244:247]
    s_waitcnt vmcnt(2)
    s_barrier
    s_add_u32 m0, s80, 0
    s_add_u32 s38, s84, 0
    buffer_load_dwordx4 v238, s[20:23], s38 offen nt lds
    s_add_u32 m0, s80, 8192
    s_add_u32 s38, s84, 8192
    buffer_load_dwordx4 v238, s[20:23], s38 offen nt lds
    s_add_u32 m0, s80, 16384
    s_add_u32 s38, s84, 16384
    buffer_load_dwordx4 v238, s[20:23], s38 offen nt lds
    s_add_u32 m0, s80, 24576
    s_add_u32 s38, s84, 24576
    buffer_load_dwordx4 v238, s[20:23], s38 offen nt lds
    v_add_u32 v228, s85, v228
    ds_read_b64_tr_b16 v[192:193], v228 offset:0
    ds_read_b64_tr_b16 v[194:195], v228 offset:4096
    v_add_f32 v254, v254, v92
    s_waitcnt lgkmcnt(4)
    v_mfma_f32_16x16x32_bf16 v[116:119], v[212:215], v[132:135], v[116:119]
    v_exp_f32 v95, v95
    v_mfma_f32_16x16x32_bf16 v[124:127], v[212:215], v[148:151], v[124:127]
    v_add_u32 v229, s85, v229
    ds_read_b64_tr_b16 v[196:197], v229 offset:0
    ds_read_b64_tr_b16 v[198:199], v229 offset:4096
    v_add_f32 v254, v254, v93
    v_cvt_pk_bf16_f32 v90, v92, v93
    s_waitcnt lgkmcnt(5)
    v_mfma_f32_16x16x32_bf16 v[116:119], v[216:219], v[136:139], v[116:119]
    v_add_f32 v255, v255, v94
    v_mfma_f32_16x16x32_bf16 v[124:127], v[216:219], v[152:155], v[124:127]
    v_add_u32 v230, s85, v230
    ds_read_b64_tr_b16 v[200:201], v230 offset:0
    ds_read_b64_tr_b16 v[202:203], v230 offset:4096
    v_add_f32 v255, v255, v95
    s_waitcnt lgkmcnt(6)
    v_mfma_f32_16x16x32_bf16 v[116:119], v[220:223], v[140:143], v[116:119]
    v_cvt_pk_bf16_f32 v91, v94, v95
    v_mfma_f32_16x16x32_bf16 v[124:127], v[220:223], v[156:159], v[124:127]
    v_add_u32 v231, s85, v231
    ds_read_b64_tr_b16 v[204:205], v231 offset:0
    ds_read_b64_tr_b16 v[206:207], v231 offset:4096
    v_add_f32 v252, v252, v253
    v_add_f32 v254, v254, v255
    v_max_f32 v239, v252, v254
    v_cmp_lt_f32 vcc, 0x46800000, v239
    s_cbranch_vccnz L_slow_2_2
L_back_2_2:
    v_add_f32 v248, v248, v252
    v_add_f32 v249, v249, v254
    s_waitcnt lgkmcnt(6)
    v_mfma_f32_16x16x32_bf16 v[0:3], v[192:195], v[64:67], v[0:3]
    v_exp_f32 v96, v96
    v_mfma_f32_16x16x32_bf16 v[8:11], v[192:195], v[72:75], v[8:11]
    v_add_u32 v232, s85, v232
    ds_read_b64_tr_b16 v[208:209], v232 offset:0
    ds_read_b64_tr_b16 v[210:211], v232 offset:4096
    v_exp_f32 v97, v97
    s_waitcnt lgkmcnt(6)
    v_mfma_f32_16x16x32_bf16 v[4:7], v[196:199], v[64:67], v[4:7]
    v_exp_f32 v98, v98
    v_mfma_f32_16x16x32_bf16 v[12:15], v[196:199], v[72:75], v[12:15]
    v_add_u32 v233, s85, v233
    ds_read_b64_tr_b16 v[212:213], v233 offset:0
    ds_read_b64_tr_b16 v[214:215], v233 offset:4096
    v_exp_f32 v99, v99
    s_waitcnt lgkmcnt(6)
    v_mfma_f32_16x16x32_bf16 v[16:19], v[200:203], v[64:67], v[16:19]
    v_add_f32 v252, v96, v97
    v_cvt_pk_bf16_f32 v96, v96, v97
    v_mfma_f32_16x16x32_bf16 v[24:27], v[200:203], v[72:75], v[24:27]
    v_add_u32 v234, s85, v234
    ds_read_b64_tr_b16 v[216:217], v234 offset:0
    ds_read_b64_tr_b16 v[218:219], v234 offset:4096
    v_exp_f32 v100, v100
    s_waitcnt lgkmcnt(6)
    v_mfma_f32_16x16x32_bf16 v[20:23], v[204:207], v[64:67], v[20:23]
    v_exp_f32 v101, v101
    v_mfma_f32_16x16x32_bf16 v[28:31], v[204:207], v[72:75], v[28:31]
    v_add_u32 v235, s85, v235
    ds_read_b64_tr_b16 v[220:221], v235 offset:0
    ds_read_b64_tr_b16 v[222:223], v235 offset:4096
    v_add_f32 v253, v98, v99
    s_waitcnt lgkmcnt(6)
    v_mfma_f32_16x16x32_bf16 v[32:35], v[208:211], v[64:67], v[32:35]
    v_cvt_pk_bf16_f32 v97, v98, v99
    v_mfma_f32_16x16x32_bf16 v[40:43], v[208:211], v[72:75], v[40:43]
    ds_read_b64_tr_b16 v[192:193], v228 offset:8192
    ds_read_b64_tr_b16 v[194:195], v228 offset:12288
    v_exp_f32 v102, v102
    v_add_f32 v252, v252, v100
    s_waitcnt lgkmcnt(6)
    v_mfma_f32_16x16x32_bf16 v[36:39], v[212:215], v[64:67], v[36:39]
    v_exp_f32 v103, v103
    v_mfma_f32_16x16x32_bf16 v[44:47], v[212:215], v[72:75], v[44:47]
    ds_read_b64_tr_b16 v[196:197], v229 offset:8192
    ds_read_b64_tr_b16 v[198:199], v229 offset:12288
    v_add_f32 v252, v252, v101
    s_waitcnt lgkmcnt(6)
    v_mfma_f32_16x16x32_bf16 v[48:51], v[216:219], v[64:67], v[48:51]
    v_cvt_pk_bf16_f32 v98, v100, v101
    v_mfma_f32_16x16x32_bf16 v[56:59], v[216:219], v[72:75], v[56:59]
    ds_read_b64_tr_b16 v[200:201], v230 offset:8192
    ds_read_b64_tr_b16 v[202:203], v230 offset:12288
    v_exp_f32 v104, v104
    v_add_f32 v253, v253, v102
    s_waitcnt lgkmcnt(6)
    v_mfma_f32_16x16x32_bf16 v[52:55], v[220:223], v[64:67], v[52:55]
    v_exp_f32 v105, v105
    v_mfma_f32_16x16x32_bf16 v[60:63], v[220:223], v[72:75], v[60:63]
    ds_read_b64_tr_b16 v[204:205], v231 offset:8192
    ds_read_b64_tr_b16 v[206:207], v231 offset:12288
    v_add_f32 v253, v253, v103
    s_waitcnt lgkmcnt(6)
    v_mfma_f32_16x16x32_bf16 v[0:3], v[192:195], v[80:83], v[0:3]
    v_cvt_pk_bf16_f32 v99, v102, v103
    v_mfma_f32_16x16x32_bf16 v[8:11], v[192:195], v[88:91], v[8:11]
    ds_read_b64_tr_b16 v[208:209], v232 offset:8192
    ds_read_b64_tr_b16 v[210:211], v232 offset:12288
    v_exp_f32 v106, v106
    s_waitcnt lgkmcnt(6)
    v_mfma_f32_16x16x32_bf16 v[4:7], v[196:199], v[80:83], v[4:7]
    v_exp_f32 v107, v107
    v_add_f32 v254, v104, v105
    v_mfma_f32_16x16x32_bf16 v[12:15], v[196:199], v[88:91], v[12:15]
    ds_read_b64_tr_b16 v[212:213], v233 offset:8192
    ds_read_b64_tr_b16 v[214:215], v233 offset:12288
    v_cvt_pk_bf16_f32 v104, v104, v105
    s_waitcnt lgkmcnt(6)
    v_mfma_f32_16x16x32_bf16 v[16:19], v[200:203], v[80:83], v[16:19]
    v_exp_f32 v108, v108
    v_mfma_f32_16x16x32_bf16 v[24:27], v[200:203], v[88:91], v[24:27]
    ds_read_b64_tr_b16 v[216:217], v234 offset:8192
    ds_read_b64_tr_b16 v[218:219], v234 offset:12288
    v_exp_f32 v109, v109
    s_waitcnt lgkmcnt(6)
    v_mfma_f32_16x16x32_bf16 v[20:23], v[204:207], v[80:83], v[20:23]
    v_add_f32 v255, v106, v107
    v_cvt_pk_bf16_f32 v105, v106, v107
    v_mfma_f32_16x16x32_bf16 v[28:31], v[204:207], v[88:91], v[28:31]
    ds_read_b64_tr_b16 v[220:221], v235 offset:8192
    ds_read_b64_tr_b16 v[222:223], v235 offset:12288
    v_exp_f32 v110, v110
    s_waitcnt lgkmcnt(6)
    v_mfma_f32_16x16x32_bf16 v[32:35], v[208:211], v[80:83], v[32:35]
    v_add_f32 v254, v254, v108
    v_mfma_f32_16x16x32_bf16 v[40:43], v[208:211], v[88:91], v[40:43]
    v_add_u32 v224, s46, v224
    ds_read_b128 v[192:195], v224 offset:0
    v_exp_f32 v111, v111
    s_waitcnt lgkmcnt(5)
    v_mfma_f32_16x16x32_bf16 v[36:39], v[212:215], v[80:83], v[36:39]
    v_add_f32 v254, v254, v109
    v_mfma_f32_16x16x32_bf16 v[44:47], v[212:215], v[88:91], v[44:47]
    v_add_u32 v225, s46, v225
    ds_read_b128 v[196:199], v225 offset:0
    v_cvt_pk_bf16_f32 v106, v108, v109
    v_exp_f32 v112, v112
    s_waitcnt lgkmcnt(4)
    v_mfma_f32_16x16x32_bf16 v[48:51], v[216:219], v[80:83], v[48:51]
    v_add_f32 v255, v255, v110
    v_mfma_f32_16x16x32_bf16 v[56:59], v[216:219], v[88:91], v[56:59]
    v_add_u32 v226, s46, v226
    ds_read_b128 v[200:203], v226 offset:0
    v_exp_f32 v113, v113
    s_waitcnt lgkmcnt(3)
    v_mfma_f32_16x16x32_bf16 v[52:55], v[220:223], v[80:83], v[52:55]
    v_add_f32 v255, v255, v111
    v_mfma_f32_16x16x32_bf16 v[60:63], v[220:223], v[88:91], v[60:63]
    v_add_u32 v227, s46, v227
    ds_read_b128 v[204:207], v227 offset:0
    v_cvt_pk_bf16_f32 v107, v110, v111
    v_exp_f32 v114, v114
    s_waitcnt lgkmcnt(3)
    v_mfma_f32_16x16x32_bf16 v[64:67], v[192:195], v[128:131], v[240:243]
    v_add_f32 v252, v252, v112
    v_mfma_f32_16x16x32_bf16 v[72:75], v[192:195], v[144:147], v[244:247]
    ds_read_b128 v[208:211], v224 offset:4096
    v_exp_f32 v115, v115
    s_waitcnt lgkmcnt(3)
    v_mfma_f32_16x16x32_bf16 v[64:67], v[196:199], v[132:135], v[64:67]
    v_add_f32 v252, v252, v113
    v_mfma_f32_16x16x32_bf16 v[72:75], v[196:199], v[148:151], v[72:75]
    ds_read_b128 v[212:215], v225 offset:4096
    v_cvt_pk_bf16_f32 v112, v112, v113
    s_waitcnt lgkmcnt(3)
    v_mfma_f32_16x16x32_bf16 v[64:67], v[200:203], v[136:139], v[64:67]
    v_exp_f32 v116, v116
    v_add_f32 v253, v253, v114
    v_mfma_f32_16x16x32_bf16 v[72:75], v[200:203], v[152:155], v[72:75]
    ds_read_b128 v[216:219], v226 offset:4096
    v_exp_f32 v117, v117
    s_waitcnt lgkmcnt(3)
    v_mfma_f32_16x16x32_bf16 v[64:67], v[204:207], v[140:143], v[64:67]
    v_add_f32 v253, v253, v115
    v_mfma_f32_16x16x32_bf16 v[72:75], v[204:207], v[156:159], v[72:75]
    ds_read_b128 v[220:223], v227 offset:4096
    v_cvt_pk_bf16_f32 v113, v114, v115
    s_waitcnt lgkmcnt(3)
    v_mfma_f32_16x16x32_bf16 v[68:71], v[208:211], v[128:131], v[240:243]
    v_exp_f32 v118, v118
    v_mfma_f32_16x16x32_bf16 v[76:79], v[208:211], v[144:147], v[244:247]
    ds_read_b128 v[192:195], v224 offset:8192
    v_add_f32 v252, v252, v116
    v_exp_f32 v119, v119
    s_waitcnt lgkmcnt(3)
    v_mfma_f32_16x16x32_bf16 v[68:71], v[212:215], v[132:135], v[68:71]
    v_add_f32 v252, v252, v117
    v_mfma_f32_16x16x32_bf16 v[76:79], v[212:215], v[148:151], v[76:79]
    ds_read_b128 v[196:199], v225 offset:8192
    v_cvt_pk_bf16_f32 v114, v116, v117
    s_waitcnt lgkmcnt(3)
    v_mfma_f32_16x16x32_bf16 v[68:71], v[216:219], v[136:139], v[68:71]
    v_exp_f32 v120, v120
    v_mfma_f32_16x16x32_bf16 v[76:79], v[216:219], v[152:155], v[76:79]
    ds_read_b128 v[200:203], v226 offset:8192
    v_add_f32 v253, v253, v118
    v_exp_f32 v121, v121
    s_waitcnt lgkmcnt(3)
    v_mfma_f32_16x16x32_bf16 v[68:71], v[220:223], v[140:143], v[68:71]
    v_add_f32 v253, v253, v119
    v_mfma_f32_16x16x32_bf16 v[76:79], v[220:223], v[156:159], v[76:79]
    ds_read_b128 v[204:207], v227 offset:8192
    v_cvt_pk_bf16_f32 v115, v118, v119
    s_waitcnt lgkmcnt(3)
    v_mfma_f32_16x16x32_bf16 v[80:83], v[192:195], v[128:131], v[240:243]
    v_exp_f32 v122, v122
    v_mfma_f32_16x16x32_bf16 v[88:91], v[192:195], v[144:147], v[244:247]
    ds_read_b128 v[208:211], v224 offset:12288
    v_add_f32 v254, v254, v120
    s_waitcnt lgkmcnt(3)
    v_mfma_f32_16x16x32_bf16 v[80:83], v[196:199], v[132:135], v[80:83]
    v_exp_f32 v123, v123
    v_add_f32 v254, v254, v121
    v_mfma_f32_16x16x32_bf16 v[88:91], v[196:199], v[148:151], v[88:91]
    ds_read_b128 v[212:215], v225 offset:12288
    v_cvt_pk_bf16_f32 v120, v120, v121
    s_waitcnt lgkmcnt(3)
    v_mfma_f32_16x16x32_bf16 v[80:83], v[200:203], v[136:139], v[80:83]
    v_exp_f32 v124, v124
    v_mfma_f32_16x16x32_bf16 v[88:91], v[200:203], v[152:155], v[88:91]
    ds_read_b128 v[216:219], v226 offset:12288
    v_add_f32 v255, v255, v122
    s_waitcnt lgkmcnt(3)
    v_mfma_f32_16x16x32_bf16 v[80:83], v[204:207], v[140:143], v[80:83]
    v_exp_f32 v125, v125
    v_add_f32 v255, v255, v123
    v_mfma_f32_16x16x32_bf16 v[88:91], v[204:207], v[156:159], v[88:91]
    ds_read_b128 v[220:223], v227 offset:12288
    v_cvt_pk_bf16_f32 v121, v122, v123
    s_waitcnt lgkmcnt(3)
    v_mfma_f32_16x16x32_bf16 v[84:87], v[208:211], v[128:131], v[240:243]
    v_exp_f32 v126, v126
    v_mfma_f32_16x16x32_bf16 v[92:95], v[208:211], v[144:147], v[244:247]
    ds_read_b64_tr_b16 v[192:193], v228 offset:16384
    ds_read_b64_tr_b16 v[194:195], v228 offset:20480
    v_add_f32 v254, v254, v124
    s_waitcnt lgkmcnt(4)
    v_mfma_f32_16x16x32_bf16 v[84:87], v[212:215], v[132:135], v[84:87]
    v_exp_f32 v127, v127
    v_mfma_f32_16x16x32_bf16 v[92:95], v[212:215], v[148:151], v[92:95]
    ds_read_b64_tr_b16 v[196:197], v229 offset:16384
    ds_read_b64_tr_b16 v[198:199], v229 offset:20480
    v_add_f32 v254, v254, v125
    v_cvt_pk_bf16_f32 v122, v124, v125
    s_waitcnt lgkmcnt(5)
    v_mfma_f32_16x16x32_bf16 v[84:87], v[216:219], v[136:139], v[84:87]
    v_add_f32 v255, v255, v126
    v_mfma_f32_16x16x32_bf16 v[92:95], v[216:219], v[152:155], v[92:95]
    ds_read_b64_tr_b16 v[200:201], v230 offset:16384
    ds_read_b64_tr_b16 v[202:203], v230 offset:20480
    v_add_f32 v255, v255, v127
    s_waitcnt lgkmcnt(6)
    v_mfma_f32_16x16x32_bf16 v[84:87], v[220:223], v[140:143], v[84:87]
    v_cvt_pk_bf16_f32 v123, v126, v127
    v_mfma_f32_16x16x32_bf16 v[92:95], v[220:223], v[156:159], v[92:95]
    ds_read_b64_tr_b16 v[204:205], v231 offset:16384
    ds_read_b64_tr_b16 v[206:207], v231 offset:20480
    v_add_f32 v252, v252, v253
    v_add_f32 v254, v254, v255
    v_max_f32 v239, v252, v254
    v_cmp_lt_f32 vcc, 0x46800000, v239
    s_cbranch_vccnz L_slow_2_3
L_back_2_3:
    v_add_f32 v248, v248, v252
    v_add_f32 v249, v249, v254
    s_waitcnt lgkmcnt(6)
    v_mfma_f32_16x16x32_bf16 v[0:3], v[192:195], v[96:99], v[0:3]
    v_exp_f32 v64, v64
    v_mfma_f32_16x16x32_bf16 v[8:11], v[192:195], v[104:107], v[8:11]
    ds_read_b64_tr_b16 v[208:209], v232 offset:16384
    ds_read_b64_tr_b16 v[210:211], v232 offset:20480
    v_exp_f32 v65, v65
    s_waitcnt lgkmcnt(6)
    v_mfma_f32_16x16x32_bf16 v[4:7], v[196:199], v[96:99], v[4:7]
    v_exp_f32 v66, v66
    v_mfma_f32_16x16x32_bf16 v[12:15], v[196:199], v[104:107], v[12:15]
    ds_read_b64_tr_b16 v[212:213], v233 offset:16384
    ds_read_b64_tr_b16 v[214:215], v233 offset:20480
    v_exp_f32 v67, v67
    s_waitcnt lgkmcnt(6)
    v_mfma_f32_16x16x32_bf16 v[16:19], v[200:203], v[96:99], v[16:19]
    v_add_f32 v252, v64, v65
    v_cvt_pk_bf16_f32 v64, v64, v65
    v_mfma_f32_16x16x32_bf16 v[24:27], v[200:203], v[104:107], v[24:27]
    ds_read_b64_tr_b16 v[216:217], v234 offset:16384
    ds_read_b64_tr_b16 v[218:219], v234 offset:20480
    v_exp_f32 v68, v68
    s_waitcnt lgkmcnt(6)
    v_mfma_f32_16x16x32_bf16 v[20:23], v[204:207], v[96:99], v[20:23]
    v_exp_f32 v69, v69
    v_mfma_f32_16x16x32_bf16 v[28:31], v[204:207], v[104:107], v[28:31]
    ds_read_b64_tr_b16 v[220:221], v235 offset:16384
    ds_read_b64_tr_b16 v[222:223], v235 offset:20480
    v_add_f32 v253, v66, v67
    s_waitcnt lgkmcnt(6)
    v_mfma_f32_16x16x32_bf16 v[32:35], v[208:211], v[96:99], v[32:35]
    v_cvt_pk_bf16_f32 v65, v66, v67
    v_mfma_f32_16x16x32_bf16 v[40:43], v[208:211], v[104:107], v[40:43]
    ds_read_b64_tr_b16 v[192:193], v228 offset:24576
    ds_read_b64_tr_b16 v[194:195], v228 offset:28672
    v_exp_f32 v70, v70
    v_add_f32 v252, v252, v68
    s_waitcnt lgkmcnt(6)
    v_mfma_f32_16x16x32_bf16 v[36:39], v[212:215], v[96:99], v[36:39]
    v_exp_f32 v71, v71
    v_mfma_f32_16x16x32_bf16 v[44:47], v[212:215], v[104:107], v[44:47]
    ds_read_b64_tr_b16 v[196:197], v229 offset:24576
    ds_read_b64_tr_b16 v[198:199], v229 offset:28672
    v_add_f32 v252, v252, v69
    s_waitcnt lgkmcnt(6)
    v_mfma_f32_16x16x32_bf16 v[48:51], v[216:219], v[96:99], v[48:51]
    v_cvt_pk_bf16_f32 v66, v68, v69
    v_mfma_f32_16x16x32_bf16 v[56:59], v[216:219], v[104:107], v[56:59]
    ds_read_b64_tr_b16 v[200:201], v230 offset:24576
    ds_read_b64_tr_b16 v[202:203], v230 offset:28672
    v_exp_f32 v72, v72
    v_add_f32 v253, v253, v70
    s_waitcnt lgkmcnt(6)
    v_mfma_f32_16x16x32_bf16 v[52:55], v[220:223], v[96:99], v[52:55]
    v_exp_f32 v73, v73
    v_mfma_f32_16x16x32_bf16 v[60:63], v[220:223], v[104:107], v[60:63]
    ds_read_b64_tr_b16 v[204:205], v231 offset:24576
    ds_read_b64_tr_b16 v[206:207], v231 offset:28672
    v_add_f32 v253, v253, v71
    s_waitcnt lgkmcnt(6)
    v_mfma_f32_16x16x32_bf16 v[0:3], v[192:195], v[112:115], v[0:3]
    v_cvt_pk_bf16_f32 v67, v70, v71
    v_mfma_f32_16x16x32_bf16 v[8:11], v[192:195], v[120:123], v[8:11]
    ds_read_b64_tr_b16 v[208:209], v232 offset:24576
    ds_read_b64_tr_b16 v[210:211], v232 offset:28672
    v_exp_f32 v74, v74
    s_waitcnt lgkmcnt(6)
    v_mfma_f32_16x16x32_bf16 v[4:7], v[196:199], v[112:115], v[4:7]
    v_exp_f32 v75, v75
    v_add_f32 v254, v72, v73
    v_mfma_f32_16x16x32_bf16 v[12:15], v[196:199], v[120:123], v[12:15]
    ds_read_b64_tr_b16 v[212:213], v233 offset:24576
    ds_read_b64_tr_b16 v[214:215], v233 offset:28672
    v_cvt_pk_bf16_f32 v72, v72, v73
    s_waitcnt lgkmcnt(6)
    v_mfma_f32_16x16x32_bf16 v[16:19], v[200:203], v[112:115], v[16:19]
    v_exp_f32 v76, v76
    v_mfma_f32_16x16x32_bf16 v[24:27], v[200:203], v[120:123], v[24:27]
    ds_read_b64_tr_b16 v[216:217], v234 offset:24576
    ds_read_b64_tr_b16 v[218:219], v234 offset:28672
    v_exp_f32 v77, v77
    s_waitcnt lgkmcnt(6)
    v_mfma_f32_16x16x32_bf16 v[20:23], v[204:207], v[112:115], v[20:23]
    v_add_f32 v255, v74, v75
    v_cvt_pk_bf16_f32 v73, v74, v75
    v_mfma_f32_16x16x32_bf16 v[28:31], v[204:207], v[120:123], v[28:31]
    ds_read_b64_tr_b16 v[220:221], v235 offset:24576
    ds_read_b64_tr_b16 v[222:223], v235 offset:28672
    v_exp_f32 v78, v78
    s_waitcnt lgkmcnt(6)
    v_mfma_f32_16x16x32_bf16 v[32:35], v[208:211], v[112:115], v[32:35]
    v_add_f32 v254, v254, v76
    v_mfma_f32_16x16x32_bf16 v[40:43], v[208:211], v[120:123], v[40:43]
    ds_read_b128 v[192:195], v224 offset:16384
    v_exp_f32 v79, v79
    s_waitcnt lgkmcnt(5)
    v_mfma_f32_16x16x32_bf16 v[36:39], v[212:215], v[112:115], v[36:39]
    v_add_f32 v254, v254, v77
    v_mfma_f32_16x16x32_bf16 v[44:47], v[212:215], v[120:123], v[44:47]
    ds_read_b128 v[196:199], v225 offset:16384
    v_cvt_pk_bf16_f32 v74, v76, v77
    v_exp_f32 v80, v80
    s_waitcnt lgkmcnt(4)
    v_mfma_f32_16x16x32_bf16 v[48:51], v[216:219], v[112:115], v[48:51]
    v_add_f32 v255, v255, v78
    v_mfma_f32_16x16x32_bf16 v[56:59], v[216:219], v[120:123], v[56:59]
    ds_read_b128 v[200:203], v226 offset:16384
    v_exp_f32 v81, v81
    s_waitcnt lgkmcnt(3)
    v_mfma_f32_16x16x32_bf16 v[52:55], v[220:223], v[112:115], v[52:55]
    v_add_f32 v255, v255, v79
    v_mfma_f32_16x16x32_bf16 v[60:63], v[220:223], v[120:123], v[60:63]
    ds_read_b128 v[204:207], v227 offset:16384
    v_cvt_pk_bf16_f32 v75, v78, v79
    v_exp_f32 v82, v82
    s_waitcnt lgkmcnt(3)
    v_mfma_f32_16x16x32_bf16 v[96:99], v[192:195], v[128:131], v[240:243]
    v_add_f32 v252, v252, v80
    v_mfma_f32_16x16x32_bf16 v[104:107], v[192:195], v[144:147], v[244:247]
    ds_read_b128 v[208:211], v224 offset:20480
    v_exp_f32 v83, v83
    s_waitcnt lgkmcnt(3)
    v_mfma_f32_16x16x32_bf16 v[96:99], v[196:199], v[132:135], v[96:99]
    v_add_f32 v252, v252, v81
    v_mfma_f32_16x16x32_bf16 v[104:107], v[196:199], v[148:151], v[104:107]
    ds_read_b128 v[212:215], v225 offset:20480
    v_cvt_pk_bf16_f32 v80, v80, v81
    s_waitcnt lgkmcnt(3)
    v_mfma_f32_16x16x32_bf16 v[96:99], v[200:203], v[136:139], v[96:99]
    v_exp_f32 v84, v84
    v_add_f32 v253, v253, v82
    v_mfma_f32_16x16x32_bf16 v[104:107], v[200:203], v[152:155], v[104:107]
    ds_read_b128 v[216:219], v226 offset:20480
    v_exp_f32 v85, v85
    s_waitcnt lgkmcnt(3)
    v_mfma_f32_16x16x32_bf16 v[96:99], v[204:207], v[140:143], v[96:99]
    v_add_f32 v253, v253, v83
    v_mfma_f32_16x16x32_bf16 v[104:107], v[204:207], v[156:159], v[104:107]
    ds_read_b128 v[220:223], v227 offset:20480
    v_cvt_pk_bf16_f32 v81, v82, v83
    s_waitcnt lgkmcnt(3)
    v_mfma_f32_16x16x32_bf16 v[100:103], v[208:211], v[128:131], v[240:243]
    v_exp_f32 v86, v86
    v_mfma_f32_16x16x32_bf16 v[108:111], v[208:211], v[144:147], v[244:247]
    ds_read_b128 v[192:195], v224 offset:24576
    v_add_f32 v252, v252, v84
    v_exp_f32 v87, v87
    s_waitcnt lgkmcnt(3)
    v_mfma_f32_16x16x32_bf16 v[100:103], v[212:215], v[132:135], v[100:103]
    v_add_f32 v252, v252, v85
    v_mfma_f32_16x16x32_bf16 v[108:111], v[212:215], v[148:151], v[108:111]
    ds_read_b128 v[196:199], v225 offset:24576
    v_cvt_pk_bf16_f32 v82, v84, v85
    s_waitcnt lgkmcnt(3)
    v_mfma_f32_16x16x32_bf16 v[100:103], v[216:219], v[136:139], v[100:103]
    v_exp_f32 v88, v88
    v_mfma_f32_16x16x32_bf16 v[108:111], v[216:219], v[152:155], v[108:111]
    ds_read_b128 v[200:203], v226 offset:24576
    v_add_f32 v253, v253, v86
    v_exp_f32 v89, v89
    s_waitcnt lgkmcnt(3)
    v_mfma_f32_16x16x32_bf16 v[100:103], v[220:223], v[140:143], v[100:103]
    v_add_f32 v253, v253, v87
    v_mfma_f32_16x16x32_bf16 v[108:111], v[220:223], v[156:159], v[108:111]
    ds_read_b128 v[204:207], v227 offset:24576
    v_cvt_pk_bf16_f32 v83, v86, v87
    s_waitcnt lgkmcnt(3)
    v_mfma_f32_16x16x32_bf16 v[112:115], v[192:195], v[128:131], v[240:243]
    v_exp_f32 v90, v90
    v_mfma_f32_16x16x32_bf16 v[120:123], v[192:195], v[144:147], v[244:247]
    ds_read_b128 v[208:211], v224 offset:28672
    v_add_f32 v254, v254, v88
    s_waitcnt lgkmcnt(3)
    v_mfma_f32_16x16x32_bf16 v[112:115], v[196:199], v[132:135], v[112:115]
    v_exp_f32 v91, v91
    v_add_f32 v254, v254, v89
    v_mfma_f32_16x16x32_bf16 v[120:123], v[196:199], v[148:151], v[120:123]
    ds_read_b128 v[212:215], v225 offset:28672
    v_cvt_pk_bf16_f32 v88, v88, v89
    s_waitcnt lgkmcnt(3)
    v_mfma_f32_16x16x32_bf16 v[112:115], v[200:203], v[136:139], v[112:115]
    v_exp_f32 v92, v92
    v_mfma_f32_16x16x32_bf16 v[120:123], v[200:203], v[152:155], v[120:123]
    ds_read_b128 v[216:219], v226 offset:28672
    v_add_f32 v255, v255, v90
    s_waitcnt lgkmcnt(3)
    v_mfma_f32_16x16x32_bf16 v[112:115], v[204:207], v[140:143], v[112:115]
    v_exp_f32 v93, v93
    v_add_f32 v255, v255, v91
    v_mfma_f32_16x16x32_bf16 v[120:123], v[204:207], v[156:159], v[120:123]
    ds_read_b128 v[220:223], v227 offset:28672
    v_cvt_pk_bf16_f32 v89, v90, v91
    s_waitcnt lgkmcnt(3)
    v_mfma_f32_16x16x32_bf16 v[116:119], v[208:211], v[128:131], v[240:243]
    v_exp_f32 v94, v94
    v_mfma_f32_16x16x32_bf16 v[124:127], v[208:211], v[144:147], v[244:247]
    s_waitcnt vmcnt(0)
    s_barrier
    s_cmp_lg_u32 s39, 0
    s_cbranch_scc1 L_nov10
    s_add_u32 m0, s81, 0
    s_add_u32 s38, s82, 0
    buffer_load_dwordx4 v238, s[20:23], s38 offen nt lds
    s_add_u32 m0, s81, 8192
    s_add_u32 s38, s82, 8192
    buffer_load_dwordx4 v238, s[20:23], s38 offen nt lds
    s_add_u32 m0, s81, 16384
    s_add_u32 s38, s82, 16384
    buffer_load_dwordx4 v238, s[20:23], s38 offen nt lds
    s_add_u32 m0, s81, 24576
    s_add_u32 s38, s82, 24576
    buffer_load_dwordx4 v238, s[20:23], s38 offen nt lds
L_nov10:
    v_add_u32 v228, s86, v228
    ds_read_b64_tr_b16 v[192:193], v228 offset:0
    ds_read_b64_tr_b16 v[194:195], v228 offset:4096
    v_add_f32 v254, v254, v92
    s_waitcnt lgkmcnt(4)
    v_mfma_f32_16x16x32_bf16 v[116:119], v[212:215], v[132:135], v[116:119]
    v_exp_f32 v95, v95
    v_mfma_f32_16x16x32_bf16 v[124:127], v[212:215], v[148:151], v[124:127]
    v_add_u32 v229, s86, v229
    ds_read_b64_tr_b16 v[196:197], v229 offset:0
    ds_read_b64_tr_b16 v[198:199], v229 offset:4096
    v_add_f32 v254, v254, v93
    v_cvt_pk_bf16_f32 v90, v92, v93
    s_waitcnt lgkmcnt(5)
    v_mfma_f32_16x16x32_bf16 v[116:119], v[216:219], v[136:139], v[116:119]
    v_add_f32 v255, v255, v94
    v_mfma_f32_16x16x32_bf16 v[124:127], v[216:219], v[152:155], v[124:127]
    v_add_u32 v230, s86, v230
    ds_read_b64_tr_b16 v[200:201], v230 offset:0
    ds_read_b64_tr_b16 v[202:203], v230 offset:4096
    v_add_f32 v255, v255, v95
    s_waitcnt lgkmcnt(6)
    v_mfma_f32_16x16x32_bf16 v[116:119], v[220:223], v[140:143], v[116:119]
    v_cvt_pk_bf16_f32 v91, v94, v95
    v_mfma_f32_16x16x32_bf16 v[124:127], v[220:223], v[156:159], v[124:127]
    v_add_u32 v231, s86, v231
    ds_read_b64_tr_b16 v[204:205], v231 offset:0
    ds_read_b64_tr_b16 v[206:207], v231 offset:4096
    v_add_f32 v252, v252, v253
    v_add_f32 v254, v254, v255
    v_max_f32 v239, v252, v254
    v_cmp_lt_f32 vcc, 0x46800000, v239
    s_cbranch_vccnz L_slow_2_4
L_back_2_4:
    v_add_f32 v248, v248, v252
    v_add_f32 v249, v249, v254
    s_waitcnt lgkmcnt(6)
    v_mfma_f32_16x16x32_bf16 v[0:3], v[192:195], v[64:67], v[0:3]
    v_exp_f32 v96, v96
    v_exp_f32 v97, v97
    v_mfma_f32_16x16x32_bf16 v[8:11], v[192:195], v[72:75], v[8:11]
    v_add_u32 v232, s86, v232
    ds_read_b64_tr_b16 v[208:209], v232 offset:0
    ds_read_b64_tr_b16 v[210:211], v232 offset:4096
    v_exp_f32 v98, v98
    v_exp_f32 v99, v99
    s_waitcnt lgkmcnt(6)
    v_mfma_f32_16x16x32_bf16 v[4:7], v[196:199], v[64:67], v[4:7]
    v_add_f32 v252, v96, v97
    v_cvt_pk_bf16_f32 v96, v96, v97
    v_exp_f32 v100, v100
    v_mfma_f32_16x16x32_bf16 v[12:15], v[196:199], v[72:75], v[12:15]
    v_add_u32 v233, s86, v233
    ds_read_b64_tr_b16 v[212:213], v233 offset:0
    ds_read_b64_tr_b16 v[214:215], v233 offset:4096
    v_exp_f32 v101, v101
    v_add_f32 v253, v98, v99
    s_waitcnt lgkmcnt(6)
    v_mfma_f32_16x16x32_bf16 v[16:19], v[200:203], v[64:67], v[16:19]
    v_cvt_pk_bf16_f32 v97, v98, v99
    v_exp_f32 v102, v102
    v_add_f32 v252, v252, v100
    v_mfma_f32_16x16x32_bf16 v[24:27], v[200:203], v[72:75], v[24:27]
    v_add_u32 v234, s86, v234
    ds_read_b64_tr_b16 v[216:217], v234 offset:0
    ds_read_b64_tr_b16 v[218:219], v234 offset:4096
    v_exp_f32 v103, v103
    v_add_f32 v252, v252, v101
    s_waitcnt lgkmcnt(6)
    v_mfma_f32_16x16x32_bf16 v[20:23], v[204:207], v[64:67], v[20:23]
    v_cvt_pk_bf16_f32 v98, v100, v101
    v_exp_f32 v104, v104
    v_add_f32 v253, v253, v102
    v_mfma_f32_16x16x32_bf16 v[28:31], v[204:207], v[72:75], v[28:31]
    v_add_u32 v235, s86, v235
    ds_read_b64_tr_b16 v[220:221], v235 offset:0
    ds_read_b64_tr_b16 v[222:223], v235 offset:4096
    v_exp_f32 v105, v105
    v_add_f32 v253, v253, v103
    s_waitcnt lgkmcnt(6)
    v_mfma_f32_16x16x32_bf16 v[32:35], v[208:211], v[64:67], v[32:35]
    v_cvt_pk_bf16_f32 v99, v102, v103
    v_exp_f32 v106, v106
    v_mfma_f32_16x16x32_bf16 v[40:43], v[208:211], v[72:75], v[40:43]
    ds_read_b64_tr_b16 v[192:193], v228 offset:8192
    ds_read_b64_tr_b16 v[194:195], v228 offset:12288
    v_exp_f32 v107, v107
    v_add_f32 v254, v104, v105
    v_cvt_pk_bf16_f32 v104, v104, v105
    s_waitcnt lgkmcnt(6)
    v_mfma_f32_16x16x32_bf16 v[36:39], v[212:215], v[64:67], v[36:39]
    v_exp_f32 v108, v108
    v_exp_f32 v109, v109
    v_mfma_f32_16x16x32_bf16 v[44:47], v[212:215], v[72:75], v[44:47]
    ds_read_b64_tr_b16 v[196:197], v229 offset:8192
    ds_read_b64_tr_b16 v[198:199], v229 offset:12288
    v_add_f32 v255, v106, v107
    v_cvt_pk_bf16_f32 v105, v106, v107
    v_exp_f32 v110, v110
    s_waitcnt lgkmcnt(6)
    v_mfma_f32_16x16x32_bf16 v[48:51], v[216:219], v[64:67], v[48:51]
    v_add_f32 v254, v254, v108
    v_exp_f32 v111, v111
    v_mfma_f32_16x16x32_bf16 v[56:59], v[216:219], v[72:75], v[56:59]
    ds_read_b64_tr_b16 v[200:201], v230 offset:8192
    ds_read_b64_tr_b16 v[202:203], v230 offset:12288
    v_add_f32 v254, v254, v109
    v_cvt_pk_bf16_f32 v106, v108, v109
    v_exp_f32 v112, v112
    s_waitcnt lgkmcnt(6)
    v_mfma_f32_16x16x32_bf16 v[52:55], v[220:223], v[64:67], v[52:55]
    v_add_f32 v255, v255, v110
    v_exp_f32 v113, v113
    v_mfma_f32_16x16x32_bf16 v[60:63], v[220:223], v[72:75], v[60:63]
    ds_read_b64_tr_b16 v[204:205], v231 offset:8192
    ds_read_b64_tr_b16 v[206:207], v231 offset:12288
    v_add_f32 v255, v255, v111
    v_cvt_pk_bf16_f32 v107, v110, v111
    v_exp_f32 v114, v114
    s_waitcnt lgkmcnt(6)
    v_mfma_f32_16x16x32_bf16 v[0:3], v[192:195], v[80:83], v[0:3]
    v_add_f32 v252, v252, v112
    v_exp_f32 v115, v115
    v_mfma_f32_16x16x32_bf16 v[8:11], v[192:195], v[88:91], v[8:11]
    ds_read_b64_tr_b16 v[208:209], v232 offset:8192
    ds_read_b64_tr_b16 v[210:211], v232 offset:12288
    v_add_f32 v252, v252, v113
    v_cvt_pk_bf16_f32 v112, v112, v113
    s_waitcnt lgkmcnt(6)
    v_mfma_f32_16x16x32_bf16 v[4:7], v[196:199], v[80:83], v[4:7]
    v_exp_f32 v116, v116
    v_add_f32 v253, v253, v114
    v_exp_f32 v117, v117
    v_mfma_f32_16x16x32_bf16 v[12:15], v[196:199], v[88:91], v[12:15]
    ds_read_b64_tr_b16 v[212:213], v233 offset:8192
    ds_read_b64_tr_b16 v[214:215], v233 offset:12288
    v_add_f32 v253, v253, v115
    v_cvt_pk_bf16_f32 v113, v114, v115
    s_waitcnt lgkmcnt(6)
    v_mfma_f32_16x16x32_bf16 v[16:19], v[200:203], v[80:83], v[16:19]
    v_exp_f32 v118, v118
    v_add_f32 v252, v252, v116
    v_exp_f32 v119, v119
    v_mfma_f32_16x16x32_bf16 v[24:27], v[200:203], v[88:91], v[24:27]
    ds_read_b64_tr_b16 v[216:217], v234 offset:8192
    ds_read_b64_tr_b16 v[218:219], v234 offset:12288
    v_add_f32 v252, v252, v117
    v_cvt_pk_bf16_f32 v114, v116, v117
    s_waitcnt lgkmcnt(6)
    v_mfma_f32_16x16x32_bf16 v[20:23], v[204:207], v[80:83], v[20:23]
    v_exp_f32 v120, v120
    v_add_f32 v253, v253, v118
    v_exp_f32 v121, v121
    v_mfma_f32_16x16x32_bf16 v[28:31], v[204:207], v[88:91], v[28:31]
    ds_read_b64_tr_b16 v[220:221], v235 offset:8192
    ds_read_b64_tr_b16 v[222:223], v235 offset:12288
    v_add_f32 v253, v253, v119
    v_cvt_pk_bf16_f32 v115, v118, v119
    s_waitcnt lgkmcnt(6)
    v_mfma_f32_16x16x32_bf16 v[32:35], v[208:211], v[80:83], v[32:35]
    v_exp_f32 v122, v122
    v_add_f32 v254, v254, v120
    v_mfma_f32_16x16x32_bf16 v[40:43], v[208:211], v[88:91], v[40:43]
    ds_read_b64_tr_b16 v[192:193], v228 offset:16384
    ds_read_b64_tr_b16 v[194:195], v228 offset:20480
    v_exp_f32 v123, v123
    v_add_f32 v254, v254, v121
    v_cvt_pk_bf16_f32 v120, v120, v121
    s_waitcnt lgkmcnt(6)
    v_mfma_f32_16x16x32_bf16 v[36:39], v[212:215], v[80:83], v[36:39]
    v_exp_f32 v124, v124
    v_add_f32 v255, v255, v122
    v_mfma_f32_16x16x32_bf16 v[44:47], v[212:215], v[88:91], v[44:47]
    ds_read_b64_tr_b16 v[196:197], v229 offset:16384
    ds_read_b64_tr_b16 v[198:199], v229 offset:20480
    v_exp_f32 v125, v125
    v_add_f32 v255, v255, v123
    v_cvt_pk_bf16_f32 v121, v122, v123
    s_waitcnt lgkmcnt(6)
    v_mfma_f32_16x16x32_bf16 v[48:51], v[216:219], v[80:83], v[48:51]
    v_exp_f32 v126, v126
    v_add_f32 v254, v254, v124
    v_mfma_f32_16x16x32_bf16 v[56:59], v[216:219], v[88:91], v[56:59]
    ds_read_b64_tr_b16 v[200:201], v230 offset:16384
    ds_read_b64_tr_b16 v[202:203], v230 offset:20480
    v_exp_f32 v127, v127
    v_add_f32 v254, v254, v125
    v_cvt_pk_bf16_f32 v122, v124, v125
    s_waitcnt lgkmcnt(6)
    v_mfma_f32_16x16x32_bf16 v[52:55], v[220:223], v[80:83], v[52:55]
    v_add_f32 v255, v255, v126
    v_add_f32 v255, v255, v127
    v_mfma_f32_16x16x32_bf16 v[60:63], v[220:223], v[88:91], v[60:63]
    ds_read_b64_tr_b16 v[204:205], v231 offset:16384
    ds_read_b64_tr_b16 v[206:207], v231 offset:20480
    v_cvt_pk_bf16_f32 v123, v126, v127
    v_add_f32 v252, v252, v253
    v_add_f32 v254, v254, v255
    v_max_f32 v239, v252, v254
    v_cmp_lt_f32 vcc, 0x46800000, v239
    s_cbranch_vccnz L_slow_2_5
L_back_2_5:
    v_add_f32 v248, v248, v252
    v_add_f32 v249, v249, v254
    s_waitcnt lgkmcnt(6)
    v_mfma_f32_16x16x32_bf16 v[0:3], v[192:195], v[96:99], v[0:3]
    v_mfma_f32_16x16x32_bf16 v[8:11], v[192:195], v[104:107], v[8:11]
    ds_read_b64_tr_b16 v[208:209], v232 offset:16384
    ds_read_b64_tr_b16 v[210:211], v232 offset:20480
    v_mov_b32 v250, v248
    s_waitcnt lgkmcnt(6)
    v_mfma_f32_16x16x32_bf16 v[4:7], v[196:199], v[96:99], v[4:7]
    v_mfma_f32_16x16x32_bf16 v[12:15], v[196:199], v[104:107], v[12:15]
    ds_read_b64_tr_b16 v[212:213], v233 offset:16384
    ds_read_b64_tr_b16 v[214:215], v233 offset:20480
    v_mov_b32 v251, v249
    s_waitcnt lgkmcnt(6)
    v_mfma_f32_16x16x32_bf16 v[16:19], v[200:203], v[96:99], v[16:19]
    v_mfma_f32_16x16x32_bf16 v[24:27], v[200:203], v[104:107], v[24:27]
    ds_read_b64_tr_b16 v[216:217], v234 offset:16384
    ds_read_b64_tr_b16 v[218:219], v234 offset:20480
    v_mov_b32 v252, v250
    s_waitcnt lgkmcnt(6)
    v_mfma_f32_16x16x32_bf16 v[20:23], v[204:207], v[96:99], v[20:23]
    v_mfma_f32_16x16x32_bf16 v[28:31], v[204:207], v[104:107], v[28:31]
    ds_read_b64_tr_b16 v[220:221], v235 offset:16384
    ds_read_b64_tr_b16 v[222:223], v235 offset:20480
    v_mov_b32 v253, v251
    s_waitcnt lgkmcnt(6)
    v_mfma_f32_16x16x32_bf16 v[32:35], v[208:211], v[96:99], v[32:35]
    v_mfma_f32_16x16x32_bf16 v[40:43], v[208:211], v[104:107], v[40:43]
    ds_read_b64_tr_b16 v[192:193], v228 offset:24576
    ds_read_b64_tr_b16 v[194:195], v228 offset:28672
    v_permlane16_swap_b32 v250, v252
    s_waitcnt lgkmcnt(6)
    v_mfma_f32_16x16x32_bf16 v[36:39], v[212:215], v[96:99], v[36:39]
    v_mfma_f32_16x16x32_bf16 v[44:47], v[212:215], v[104:107], v[44:47]
    ds_read_b64_tr_b16 v[196:197], v229 offset:24576
    ds_read_b64_tr_b16 v[198:199], v229 offset:28672
    v_permlane16_swap_b32 v251, v253
    s_waitcnt lgkmcnt(6)
    v_mfma_f32_16x16x32_bf16 v[48:51], v[216:219], v[96:99], v[48:51]
    v_mfma_f32_16x16x32_bf16 v[56:59], v[216:219], v[104:107], v[56:59]
    ds_read_b64_tr_b16 v[200:201], v230 offset:24576
    ds_read_b64_tr_b16 v[202:203], v230 offset:28672
    v_add_f32 v250, v250, v252
    s_waitcnt lgkmcnt(6)
    v_mfma_f32_16x16x32_bf16 v[52:55], v[220:223], v[96:99], v[52:55]
    v_mfma_f32_16x16x32_bf16 v[60:63], v[220:223], v[104:107], v[60:63]
    ds_read_b64_tr_b16 v[204:205], v231 offset:24576
    ds_read_b64_tr_b16 v[206:207], v231 offset:28672
    v_add_f32 v251, v251, v253
    s_waitcnt lgkmcnt(6)
    v_mfma_f32_16x16x32_bf16 v[0:3], v[192:195], v[112:115], v[0:3]
    v_mfma_f32_16x16x32_bf16 v[8:11], v[192:195], v[120:123], v[8:11]
    ds_read_b64_tr_b16 v[208:209], v232 offset:24576
    ds_read_b64_tr_b16 v[210:211], v232 offset:28672
    v_mov_b32 v252, v250
    s_waitcnt lgkmcnt(6)
    v_mfma_f32_16x16x32_bf16 v[4:7], v[196:199], v[112:115], v[4:7]
    v_mfma_f32_16x16x32_bf16 v[12:15], v[196:199], v[120:123], v[12:15]
    ds_read_b64_tr_b16 v[212:213], v233 offset:24576
    ds_read_b64_tr_b16 v[214:215], v233 offset:28672
    v_mov_b32 v253, v251
    s_waitcnt lgkmcnt(6)
    v_mfma_f32_16x16x32_bf16 v[16:19], v[200:203], v[112:115], v[16:19]
    v_mfma_f32_16x16x32_bf16 v[24:27], v[200:203], v[120:123], v[24:27]
    ds_read_b64_tr_b16 v[216:217], v234 offset:24576
    ds_read_b64_tr_b16 v[218:219], v234 offset:28672
    v_permlane32_swap_b32 v250, v252
    s_waitcnt lgkmcnt(6)
    v_mfma_f32_16x16x32_bf16 v[20:23], v[204:207], v[112:115], v[20:23]
    v_mfma_f32_16x16x32_bf16 v[28:31], v[204:207], v[120:123], v[28:31]
    ds_read_b64_tr_b16 v[220:221], v235 offset:24576
    ds_read_b64_tr_b16 v[222:223], v235 offset:28672
    v_permlane32_swap_b32 v251, v253
    s_waitcnt lgkmcnt(6)
    v_mfma_f32_16x16x32_bf16 v[32:35], v[208:211], v[112:115], v[32:35]
    v_mfma_f32_16x16x32_bf16 v[40:43], v[208:211], v[120:123], v[40:43]
    v_add_f32 v250, v250, v252
    s_waitcnt lgkmcnt(4)
    v_mfma_f32_16x16x32_bf16 v[36:39], v[212:215], v[112:115], v[36:39]
    v_mfma_f32_16x16x32_bf16 v[44:47], v[212:215], v[120:123], v[44:47]
    v_add_f32 v251, v251, v253
    s_waitcnt lgkmcnt(2)
    v_mfma_f32_16x16x32_bf16 v[48:51], v[216:219], v[112:115], v[48:51]
    v_mfma_f32_16x16x32_bf16 v[56:59], v[216:219], v[120:123], v[56:59]
    v_rcp_f32 v250, v250
    s_waitcnt lgkmcnt(0)
    v_mfma_f32_16x16x32_bf16 v[52:55], v[220:223], v[112:115], v[52:55]
    v_mfma_f32_16x16x32_bf16 v[60:63], v[220:223], v[120:123], v[60:63]
    v_rcp_f32 v251, v251
    s_cmp_lg_u32 s39, 0
    s_cbranch_scc1 L_nog9
    s_waitcnt vmcnt(0)
    s_barrier
L_nog9:
    s_nop 7
    v_xor_b32 v239, 64, v237
    v_mul_f32 v0, v0, v250
    v_mul_f32 v1, v1, v250
    v_mul_f32 v2, v2, v250
    v_mul_f32 v3, v3, v250
    v_mul_f32 v4, v4, v250
    v_mul_f32 v5, v5, v250
    v_mul_f32 v6, v6, v250
    v_mul_f32 v7, v7, v250
    v_cvt_pk_bf16_f32 v0, v0, v1
    v_cvt_pk_bf16_f32 v1, v2, v3
    v_cvt_pk_bf16_f32 v2, v4, v5
    v_cvt_pk_bf16_f32 v3, v6, v7
    s_nop 0
    v_permlane16_swap_b32 v0, v2
    v_permlane16_swap_b32 v1, v3
    v_mul_f32 v16, v16, v250
    v_mul_f32 v17, v17, v250
    v_mul_f32 v18, v18, v250
    v_mul_f32 v19, v19, v250
    v_mul_f32 v20, v20, v250
    v_mul_f32 v21, v21, v250
    v_mul_f32 v22, v22, v250
    v_mul_f32 v23, v23, v250
    v_cvt_pk_bf16_f32 v16, v16, v17
    v_cvt_pk_bf16_f32 v17, v18, v19
    v_cvt_pk_bf16_f32 v18, v20, v21
    v_cvt_pk_bf16_f32 v19, v22, v23
    s_nop 0
    v_permlane16_swap_b32 v16, v18
    v_permlane16_swap_b32 v17, v19
    s_nop 0
    v_mov_b32_dpp v4, v16 row_ror:8 row_mask:0xf bank_mask:0xf
    v_mov_b32_dpp v5, v17 row_ror:8 row_mask:0xf bank_mask:0xf
    v_mov_b32_dpp v6, v18 row_ror:8 row_mask:0xf bank_mask:0xf
    v_mov_b32_dpp v7, v19 row_ror:8 row_mask:0xf bank_mask:0xf
    v_cndmask_b32 v16, v4, v0, s[96:97]
    v_cndmask_b32 v17, v5, v1, s[96:97]
    v_cndmask_b32 v18, v6, v2, s[96:97]
    v_cndmask_b32 v19, v7, v3, s[96:97]
    v_cndmask_b32 v0, v0, v4, s[96:97]
    v_cndmask_b32 v1, v1, v5, s[96:97]
    v_cndmask_b32 v2, v2, v6, s[96:97]
    v_cndmask_b32 v3, v3, v7, s[96:97]
    buffer_store_dwordx4 v[0:3], v237, s[24:27], s35 offen offset:0 sc1
    buffer_store_dwordx4 v[16:19], v239, s[24:27], s35 offen offset:2048 sc1
    v_mul_f32 v8, v8, v251
    v_mul_f32 v9, v9, v251
    v_mul_f32 v10, v10, v251
    v_mul_f32 v11, v11, v251
    v_mul_f32 v12, v12, v251
    v_mul_f32 v13, v13, v251
    v_mul_f32 v14, v14, v251
    v_mul_f32 v15, v15, v251
    v_cvt_pk_bf16_f32 v8, v8, v9
    v_cvt_pk_bf16_f32 v9, v10, v11
    v_cvt_pk_bf16_f32 v10, v12, v13
    v_cvt_pk_bf16_f32 v11, v14, v15
    s_nop 0
    v_permlane16_swap_b32 v8, v10
    v_permlane16_swap_b32 v9, v11
    v_mul_f32 v24, v24, v251
    v_mul_f32 v25, v25, v251
    v_mul_f32 v26, v26, v251
    v_mul_f32 v27, v27, v251
    v_mul_f32 v28, v28, v251
    v_mul_f32 v29, v29, v251
    v_mul_f32 v30, v30, v251
    v_mul_f32 v31, v31, v251
    v_cvt_pk_bf16_f32 v24, v24, v25
    v_cvt_pk_bf16_f32 v25, v26, v27
    v_cvt_pk_bf16_f32 v26, v28, v29
    v_cvt_pk_bf16_f32 v27, v30, v31
    s_nop 0
    v_permlane16_swap_b32 v24, v26
    v_permlane16_swap_b32 v25, v27
    s_nop 0
    v_mov_b32_dpp v12, v24 row_ror:8 row_mask:0xf bank_mask:0xf
    v_mov_b32_dpp v13, v25 row_ror:8 row_mask:0xf bank_mask:0xf
    v_mov_b32_dpp v14, v26 row_ror:8 row_mask:0xf bank_mask:0xf
    v_mov_b32_dpp v15, v27 row_ror:8 row_mask:0xf bank_mask:0xf
    v_cndmask_b32 v24, v12, v8, s[96:97]
    v_cndmask_b32 v25, v13, v9, s[96:97]
    v_cndmask_b32 v26, v14, v10, s[96:97]
    v_cndmask_b32 v27, v15, v11, s[96:97]
    v_cndmask_b32 v8, v8, v12, s[96:97]
    v_cndmask_b32 v9, v9, v13, s[96:97]
    v_cndmask_b32 v10, v10, v14, s[96:97]
    v_cndmask_b32 v11, v11, v15, s[96:97]
    buffer_store_dwordx4 v[8:11], v237, s[24:27], s95 offen offset:0 sc1
    buffer_store_dwordx4 v[24:27], v239, s[24:27], s95 offen offset:2048 sc1
    v_mul_f32 v32, v32, v250
    v_mul_f32 v33, v33, v250
    v_mul_f32 v34, v34, v250
    v_mul_f32 v35, v35, v250
    v_mul_f32 v36, v36, v250
    v_mul_f32 v37, v37, v250
    v_mul_f32 v38, v38, v250
    v_mul_f32 v39, v39, v250
    v_cvt_pk_bf16_f32 v32, v32, v33
    v_cvt_pk_bf16_f32 v33, v34, v35
    v_cvt_pk_bf16_f32 v34, v36, v37
    v_cvt_pk_bf16_f32 v35, v38, v39
    s_nop 0
    v_permlane16_swap_b32 v32, v34
    v_permlane16_swap_b32 v33, v35
    v_mul_f32 v48, v48, v250
    v_mul_f32 v49, v49, v250
    v_mul_f32 v50, v50, v250
    v_mul_f32 v51, v51, v250
    v_mul_f32 v52, v52, v250
    v_mul_f32 v53, v53, v250
    v_mul_f32 v54, v54, v250
    v_mul_f32 v55, v55, v250
    v_cvt_pk_bf16_f32 v48, v48, v49
    v_cvt_pk_bf16_f32 v49, v50, v51
    v_cvt_pk_bf16_f32 v50, v52, v53
    v_cvt_pk_bf16_f32 v51, v54, v55
    s_nop 0
    v_permlane16_swap_b32 v48, v50
    v_permlane16_swap_b32 v49, v51
    s_nop 0
    v_mov_b32_dpp v36, v48 row_ror:8 row_mask:0xf bank_mask:0xf
    v_mov_b32_dpp v37, v49 row_ror:8 row_mask:0xf bank_mask:0xf
    v_mov_b32_dpp v38, v50 row_ror:8 row_mask:0xf bank_mask:0xf
    v_mov_b32_dpp v39, v51 row_ror:8 row_mask:0xf bank_mask:0xf
    v_cndmask_b32 v48, v36, v32, s[96:97]
    v_cndmask_b32 v49, v37, v33, s[96:97]
    v_cndmask_b32 v50, v38, v34, s[96:97]
    v_cndmask_b32 v51, v39, v35, s[96:97]
    v_cndmask_b32 v32, v32, v36, s[96:97]
    v_cndmask_b32 v33, v33, v37, s[96:97]
    v_cndmask_b32 v34, v34, v38, s[96:97]
    v_cndmask_b32 v35, v35, v39, s[96:97]
    buffer_store_dwordx4 v[32:35], v237, s[24:27], s35 offen offset:128 sc1
    buffer_store_dwordx4 v[48:51], v239, s[24:27], s35 offen offset:2176 sc1
    v_mul_f32 v40, v40, v251
    v_mul_f32 v41, v41, v251
    v_mul_f32 v42, v42, v251
    v_mul_f32 v43, v43, v251
    v_mul_f32 v44, v44, v251
    v_mul_f32 v45, v45, v251
    v_mul_f32 v46, v46, v251
    v_mul_f32 v47, v47, v251
    v_cvt_pk_bf16_f32 v40, v40, v41
    v_cvt_pk_bf16_f32 v41, v42, v43
    v_cvt_pk_bf16_f32 v42, v44, v45
    v_cvt_pk_bf16_f32 v43, v46, v47
    s_nop 0
    v_permlane16_swap_b32 v40, v42
    v_permlane16_swap_b32 v41, v43
    v_mul_f32 v56, v56, v251
    v_mul_f32 v57, v57, v251
    v_mul_f32 v58, v58, v251
    v_mul_f32 v59, v59, v251
    v_mul_f32 v60, v60, v251
    v_mul_f32 v61, v61, v251
    v_mul_f32 v62, v62, v251
    v_mul_f32 v63, v63, v251
    v_cvt_pk_bf16_f32 v56, v56, v57
    v_cvt_pk_bf16_f32 v57, v58, v59
    v_cvt_pk_bf16_f32 v58, v60, v61
    v_cvt_pk_bf16_f32 v59, v62, v63
    s_nop 0
    v_permlane16_swap_b32 v56, v58
    v_permlane16_swap_b32 v57, v59
    s_nop 0
    v_mov_b32_dpp v44, v56 row_ror:8 row_mask:0xf bank_mask:0xf
    v_mov_b32_dpp v45, v57 row_ror:8 row_mask:0xf bank_mask:0xf
    v_mov_b32_dpp v46, v58 row_ror:8 row_mask:0xf bank_mask:0xf
    v_mov_b32_dpp v47, v59 row_ror:8 row_mask:0xf bank_mask:0xf
    v_cndmask_b32 v56, v44, v40, s[96:97]
    v_cndmask_b32 v57, v45, v41, s[96:97]
    v_cndmask_b32 v58, v46, v42, s[96:97]
    v_cndmask_b32 v59, v47, v43, s[96:97]
    v_cndmask_b32 v40, v40, v44, s[96:97]
    v_cndmask_b32 v41, v41, v45, s[96:97]
    v_cndmask_b32 v42, v42, v46, s[96:97]
    v_cndmask_b32 v43, v43, v47, s[96:97]
    buffer_store_dwordx4 v[40:43], v237, s[24:27], s95 offen offset:128 sc1
    buffer_store_dwordx4 v[56:59], v239, s[24:27], s95 offen offset:2176 sc1
L_end:
    s_endpgm
L_slow_0_1:
    s_nop 15
    v_add_u32 v239, s42, v224
    v_subrev_u32 v239, s43, v239
    ds_read_b128 v[252:255], v239 offset:16384
    s_waitcnt lgkmcnt(0)
    v_mfma_f32_16x16x32_bf16 v[96:99], v[252:255], v[128:131], 0
    v_mfma_f32_16x16x32_bf16 v[104:107], v[252:255], v[144:147], 0
    s_nop 3
    v_add_u32 v239, s42, v225
    v_subrev_u32 v239, s43, v239
    ds_read_b128 v[252:255], v239 offset:16384
    s_waitcnt lgkmcnt(0)
    v_mfma_f32_16x16x32_bf16 v[96:99], v[252:255], v[132:135], v[96:99]
    v_mfma_f32_16x16x32_bf16 v[104:107], v[252:255], v[148:151], v[104:107]
    s_nop 3
    v_add_u32 v239, s42, v226
    v_subrev_u32 v239, s43, v239
    ds_read_b128 v[252:255], v239 offset:16384
    s_waitcnt lgkmcnt(0)
    v_mfma_f32_16x16x32_bf16 v[96:99], v[252:255], v[136:139], v[96:99]
    v_mfma_f32_16x16x32_bf16 v[104:107], v[252:255], v[152:155], v[104:107]
    s_nop 3
    v_add_u32 v239, s42, v227
    v_subrev_u32 v239, s43, v239
    ds_read_b128 v[252:255], v239 offset:16384
    s_waitcnt lgkmcnt(0)
    v_mfma_f32_16x16x32_bf16 v[96:99], v[252:255], v[140:143], v[96:99]
    v_mfma_f32_16x16x32_bf16 v[104:107], v[252:255], v[156:159], v[104:107]
    s_nop 3
    v_add_u32 v239, s42, v224
    v_subrev_u32 v239, s43, v239
    ds_read_b128 v[252:255], v239 offset:20480
    s_waitcnt lgkmcnt(0)
    v_mfma_f32_16x16x32_bf16 v[100:103], v[252:255], v[128:131], 0
    v_mfma_f32_16x16x32_bf16 v[108:111], v[252:255], v[144:147], 0
    s_nop 3
    v_add_u32 v239, s42, v225
    v_subrev_u32 v239, s43, v239
    ds_read_b128 v[252:255], v239 offset:20480
    s_waitcnt lgkmcnt(0)
    v_mfma_f32_16x16x32_bf16 v[100:103], v[252:255], v[132:135], v[100:103]
    v_mfma_f32_16x16x32_bf16 v[108:111], v[252:255], v[148:151], v[108:111]
    s_nop 3
    v_add_u32 v239, s42, v226
    v_subrev_u32 v239, s43, v239
    ds_read_b128 v[252:255], v239 offset:20480
    s_waitcnt lgkmcnt(0)
    v_mfma_f32_16x16x32_bf16 v[100:103], v[252:255], v[136:139], v[100:103]
    v_mfma_f32_16x16x32_bf16 v[108:111], v[252:255], v[152:155], v[108:111]
    s_nop 3
    v_add_u32 v239, s42, v227
    v_subrev_u32 v239, s43, v239
    ds_read_b128 v[252:255], v239 offset:20480
    s_waitcnt lgkmcnt(0)
    v_mfma_f32_16x16x32_bf16 v[100:103], v[252:255], v[140:143], v[100:103]
    v_mfma_f32_16x16x32_bf16 v[108:111], v[252:255], v[156:159], v[108:111]
    s_nop 3
    v_add_u32 v239, s42, v224
    v_subrev_u32 v239, s43, v239
    ds_read_b128 v[252:255], v239 offset:24576
    s_waitcnt lgkmcnt(0)
    v_mfma_f32_16x16x32_bf16 v[112:115], v[252:255], v[128:131], 0
    v_mfma_f32_16x16x32_bf16 v[120:123], v[252:255], v[144:147], 0
    s_nop 3
    v_add_u32 v239, s42, v225
    v_subrev_u32 v239, s43, v239
    ds_read_b128 v[252:255], v239 offset:24576
    s_waitcnt lgkmcnt(0)
    v_mfma_f32_16x16x32_bf16 v[112:115], v[252:255], v[132:135], v[112:115]
    v_mfma_f32_16x16x32_bf16 v[120:123], v[252:255], v[148:151], v[120:123]
    s_nop 3
    v_add_u32 v239, s42, v226
    v_subrev_u32 v239, s43, v239
    ds_read_b128 v[252:255], v239 offset:24576
    s_waitcnt lgkmcnt(0)
    v_mfma_f32_16x16x32_bf16 v[112:115], v[252:255], v[136:139], v[112:115]
    v_mfma_f32_16x16x32_bf16 v[120:123], v[252:255], v[152:155], v[120:123]
    s_nop 3
    v_add_u32 v239, s42, v227
    v_subrev_u32 v239, s43, v239
    ds_read_b128 v[252:255], v239 offset:24576
    s_waitcnt lgkmcnt(0)
    v_mfma_f32_16x16x32_bf16 v[112:115], v[252:255], v[140:143], v[112:115]
    v_mfma_f32_16x16x32_bf16 v[120:123], v[252:255], v[156:159], v[120:123]
    s_nop 3
    v_add_u32 v239, s42, v224
    v_subrev_u32 v239, s43, v239
    ds_read_b128 v[252:255], v239 offset:28672
    s_waitcnt lgkmcnt(0)
    v_mfma_f32_16x16x32_bf16 v[116:119], v[252:255], v[128:131], 0
    v_mfma_f32_16x16x32_bf16 v[124:127], v[252:255], v[144:147], 0
    s_nop 3
    v_add_u32 v239, s42, v225
    v_subrev_u32 v239, s43, v239
    ds_read_b128 v[252:255], v239 offset:28672
    s_waitcnt lgkmcnt(0)
    v_mfma_f32_16x16x32_bf16 v[116:119], v[252:255], v[132:135], v[116:119]
    v_mfma_f32_16x16x32_bf16 v[124:127], v[252:255], v[148:151], v[124:127]
    s_nop 3
    v_add_u32 v239, s42, v226
    v_subrev_u32 v239, s43, v239
    ds_read_b128 v[252:255], v239 offset:28672
    s_waitcnt lgkmcnt(0)
    v_mfma_f32_16x16x32_bf16 v[116:119], v[252:255], v[136:139], v[116:119]
    v_mfma_f32_16x16x32_bf16 v[124:127], v[252:255], v[152:155], v[124:127]
    s_nop 3
    v_add_u32 v239, s42, v227
    v_subrev_u32 v239, s43, v239
    ds_read_b128 v[252:255], v239 offset:28672
    s_waitcnt lgkmcnt(0)
    v_mfma_f32_16x16x32_bf16 v[116:119], v[252:255], v[140:143], v[116:119]
    v_mfma_f32_16x16x32_bf16 v[124:127], v[252:255], v[156:159], v[124:127]
    s_nop 3
    s_nop 15
    v_max3_f32 v252, v96, v97, v98
    v_max3_f32 v254, v104, v105, v106
    v_max3_f32 v252, v252, v99, v100
    v_max3_f32 v254, v254, v107, v108
    v_max3_f32 v252, v252, v101, v102
    v_max3_f32 v254, v254, v109, v110
    v_max3_f32 v252, v252, v103, v112
    v_max3_f32 v254, v254, v111, v120
    v_max3_f32 v252, v252, v113, v114
    v_max3_f32 v254, v254, v121, v122
    v_max3_f32 v252, v252, v115, v116
    v_max3_f32 v254, v254, v123, v124
    v_max3_f32 v252, v252, v117, v118
    v_max3_f32 v254, v254, v125, v126
    v_max_f32 v252, v252, v119
    v_max_f32 v254, v254, v127
    v_mov_b32 v253, v252
    v_mov_b32 v255, v254
    s_nop 0
    v_permlane16_swap_b32 v252, v253
    v_permlane16_swap_b32 v254, v255
    v_max_f32 v252, v252, v253
    v_max_f32 v254, v254, v255
    v_mov_b32 v253, v252
    v_mov_b32 v255, v254
    s_nop 0
    v_permlane32_swap_b32 v252, v253
    v_permlane32_swap_b32 v254, v255
    v_max_f32 v252, v252, v253
    v_max_f32 v254, v254, v255
    v_sub_f32 v252, 0, v252
    v_min_f32 v252, v252, v240
    v_sub_f32 v253, v252, v240
    v_exp_f32 v250, v253
    v_mov_b32 v240, v252
    v_mov_b32 v241, v252
    v_mov_b32 v242, v252
    v_mov_b32 v243, v252
    v_mul_f32 v248, v248, v250
    v_mul_f32 v0, v0, v250
    v_mul_f32 v1, v1, v250
    v_mul_f32 v2, v2, v250
    v_mul_f32 v3, v3, v250
    v_mul_f32 v4, v4, v250
    v_mul_f32 v5, v5, v250
    v_mul_f32 v6, v6, v250
    v_mul_f32 v7, v7, v250
    v_mul_f32 v16, v16, v250
    v_mul_f32 v17, v17, v250
    v_mul_f32 v18, v18, v250
    v_mul_f32 v19, v19, v250
    v_mul_f32 v20, v20, v250
    v_mul_f32 v21, v21, v250
    v_mul_f32 v22, v22, v250
    v_mul_f32 v23, v23, v250
    v_mul_f32 v32, v32, v250
    v_mul_f32 v33, v33, v250
    v_mul_f32 v34, v34, v250
    v_mul_f32 v35, v35, v250
    v_mul_f32 v36, v36, v250
    v_mul_f32 v37, v37, v250
    v_mul_f32 v38, v38, v250
    v_mul_f32 v39, v39, v250
    v_mul_f32 v48, v48, v250
    v_mul_f32 v49, v49, v250
    v_mul_f32 v50, v50, v250
    v_mul_f32 v51, v51, v250
    v_mul_f32 v52, v52, v250
    v_mul_f32 v53, v53, v250
    v_mul_f32 v54, v54, v250
    v_mul_f32 v55, v55, v250
    v_add_f32 v64, v64, v253
    v_add_f32 v65, v65, v253
    v_add_f32 v66, v66, v253
    v_add_f32 v67, v67, v253
    v_add_f32 v68, v68, v253
    v_add_f32 v69, v69, v253
    v_add_f32 v70, v70, v253
    v_add_f32 v71, v71, v253
    v_add_f32 v80, v80, v253
    v_add_f32 v81, v81, v253
    v_add_f32 v82, v82, v253
    v_add_f32 v83, v83, v253
    v_add_f32 v84, v84, v253
    v_add_f32 v85, v85, v253
    v_add_f32 v86, v86, v253
    v_add_f32 v87, v87, v253
    v_sub_f32 v254, 0, v254
    v_min_f32 v254, v254, v244
    v_sub_f32 v255, v254, v244
    v_exp_f32 v251, v255
    v_mov_b32 v244, v254
    v_mov_b32 v245, v254
    v_mov_b32 v246, v254
    v_mov_b32 v247, v254
    v_mul_f32 v249, v249, v251
    v_mul_f32 v8, v8, v251
    v_mul_f32 v9, v9, v251
    v_mul_f32 v10, v10, v251
    v_mul_f32 v11, v11, v251
    v_mul_f32 v12, v12, v251
    v_mul_f32 v13, v13, v251
    v_mul_f32 v14, v14, v251
    v_mul_f32 v15, v15, v251
    v_mul_f32 v24, v24, v251
    v_mul_f32 v25, v25, v251
    v_mul_f32 v26, v26, v251
    v_mul_f32 v27, v27, v251
    v_mul_f32 v28, v28, v251
    v_mul_f32 v29, v29, v251
    v_mul_f32 v30, v30, v251
    v_mul_f32 v31, v31, v251
    v_mul_f32 v40, v40, v251
    v_mul_f32 v41, v41, v251
    v_mul_f32 v42, v42, v251
    v_mul_f32 v43, v43, v251
    v_mul_f32 v44, v44, v251
    v_mul_f32 v45, v45, v251
    v_mul_f32 v46, v46, v251
    v_mul_f32 v47, v47, v251
    v_mul_f32 v56, v56, v251
    v_mul_f32 v57, v57, v251
    v_mul_f32 v58, v58, v251
    v_mul_f32 v59, v59, v251
    v_mul_f32 v60, v60, v251
    v_mul_f32 v61, v61, v251
    v_mul_f32 v62, v62, v251
    v_mul_f32 v63, v63, v251
    v_add_f32 v72, v72, v255
    v_add_f32 v73, v73, v255
    v_add_f32 v74, v74, v255
    v_add_f32 v75, v75, v255
    v_add_f32 v76, v76, v255
    v_add_f32 v77, v77, v255
    v_add_f32 v78, v78, v255
    v_add_f32 v79, v79, v255
    v_add_f32 v88, v88, v255
    v_add_f32 v89, v89, v255
    v_add_f32 v90, v90, v255
    v_add_f32 v91, v91, v255
    v_add_f32 v92, v92, v255
    v_add_f32 v93, v93, v255
    v_add_f32 v94, v94, v255
    v_add_f32 v95, v95, v255
    v_add_f32 v96, v96, v241
    v_add_f32 v97, v97, v242
    v_exp_f32 v96, v96
    v_add_f32 v98, v98, v243
    v_exp_f32 v97, v97
    v_add_f32 v99, v99, v240
    v_exp_f32 v98, v98
    v_add_f32 v100, v100, v241
    v_exp_f32 v99, v99
    v_add_f32 v252, v96, v97
    v_cvt_pk_bf16_f32 v96, v96, v97
    v_add_f32 v101, v101, v242
    v_exp_f32 v100, v100
    v_add_f32 v102, v102, v243
    v_exp_f32 v101, v101
    v_add_f32 v253, v98, v99
    v_cvt_pk_bf16_f32 v97, v98, v99
    v_add_f32 v103, v103, v240
    v_exp_f32 v102, v102
    v_add_f32 v252, v252, v100
    v_add_f32 v104, v104, v245
    v_exp_f32 v103, v103
    v_add_f32 v252, v252, v101
    v_cvt_pk_bf16_f32 v98, v100, v101
    v_add_f32 v105, v105, v246
    v_exp_f32 v104, v104
    v_add_f32 v253, v253, v102
    v_add_f32 v106, v106, v247
    v_exp_f32 v105, v105
    v_add_f32 v253, v253, v103
    v_cvt_pk_bf16_f32 v99, v102, v103
    v_add_f32 v107, v107, v244
    v_exp_f32 v106, v106
    v_add_f32 v108, v108, v245
    v_exp_f32 v107, v107
    v_add_f32 v254, v104, v105
    v_cvt_pk_bf16_f32 v104, v104, v105
    v_add_f32 v109, v109, v246
    v_exp_f32 v108, v108
    v_add_f32 v110, v110, v247
    v_exp_f32 v109, v109
    v_add_f32 v255, v106, v107
    v_cvt_pk_bf16_f32 v105, v106, v107
    v_add_f32 v111, v111, v244
    v_exp_f32 v110, v110
    v_add_f32 v254, v254, v108
    v_add_f32 v112, v112, v241
    v_exp_f32 v111, v111
    v_add_f32 v254, v254, v109
    v_cvt_pk_bf16_f32 v106, v108, v109
    v_add_f32 v113, v113, v242
    v_exp_f32 v112, v112
    v_add_f32 v255, v255, v110
    v_add_f32 v114, v114, v243
    v_exp_f32 v113, v113
    v_add_f32 v255, v255, v111
    v_cvt_pk_bf16_f32 v107, v110, v111
    v_add_f32 v115, v115, v240
    v_exp_f32 v114, v114
    v_add_f32 v252, v252, v112
    v_add_f32 v116, v116, v241
    v_exp_f32 v115, v115
    v_add_f32 v252, v252, v113
    v_cvt_pk_bf16_f32 v112, v112, v113
    v_add_f32 v117, v117, v242
    v_exp_f32 v116, v116
    v_add_f32 v253, v253, v114
    v_add_f32 v118, v118, v243
    v_exp_f32 v117, v117
    v_add_f32 v253, v253, v115
    v_cvt_pk_bf16_f32 v113, v114, v115
    v_add_f32 v119, v119, v240
    v_exp_f32 v118, v118
    v_add_f32 v252, v252, v116
    v_add_f32 v120, v120, v245
    v_exp_f32 v119, v119
    v_add_f32 v252, v252, v117
    v_cvt_pk_bf16_f32 v114, v116, v117
    v_add_f32 v121, v121, v246
    v_exp_f32 v120, v120
    v_add_f32 v253, v253, v118
    v_add_f32 v122, v122, v247
    v_exp_f32 v121, v121
    v_add_f32 v253, v253, v119
    v_cvt_pk_bf16_f32 v115, v118, v119
    v_add_f32 v123, v123, v244
    v_exp_f32 v122, v122
    v_add_f32 v254, v254, v120
    v_add_f32 v124, v124, v245
    v_exp_f32 v123, v123
    v_add_f32 v254, v254, v121
    v_cvt_pk_bf16_f32 v120, v120, v121
    v_add_f32 v125, v125, v246
    v_exp_f32 v124, v124
    v_add_f32 v255, v255, v122
    v_add_f32 v126, v126, v247
    v_exp_f32 v125, v125
    v_add_f32 v255, v255, v123
    v_cvt_pk_bf16_f32 v121, v122, v123
    v_add_f32 v127, v127, v244
    v_exp_f32 v126, v126
    v_add_f32 v254, v254, v124
    v_exp_f32 v127, v127
    v_add_f32 v254, v254, v125
    v_cvt_pk_bf16_f32 v122, v124, v125
    v_add_f32 v255, v255, v126
    v_add_f32 v255, v255, v127
    v_cvt_pk_bf16_f32 v123, v126, v127
    v_add_f32 v252, v252, v253
    v_add_f32 v254, v254, v255
    s_nop 3
    s_branch L_back_0_1
L_slow_0_2:
    s_nop 15
    v_add_u32 v239, s43, v224
    v_subrev_u32 v239, s43, v239
    ds_read_b128 v[252:255], v239 offset:0
    s_waitcnt lgkmcnt(0)
    v_mfma_f32_16x16x32_bf16 v[64:67], v[252:255], v[128:131], 0
    v_mfma_f32_16x16x32_bf16 v[72:75], v[252:255], v[144:147], 0
    s_nop 3
    v_add_u32 v239, s43, v225
    v_subrev_u32 v239, s43, v239
    ds_read_b128 v[252:255], v239 offset:0
    s_waitcnt lgkmcnt(0)
    v_mfma_f32_16x16x32_bf16 v[64:67], v[252:255], v[132:135], v[64:67]
    v_mfma_f32_16x16x32_bf16 v[72:75], v[252:255], v[148:151], v[72:75]
    s_nop 3
    v_add_u32 v239, s43, v226
    v_subrev_u32 v239, s43, v239
    ds_read_b128 v[252:255], v239 offset:0
    s_waitcnt lgkmcnt(0)
    v_mfma_f32_16x16x32_bf16 v[64:67], v[252:255], v[136:139], v[64:67]
    v_mfma_f32_16x16x32_bf16 v[72:75], v[252:255], v[152:155], v[72:75]
    s_nop 3
    v_add_u32 v239, s43, v227
    v_subrev_u32 v239, s43, v239
    ds_read_b128 v[252:255], v239 offset:0
    s_waitcnt lgkmcnt(0)
    v_mfma_f32_16x16x32_bf16 v[64:67], v[252:255], v[140:143], v[64:67]
    v_mfma_f32_16x16x32_bf16 v[72:75], v[252:255], v[156:159], v[72:75]
    s_nop 3
    v_add_u32 v239, s43, v224
    v_subrev_u32 v239, s43, v239
    ds_read_b128 v[252:255], v239 offset:4096
    s_waitcnt lgkmcnt(0)
    v_mfma_f32_16x16x32_bf16 v[68:71], v[252:255], v[128:131], 0
    v_mfma_f32_16x16x32_bf16 v[76:79], v[252:255], v[144:147], 0
    s_nop 3
    v_add_u32 v239, s43, v225
    v_subrev_u32 v239, s43, v239
    ds_read_b128 v[252:255], v239 offset:4096
    s_waitcnt lgkmcnt(0)
    v_mfma_f32_16x16x32_bf16 v[68:71], v[252:255], v[132:135], v[68:71]
    v_mfma_f32_16x16x32_bf16 v[76:79], v[252:255], v[148:151], v[76:79]
    s_nop 3
    v_add_u32 v239, s43, v226
    v_subrev_u32 v239, s43, v239
    ds_read_b128 v[252:255], v239 offset:4096
    s_waitcnt lgkmcnt(0)
    v_mfma_f32_16x16x32_bf16 v[68:71], v[252:255], v[136:139], v[68:71]
    v_mfma_f32_16x16x32_bf16 v[76:79], v[252:255], v[152:155], v[76:79]
    s_nop 3
    v_add_u32 v239, s43, v227
    v_subrev_u32 v239, s43, v239
    ds_read_b128 v[252:255], v239 offset:4096
    s_waitcnt lgkmcnt(0)
    v_mfma_f32_16x16x32_bf16 v[68:71], v[252:255], v[140:143], v[68:71]
    v_mfma_f32_16x16x32_bf16 v[76:79], v[252:255], v[156:159], v[76:79]
    s_nop 3
    v_add_u32 v239, s43, v224
    v_subrev_u32 v239, s43, v239
    ds_read_b128 v[252:255], v239 offset:8192
    s_waitcnt lgkmcnt(0)
    v_mfma_f32_16x16x32_bf16 v[80:83], v[252:255], v[128:131], 0
    v_mfma_f32_16x16x32_bf16 v[88:91], v[252:255], v[144:147], 0
    s_nop 3
    v_add_u32 v239, s43, v225
    v_subrev_u32 v239, s43, v239
    ds_read_b128 v[252:255], v239 offset:8192
    s_waitcnt lgkmcnt(0)
    v_mfma_f32_16x16x32_bf16 v[80:83], v[252:255], v[132:135], v[80:83]
    v_mfma_f32_16x16x32_bf16 v[88:91], v[252:255], v[148:151], v[88:91]
    s_nop 3
    v_add_u32 v239, s43, v226
    v_subrev_u32 v239, s43, v239
    ds_read_b128 v[252:255], v239 offset:8192
    s_waitcnt lgkmcnt(0)
    v_mfma_f32_16x16x32_bf16 v[80:83], v[252:255], v[136:139], v[80:83]
    v_mfma_f32_16x16x32_bf16 v[88:91], v[252:255], v[152:155], v[88:91]
    s_nop 3
    v_add_u32 v239, s43, v227
    v_subrev_u32 v239, s43, v239
    ds_read_b128 v[252:255], v239 offset:8192
    s_waitcnt lgkmcnt(0)
    v_mfma_f32_16x16x32_bf16 v[80:83], v[252:255], v[140:143], v[80:83]
    v_mfma_f32_16x16x32_bf16 v[88:91], v[252:255], v[156:159], v[88:91]
    s_nop 3
    v_add_u32 v239, s43, v224
    v_subrev_u32 v239, s43, v239
    ds_read_b128 v[252:255], v239 offset:12288
    s_waitcnt lgkmcnt(0)
    v_mfma_f32_16x16x32_bf16 v[84:87], v[252:255], v[128:131], 0
    v_mfma_f32_16x16x32_bf16 v[92:95], v[252:255], v[144:147], 0
    s_nop 3
    v_add_u32 v239, s43, v225
    v_subrev_u32 v239, s43, v239
    ds_read_b128 v[252:255], v239 offset:12288
    s_waitcnt lgkmcnt(0)
    v_mfma_f32_16x16x32_bf16 v[84:87], v[252:255], v[132:135], v[84:87]
    v_mfma_f32_16x16x32_bf16 v[92:95], v[252:255], v[148:151], v[92:95]
    s_nop 3
    v_add_u32 v239, s43, v226
    v_subrev_u32 v239, s43, v239
    ds_read_b128 v[252:255], v239 offset:12288
    s_waitcnt lgkmcnt(0)
    v_mfma_f32_16x16x32_bf16 v[84:87], v[252:255], v[136:139], v[84:87]
    v_mfma_f32_16x16x32_bf16 v[92:95], v[252:255], v[152:155], v[92:95]
    s_nop 3
    v_add_u32 v239, s43, v227
    v_subrev_u32 v239, s43, v239
    ds_read_b128 v[252:255], v239 offset:12288
    s_waitcnt lgkmcnt(0)
    v_mfma_f32_16x16x32_bf16 v[84:87], v[252:255], v[140:143], v[84:87]
    v_mfma_f32_16x16x32_bf16 v[92:95], v[252:255], v[156:159], v[92:95]
    s_nop 3
    s_nop 15
    v_max3_f32 v252, v64, v65, v66
    v_max3_f32 v254, v72, v73, v74
    v_max3_f32 v252, v252, v67, v68
    v_max3_f32 v254, v254, v75, v76
    v_max3_f32 v252, v252, v69, v70
    v_max3_f32 v254, v254, v77, v78
    v_max3_f32 v252, v252, v71, v80
    v_max3_f32 v254, v254, v79, v88
    v_max3_f32 v252, v252, v81, v82
    v_max3_f32 v254, v254, v89, v90
    v_max3_f32 v252, v252, v83, v84
    v_max3_f32 v254, v254, v91, v92
    v_max3_f32 v252, v252, v85, v86
    v_max3_f32 v254, v254, v93, v94
    v_max_f32 v252, v252, v87
    v_max_f32 v254, v254, v95
    v_mov_b32 v253, v252
    v_mov_b32 v255, v254
    s_nop 0
    v_permlane16_swap_b32 v252, v253
    v_permlane16_swap_b32 v254, v255
    v_max_f32 v252, v252, v253
    v_max_f32 v254, v254, v255
    v_mov_b32 v253, v252
    v_mov_b32 v255, v254
    s_nop 0
    v_permlane32_swap_b32 v252, v253
    v_permlane32_swap_b32 v254, v255
    v_max_f32 v252, v252, v253
    v_max_f32 v254, v254, v255
    v_sub_f32 v252, 0, v252
    v_min_f32 v252, v252, v240
    v_sub_f32 v253, v252, v240
    v_exp_f32 v250, v253
    v_mov_b32 v240, v252
    v_mov_b32 v241, v252
    v_mov_b32 v242, v252
    v_mov_b32 v243, v252
    v_mul_f32 v248, v248, v250
    v_mul_f32 v0, v0, v250
    v_mul_f32 v1, v1, v250
    v_mul_f32 v2, v2, v250
    v_mul_f32 v3, v3, v250
    v_mul_f32 v4, v4, v250
    v_mul_f32 v5, v5, v250
    v_mul_f32 v6, v6, v250
    v_mul_f32 v7, v7, v250
    v_mul_f32 v16, v16, v250
    v_mul_f32 v17, v17, v250
    v_mul_f32 v18, v18, v250
    v_mul_f32 v19, v19, v250
    v_mul_f32 v20, v20, v250
    v_mul_f32 v21, v21, v250
    v_mul_f32 v22, v22, v250
    v_mul_f32 v23, v23, v250
    v_mul_f32 v32, v32, v250
    v_mul_f32 v33, v33, v250
    v_mul_f32 v34, v34, v250
    v_mul_f32 v35, v35, v250
    v_mul_f32 v36, v36, v250
    v_mul_f32 v37, v37, v250
    v_mul_f32 v38, v38, v250
    v_mul_f32 v39, v39, v250
    v_mul_f32 v48, v48, v250
    v_mul_f32 v49, v49, v250
    v_mul_f32 v50, v50, v250
    v_mul_f32 v51, v51, v250
    v_mul_f32 v52, v52, v250
    v_mul_f32 v53, v53, v250
    v_mul_f32 v54, v54, v250
    v_mul_f32 v55, v55, v250
    v_add_f32 v96, v96, v253
    v_add_f32 v97, v97, v253
    v_add_f32 v98, v98, v253
    v_add_f32 v99, v99, v253
    v_add_f32 v100, v100, v253
    v_add_f32 v101, v101, v253
    v_add_f32 v102, v102, v253
    v_add_f32 v103, v103, v253
    v_add_f32 v112, v112, v253
    v_add_f32 v113, v113, v253
    v_add_f32 v114, v114, v253
    v_add_f32 v115, v115, v253
    v_add_f32 v116, v116, v253
    v_add_f32 v117, v117, v253
    v_add_f32 v118, v118, v253
    v_add_f32 v119, v119, v253
    v_sub_f32 v254, 0, v254
    v_min_f32 v254, v254, v244
    v_sub_f32 v255, v254, v244
    v_exp_f32 v251, v255
    v_mov_b32 v244, v254
    v_mov_b32 v245, v254
    v_mov_b32 v246, v254
    v_mov_b32 v247, v254
    v_mul_f32 v249, v249, v251
    v_mul_f32 v8, v8, v251
    v_mul_f32 v9, v9, v251
    v_mul_f32 v10, v10, v251
    v_mul_f32 v11, v11, v251
    v_mul_f32 v12, v12, v251
    v_mul_f32 v13, v13, v251
    v_mul_f32 v14, v14, v251
    v_mul_f32 v15, v15, v251
    v_mul_f32 v24, v24, v251
    v_mul_f32 v25, v25, v251
    v_mul_f32 v26, v26, v251
    v_mul_f32 v27, v27, v251
    v_mul_f32 v28, v28, v251
    v_mul_f32 v29, v29, v251
    v_mul_f32 v30, v30, v251
    v_mul_f32 v31, v31, v251
    v_mul_f32 v40, v40, v251
    v_mul_f32 v41, v41, v251
    v_mul_f32 v42, v42, v251
    v_mul_f32 v43, v43, v251
    v_mul_f32 v44, v44, v251
    v_mul_f32 v45, v45, v251
    v_mul_f32 v46, v46, v251
    v_mul_f32 v47, v47, v251
    v_mul_f32 v56, v56, v251
    v_mul_f32 v57, v57, v251
    v_mul_f32 v58, v58, v251
    v_mul_f32 v59, v59, v251
    v_mul_f32 v60, v60, v251
    v_mul_f32 v61, v61, v251
    v_mul_f32 v62, v62, v251
    v_mul_f32 v63, v63, v251
    v_add_f32 v104, v104, v255
    v_add_f32 v105, v105, v255
    v_add_f32 v106, v106, v255
    v_add_f32 v107, v107, v255
    v_add_f32 v108, v108, v255
    v_add_f32 v109, v109, v255
    v_add_f32 v110, v110, v255
    v_add_f32 v111, v111, v255
    v_add_f32 v120, v120, v255
    v_add_f32 v121, v121, v255
    v_add_f32 v122, v122, v255
    v_add_f32 v123, v123, v255
    v_add_f32 v124, v124, v255
    v_add_f32 v125, v125, v255
    v_add_f32 v126, v126, v255
    v_add_f32 v127, v127, v255
    v_add_f32 v64, v64, v241
    v_add_f32 v65, v65, v242
    v_exp_f32 v64, v64
    v_add_f32 v66, v66, v243
    v_exp_f32 v65, v65
    v_add_f32 v67, v67, v240
    v_exp_f32 v66, v66
    v_add_f32 v68, v68, v241
    v_exp_f32 v67, v67
    v_add_f32 v252, v64, v65
    v_cvt_pk_bf16_f32 v64, v64, v65
    v_add_f32 v69, v69, v242
    v_exp_f32 v68, v68
    v_add_f32 v70, v70, v243
    v_exp_f32 v69, v69
    v_add_f32 v253, v66, v67
    v_cvt_pk_bf16_f32 v65, v66, v67
    v_add_f32 v71, v71, v240
    v_exp_f32 v70, v70
    v_add_f32 v252, v252, v68
    v_add_f32 v72, v72, v245
    v_exp_f32 v71, v71
    v_add_f32 v252, v252, v69
    v_cvt_pk_bf16_f32 v66, v68, v69
    v_add_f32 v73, v73, v246
    v_exp_f32 v72, v72
    v_add_f32 v253, v253, v70
    v_add_f32 v74, v74, v247
    v_exp_f32 v73, v73
    v_add_f32 v253, v253, v71
    v_cvt_pk_bf16_f32 v67, v70, v71
    v_add_f32 v75, v75, v244
    v_exp_f32 v74, v74
    v_add_f32 v76, v76, v245
    v_exp_f32 v75, v75
    v_add_f32 v254, v72, v73
    v_cvt_pk_bf16_f32 v72, v72, v73
    v_add_f32 v77, v77, v246
    v_exp_f32 v76, v76
    v_add_f32 v78, v78, v247
    v_exp_f32 v77, v77
    v_add_f32 v255, v74, v75
    v_cvt_pk_bf16_f32 v73, v74, v75
    v_add_f32 v79, v79, v244
    v_exp_f32 v78, v78
    v_add_f32 v254, v254, v76
    v_add_f32 v80, v80, v241
    v_exp_f32 v79, v79
    v_add_f32 v254, v254, v77
    v_cvt_pk_bf16_f32 v74, v76, v77
    v_add_f32 v81, v81, v242
    v_exp_f32 v80, v80
    v_add_f32 v255, v255, v78
    v_add_f32 v82, v82, v243
    v_exp_f32 v81, v81
    v_add_f32 v255, v255, v79
    v_cvt_pk_bf16_f32 v75, v78, v79
    v_add_f32 v83, v83, v240
    v_exp_f32 v82, v82
    v_add_f32 v252, v252, v80
    v_add_f32 v84, v84, v241
    v_exp_f32 v83, v83
    v_add_f32 v252, v252, v81
    v_cvt_pk_bf16_f32 v80, v80, v81
    v_add_f32 v85, v85, v242
    v_exp_f32 v84, v84
    v_add_f32 v253, v253, v82
    v_add_f32 v86, v86, v243
    v_exp_f32 v85, v85
    v_add_f32 v253, v253, v83
    v_cvt_pk_bf16_f32 v81, v82, v83
    v_add_f32 v87, v87, v240
    v_exp_f32 v86, v86
    v_add_f32 v252, v252, v84
    v_add_f32 v88, v88, v245
    v_exp_f32 v87, v87
    v_add_f32 v252, v252, v85
    v_cvt_pk_bf16_f32 v82, v84, v85
    v_add_f32 v89, v89, v246
    v_exp_f32 v88, v88
    v_add_f32 v253, v253, v86
    v_add_f32 v90, v90, v247
    v_exp_f32 v89, v89
    v_add_f32 v253, v253, v87
    v_cvt_pk_bf16_f32 v83, v86, v87
    v_add_f32 v91, v91, v244
    v_exp_f32 v90, v90
    v_add_f32 v254, v254, v88
    v_add_f32 v92, v92, v245
    v_exp_f32 v91, v91
    v_add_f32 v254, v254, v89
    v_cvt_pk_bf16_f32 v88, v88, v89
    v_add_f32 v93, v93, v246
    v_exp_f32 v92, v92
    v_add_f32 v255, v255, v90
    v_add_f32 v94, v94, v247
    v_exp_f32 v93, v93
    v_add_f32 v255, v255, v91
    v_cvt_pk_bf16_f32 v89, v90, v91
    v_add_f32 v95, v95, v244
    v_exp_f32 v94, v94
    v_add_f32 v254, v254, v92
    v_exp_f32 v95, v95
    v_add_f32 v254, v254, v93
    v_cvt_pk_bf16_f32 v90, v92, v93
    v_add_f32 v255, v255, v94
    v_add_f32 v255, v255, v95
    v_cvt_pk_bf16_f32 v91, v94, v95
    v_add_f32 v252, v252, v253
    v_add_f32 v254, v254, v255
    s_nop 3
    s_branch L_back_0_2
L_slow_0_3:
    s_nop 15
    v_add_u32 v239, s43, v224
    v_subrev_u32 v239, s44, v239
    ds_read_b128 v[252:255], v239 offset:16384
    s_waitcnt lgkmcnt(0)
    v_mfma_f32_16x16x32_bf16 v[96:99], v[252:255], v[128:131], 0
    v_mfma_f32_16x16x32_bf16 v[104:107], v[252:255], v[144:147], 0
    s_nop 3
    v_add_u32 v239, s43, v225
    v_subrev_u32 v239, s44, v239
    ds_read_b128 v[252:255], v239 offset:16384
    s_waitcnt lgkmcnt(0)
    v_mfma_f32_16x16x32_bf16 v[96:99], v[252:255], v[132:135], v[96:99]
    v_mfma_f32_16x16x32_bf16 v[104:107], v[252:255], v[148:151], v[104:107]
    s_nop 3
    v_add_u32 v239, s43, v226
    v_subrev_u32 v239, s44, v239
    ds_read_b128 v[252:255], v239 offset:16384
    s_waitcnt lgkmcnt(0)
    v_mfma_f32_16x16x32_bf16 v[96:99], v[252:255], v[136:139], v[96:99]
    v_mfma_f32_16x16x32_bf16 v[104:107], v[252:255], v[152:155], v[104:107]
    s_nop 3
    v_add_u32 v239, s43, v227
    v_subrev_u32 v239, s44, v239
    ds_read_b128 v[252:255], v239 offset:16384
    s_waitcnt lgkmcnt(0)
    v_mfma_f32_16x16x32_bf16 v[96:99], v[252:255], v[140:143], v[96:99]
    v_mfma_f32_16x16x32_bf16 v[104:107], v[252:255], v[156:159], v[104:107]
    s_nop 3
    v_add_u32 v239, s43, v224
    v_subrev_u32 v239, s44, v239
    ds_read_b128 v[252:255], v239 offset:20480
    s_waitcnt lgkmcnt(0)
    v_mfma_f32_16x16x32_bf16 v[100:103], v[252:255], v[128:131], 0
    v_mfma_f32_16x16x32_bf16 v[108:111], v[252:255], v[144:147], 0
    s_nop 3
    v_add_u32 v239, s43, v225
    v_subrev_u32 v239, s44, v239
    ds_read_b128 v[252:255], v239 offset:20480
    s_waitcnt lgkmcnt(0)
    v_mfma_f32_16x16x32_bf16 v[100:103], v[252:255], v[132:135], v[100:103]
    v_mfma_f32_16x16x32_bf16 v[108:111], v[252:255], v[148:151], v[108:111]
    s_nop 3
    v_add_u32 v239, s43, v226
    v_subrev_u32 v239, s44, v239
    ds_read_b128 v[252:255], v239 offset:20480
    s_waitcnt lgkmcnt(0)
    v_mfma_f32_16x16x32_bf16 v[100:103], v[252:255], v[136:139], v[100:103]
    v_mfma_f32_16x16x32_bf16 v[108:111], v[252:255], v[152:155], v[108:111]
    s_nop 3
    v_add_u32 v239, s43, v227
    v_subrev_u32 v239, s44, v239
    ds_read_b128 v[252:255], v239 offset:20480
    s_waitcnt lgkmcnt(0)
    v_mfma_f32_16x16x32_bf16 v[100:103], v[252:255], v[140:143], v[100:103]
    v_mfma_f32_16x16x32_bf16 v[108:111], v[252:255], v[156:159], v[108:111]
    s_nop 3
    v_add_u32 v239, s43, v224
    v_subrev_u32 v239, s44, v239
    ds_read_b128 v[252:255], v239 offset:24576
    s_waitcnt lgkmcnt(0)
    v_mfma_f32_16x16x32_bf16 v[112:115], v[252:255], v[128:131], 0
    v_mfma_f32_16x16x32_bf16 v[120:123], v[252:255], v[144:147], 0
    s_nop 3
    v_add_u32 v239, s43, v225
    v_subrev_u32 v239, s44, v239
    ds_read_b128 v[252:255], v239 offset:24576
    s_waitcnt lgkmcnt(0)
    v_mfma_f32_16x16x32_bf16 v[112:115], v[252:255], v[132:135], v[112:115]
    v_mfma_f32_16x16x32_bf16 v[120:123], v[252:255], v[148:151], v[120:123]
    s_nop 3
    v_add_u32 v239, s43, v226
    v_subrev_u32 v239, s44, v239
    ds_read_b128 v[252:255], v239 offset:24576
    s_waitcnt lgkmcnt(0)
    v_mfma_f32_16x16x32_bf16 v[112:115], v[252:255], v[136:139], v[112:115]
    v_mfma_f32_16x16x32_bf16 v[120:123], v[252:255], v[152:155], v[120:123]
    s_nop 3
    v_add_u32 v239, s43, v227
    v_subrev_u32 v239, s44, v239
    ds_read_b128 v[252:255], v239 offset:24576
    s_waitcnt lgkmcnt(0)
    v_mfma_f32_16x16x32_bf16 v[112:115], v[252:255], v[140:143], v[112:115]
    v_mfma_f32_16x16x32_bf16 v[120:123], v[252:255], v[156:159], v[120:123]
    s_nop 3
    v_add_u32 v239, s43, v224
    v_subrev_u32 v239, s44, v239
    ds_read_b128 v[252:255], v239 offset:28672
    s_waitcnt lgkmcnt(0)
    v_mfma_f32_16x16x32_bf16 v[116:119], v[252:255], v[128:131], 0
    v_mfma_f32_16x16x32_bf16 v[124:127], v[252:255], v[144:147], 0
    s_nop 3
    v_add_u32 v239, s43, v225
    v_subrev_u32 v239, s44, v239
    ds_read_b128 v[252:255], v239 offset:28672
    s_waitcnt lgkmcnt(0)
    v_mfma_f32_16x16x32_bf16 v[116:119], v[252:255], v[132:135], v[116:119]
    v_mfma_f32_16x16x32_bf16 v[124:127], v[252:255], v[148:151], v[124:127]
    s_nop 3
    v_add_u32 v239, s43, v226
    v_subrev_u32 v239, s44, v239
    ds_read_b128 v[252:255], v239 offset:28672
    s_waitcnt lgkmcnt(0)
    v_mfma_f32_16x16x32_bf16 v[116:119], v[252:255], v[136:139], v[116:119]
    v_mfma_f32_16x16x32_bf16 v[124:127], v[252:255], v[152:155], v[124:127]
    s_nop 3
    v_add_u32 v239, s43, v227
    v_subrev_u32 v239, s44, v239
    ds_read_b128 v[252:255], v239 offset:28672
    s_waitcnt lgkmcnt(0)
    v_mfma_f32_16x16x32_bf16 v[116:119], v[252:255], v[140:143], v[116:119]
    v_mfma_f32_16x16x32_bf16 v[124:127], v[252:255], v[156:159], v[124:127]
    s_nop 3
    s_nop 15
    v_max3_f32 v252, v96, v97, v98
    v_max3_f32 v254, v104, v105, v106
    v_max3_f32 v252, v252, v99, v100
    v_max3_f32 v254, v254, v107, v108
    v_max3_f32 v252, v252, v101, v102
    v_max3_f32 v254, v254, v109, v110
    v_max3_f32 v252, v252, v103, v112
    v_max3_f32 v254, v254, v111, v120
    v_max3_f32 v252, v252, v113, v114
    v_max3_f32 v254, v254, v121, v122
    v_max3_f32 v252, v252, v115, v116
    v_max3_f32 v254, v254, v123, v124
    v_max3_f32 v252, v252, v117, v118
    v_max3_f32 v254, v254, v125, v126
    v_max_f32 v252, v252, v119
    v_max_f32 v254, v254, v127
    v_mov_b32 v253, v252
    v_mov_b32 v255, v254
    s_nop 0
    v_permlane16_swap_b32 v252, v253
    v_permlane16_swap_b32 v254, v255
    v_max_f32 v252, v252, v253
    v_max_f32 v254, v254, v255
    v_mov_b32 v253, v252
    v_mov_b32 v255, v254
    s_nop 0
    v_permlane32_swap_b32 v252, v253
    v_permlane32_swap_b32 v254, v255
    v_max_f32 v252, v252, v253
    v_max_f32 v254, v254, v255
    v_sub_f32 v252, 0, v252
    v_min_f32 v252, v252, v240
    v_sub_f32 v253, v252, v240
    v_exp_f32 v250, v253
    v_mov_b32 v240, v252
    v_mov_b32 v241, v252
    v_mov_b32 v242, v252
    v_mov_b32 v243, v252
    v_mul_f32 v248, v248, v250
    v_mul_f32 v0, v0, v250
    v_mul_f32 v1, v1, v250
    v_mul_f32 v2, v2, v250
    v_mul_f32 v3, v3, v250
    v_mul_f32 v4, v4, v250
    v_mul_f32 v5, v5, v250
    v_mul_f32 v6, v6, v250
    v_mul_f32 v7, v7, v250
    v_mul_f32 v16, v16, v250
    v_mul_f32 v17, v17, v250
    v_mul_f32 v18, v18, v250
    v_mul_f32 v19, v19, v250
    v_mul_f32 v20, v20, v250
    v_mul_f32 v21, v21, v250
    v_mul_f32 v22, v22, v250
    v_mul_f32 v23, v23, v250
    v_mul_f32 v32, v32, v250
    v_mul_f32 v33, v33, v250
    v_mul_f32 v34, v34, v250
    v_mul_f32 v35, v35, v250
    v_mul_f32 v36, v36, v250
    v_mul_f32 v37, v37, v250
    v_mul_f32 v38, v38, v250
    v_mul_f32 v39, v39, v250
    v_mul_f32 v48, v48, v250
    v_mul_f32 v49, v49, v250
    v_mul_f32 v50, v50, v250
    v_mul_f32 v51, v51, v250
    v_mul_f32 v52, v52, v250
    v_mul_f32 v53, v53, v250
    v_mul_f32 v54, v54, v250
    v_mul_f32 v55, v55, v250
    v_add_f32 v64, v64, v253
    v_add_f32 v65, v65, v253
    v_add_f32 v66, v66, v253
    v_add_f32 v67, v67, v253
    v_add_f32 v68, v68, v253
    v_add_f32 v69, v69, v253
    v_add_f32 v70, v70, v253
    v_add_f32 v71, v71, v253
    v_add_f32 v80, v80, v253
    v_add_f32 v81, v81, v253
    v_add_f32 v82, v82, v253
    v_add_f32 v83, v83, v253
    v_add_f32 v84, v84, v253
    v_add_f32 v85, v85, v253
    v_add_f32 v86, v86, v253
    v_add_f32 v87, v87, v253
    v_sub_f32 v254, 0, v254
    v_min_f32 v254, v254, v244
    v_sub_f32 v255, v254, v244
    v_exp_f32 v251, v255
    v_mov_b32 v244, v254
    v_mov_b32 v245, v254
    v_mov_b32 v246, v254
    v_mov_b32 v247, v254
    v_mul_f32 v249, v249, v251
    v_mul_f32 v8, v8, v251
    v_mul_f32 v9, v9, v251
    v_mul_f32 v10, v10, v251
    v_mul_f32 v11, v11, v251
    v_mul_f32 v12, v12, v251
    v_mul_f32 v13, v13, v251
    v_mul_f32 v14, v14, v251
    v_mul_f32 v15, v15, v251
    v_mul_f32 v24, v24, v251
    v_mul_f32 v25, v25, v251
    v_mul_f32 v26, v26, v251
    v_mul_f32 v27, v27, v251
    v_mul_f32 v28, v28, v251
    v_mul_f32 v29, v29, v251
    v_mul_f32 v30, v30, v251
    v_mul_f32 v31, v31, v251
    v_mul_f32 v40, v40, v251
    v_mul_f32 v41, v41, v251
    v_mul_f32 v42, v42, v251
    v_mul_f32 v43, v43, v251
    v_mul_f32 v44, v44, v251
    v_mul_f32 v45, v45, v251
    v_mul_f32 v46, v46, v251
    v_mul_f32 v47, v47, v251
    v_mul_f32 v56, v56, v251
    v_mul_f32 v57, v57, v251
    v_mul_f32 v58, v58, v251
    v_mul_f32 v59, v59, v251
    v_mul_f32 v60, v60, v251
    v_mul_f32 v61, v61, v251
    v_mul_f32 v62, v62, v251
    v_mul_f32 v63, v63, v251
    v_add_f32 v72, v72, v255
    v_add_f32 v73, v73, v255
    v_add_f32 v74, v74, v255
    v_add_f32 v75, v75, v255
    v_add_f32 v76, v76, v255
    v_add_f32 v77, v77, v255
    v_add_f32 v78, v78, v255
    v_add_f32 v79, v79, v255
    v_add_f32 v88, v88, v255
    v_add_f32 v89, v89, v255
    v_add_f32 v90, v90, v255
    v_add_f32 v91, v91, v255
    v_add_f32 v92, v92, v255
    v_add_f32 v93, v93, v255
    v_add_f32 v94, v94, v255
    v_add_f32 v95, v95, v255
    v_add_f32 v96, v96, v241
    v_add_f32 v97, v97, v242
    v_exp_f32 v96, v96
    v_add_f32 v98, v98, v243
    v_exp_f32 v97, v97
    v_add_f32 v99, v99, v240
    v_exp_f32 v98, v98
    v_add_f32 v100, v100, v241
    v_exp_f32 v99, v99
    v_add_f32 v252, v96, v97
    v_cvt_pk_bf16_f32 v96, v96, v97
    v_add_f32 v101, v101, v242
    v_exp_f32 v100, v100
    v_add_f32 v102, v102, v243
    v_exp_f32 v101, v101
    v_add_f32 v253, v98, v99
    v_cvt_pk_bf16_f32 v97, v98, v99
    v_add_f32 v103, v103, v240
    v_exp_f32 v102, v102
    v_add_f32 v252, v252, v100
    v_add_f32 v104, v104, v245
    v_exp_f32 v103, v103
    v_add_f32 v252, v252, v101
    v_cvt_pk_bf16_f32 v98, v100, v101
    v_add_f32 v105, v105, v246
    v_exp_f32 v104, v104
    v_add_f32 v253, v253, v102
    v_add_f32 v106, v106, v247
    v_exp_f32 v105, v105
    v_add_f32 v253, v253, v103
    v_cvt_pk_bf16_f32 v99, v102, v103
    v_add_f32 v107, v107, v244
    v_exp_f32 v106, v106
    v_add_f32 v108, v108, v245
    v_exp_f32 v107, v107
    v_add_f32 v254, v104, v105
    v_cvt_pk_bf16_f32 v104, v104, v105
    v_add_f32 v109, v109, v246
    v_exp_f32 v108, v108
    v_add_f32 v110, v110, v247
    v_exp_f32 v109, v109
    v_add_f32 v255, v106, v107
    v_cvt_pk_bf16_f32 v105, v106, v107
    v_add_f32 v111, v111, v244
    v_exp_f32 v110, v110
    v_add_f32 v254, v254, v108
    v_add_f32 v112, v112, v241
    v_exp_f32 v111, v111
    v_add_f32 v254, v254, v109
    v_cvt_pk_bf16_f32 v106, v108, v109
    v_add_f32 v113, v113, v242
    v_exp_f32 v112, v112
    v_add_f32 v255, v255, v110
    v_add_f32 v114, v114, v243
    v_exp_f32 v113, v113
    v_add_f32 v255, v255, v111
    v_cvt_pk_bf16_f32 v107, v110, v111
    v_add_f32 v115, v115, v240
    v_exp_f32 v114, v114
    v_add_f32 v252, v252, v112
    v_add_f32 v116, v116, v241
    v_exp_f32 v115, v115
    v_add_f32 v252, v252, v113
    v_cvt_pk_bf16_f32 v112, v112, v113
    v_add_f32 v117, v117, v242
    v_exp_f32 v116, v116
    v_add_f32 v253, v253, v114
    v_add_f32 v118, v118, v243
    v_exp_f32 v117, v117
    v_add_f32 v253, v253, v115
    v_cvt_pk_bf16_f32 v113, v114, v115
    v_add_f32 v119, v119, v240
    v_exp_f32 v118, v118
    v_add_f32 v252, v252, v116
    v_add_f32 v120, v120, v245
    v_exp_f32 v119, v119
    v_add_f32 v252, v252, v117
    v_cvt_pk_bf16_f32 v114, v116, v117
    v_add_f32 v121, v121, v246
    v_exp_f32 v120, v120
    v_add_f32 v253, v253, v118
    v_add_f32 v122, v122, v247
    v_exp_f32 v121, v121
    v_add_f32 v253, v253, v119
    v_cvt_pk_bf16_f32 v115, v118, v119
    v_add_f32 v123, v123, v244
    v_exp_f32 v122, v122
    v_add_f32 v254, v254, v120
    v_add_f32 v124, v124, v245
    v_exp_f32 v123, v123
    v_add_f32 v254, v254, v121
    v_cvt_pk_bf16_f32 v120, v120, v121
    v_add_f32 v125, v125, v246
    v_exp_f32 v124, v124
    v_add_f32 v255, v255, v122
    v_add_f32 v126, v126, v247
    v_exp_f32 v125, v125
    v_add_f32 v255, v255, v123
    v_cvt_pk_bf16_f32 v121, v122, v123
    v_add_f32 v127, v127, v244
    v_exp_f32 v126, v126
    v_add_f32 v254, v254, v124
    v_exp_f32 v127, v127
    v_add_f32 v254, v254, v125
    v_cvt_pk_bf16_f32 v122, v124, v125
    v_add_f32 v255, v255, v126
    v_add_f32 v255, v255, v127
    v_cvt_pk_bf16_f32 v123, v126, v127
    v_add_f32 v252, v252, v253
    v_add_f32 v254, v254, v255
    s_nop 3
    s_branch L_back_0_3
L_slow_0_4:
    s_nop 15
    v_add_u32 v239, s44, v224
    v_subrev_u32 v239, s44, v239
    ds_read_b128 v[252:255], v239 offset:0
    s_waitcnt lgkmcnt(0)
    v_mfma_f32_16x16x32_bf16 v[64:67], v[252:255], v[128:131], 0
    v_mfma_f32_16x16x32_bf16 v[72:75], v[252:255], v[144:147], 0
    s_nop 3
    v_add_u32 v239, s44, v225
    v_subrev_u32 v239, s44, v239
    ds_read_b128 v[252:255], v239 offset:0
    s_waitcnt lgkmcnt(0)
    v_mfma_f32_16x16x32_bf16 v[64:67], v[252:255], v[132:135], v[64:67]
    v_mfma_f32_16x16x32_bf16 v[72:75], v[252:255], v[148:151], v[72:75]
    s_nop 3
    v_add_u32 v239, s44, v226
    v_subrev_u32 v239, s44, v239
    ds_read_b128 v[252:255], v239 offset:0
    s_waitcnt lgkmcnt(0)
    v_mfma_f32_16x16x32_bf16 v[64:67], v[252:255], v[136:139], v[64:67]
    v_mfma_f32_16x16x32_bf16 v[72:75], v[252:255], v[152:155], v[72:75]
    s_nop 3
    v_add_u32 v239, s44, v227
    v_subrev_u32 v239, s44, v239
    ds_read_b128 v[252:255], v239 offset:0
    s_waitcnt lgkmcnt(0)
    v_mfma_f32_16x16x32_bf16 v[64:67], v[252:255], v[140:143], v[64:67]
    v_mfma_f32_16x16x32_bf16 v[72:75], v[252:255], v[156:159], v[72:75]
    s_nop 3
    v_add_u32 v239, s44, v224
    v_subrev_u32 v239, s44, v239
    ds_read_b128 v[252:255], v239 offset:4096
    s_waitcnt lgkmcnt(0)
    v_mfma_f32_16x16x32_bf16 v[68:71], v[252:255], v[128:131], 0
    v_mfma_f32_16x16x32_bf16 v[76:79], v[252:255], v[144:147], 0
    s_nop 3
    v_add_u32 v239, s44, v225
    v_subrev_u32 v239, s44, v239
    ds_read_b128 v[252:255], v239 offset:4096
    s_waitcnt lgkmcnt(0)
    v_mfma_f32_16x16x32_bf16 v[68:71], v[252:255], v[132:135], v[68:71]
    v_mfma_f32_16x16x32_bf16 v[76:79], v[252:255], v[148:151], v[76:79]
    s_nop 3
    v_add_u32 v239, s44, v226
    v_subrev_u32 v239, s44, v239
    ds_read_b128 v[252:255], v239 offset:4096
    s_waitcnt lgkmcnt(0)
    v_mfma_f32_16x16x32_bf16 v[68:71], v[252:255], v[136:139], v[68:71]
    v_mfma_f32_16x16x32_bf16 v[76:79], v[252:255], v[152:155], v[76:79]
    s_nop 3
    v_add_u32 v239, s44, v227
    v_subrev_u32 v239, s44, v239
    ds_read_b128 v[252:255], v239 offset:4096
    s_waitcnt lgkmcnt(0)
    v_mfma_f32_16x16x32_bf16 v[68:71], v[252:255], v[140:143], v[68:71]
    v_mfma_f32_16x16x32_bf16 v[76:79], v[252:255], v[156:159], v[76:79]
    s_nop 3
    v_add_u32 v239, s44, v224
    v_subrev_u32 v239, s44, v239
    ds_read_b128 v[252:255], v239 offset:8192
    s_waitcnt lgkmcnt(0)
    v_mfma_f32_16x16x32_bf16 v[80:83], v[252:255], v[128:131], 0
    v_mfma_f32_16x16x32_bf16 v[88:91], v[252:255], v[144:147], 0
    s_nop 3
    v_add_u32 v239, s44, v225
    v_subrev_u32 v239, s44, v239
    ds_read_b128 v[252:255], v239 offset:8192
    s_waitcnt lgkmcnt(0)
    v_mfma_f32_16x16x32_bf16 v[80:83], v[252:255], v[132:135], v[80:83]
    v_mfma_f32_16x16x32_bf16 v[88:91], v[252:255], v[148:151], v[88:91]
    s_nop 3
    v_add_u32 v239, s44, v226
    v_subrev_u32 v239, s44, v239
    ds_read_b128 v[252:255], v239 offset:8192
    s_waitcnt lgkmcnt(0)
    v_mfma_f32_16x16x32_bf16 v[80:83], v[252:255], v[136:139], v[80:83]
    v_mfma_f32_16x16x32_bf16 v[88:91], v[252:255], v[152:155], v[88:91]
    s_nop 3
    v_add_u32 v239, s44, v227
    v_subrev_u32 v239, s44, v239
    ds_read_b128 v[252:255], v239 offset:8192
    s_waitcnt lgkmcnt(0)
    v_mfma_f32_16x16x32_bf16 v[80:83], v[252:255], v[140:143], v[80:83]
    v_mfma_f32_16x16x32_bf16 v[88:91], v[252:255], v[156:159], v[88:91]
    s_nop 3
    v_add_u32 v239, s44, v224
    v_subrev_u32 v239, s44, v239
    ds_read_b128 v[252:255], v239 offset:12288
    s_waitcnt lgkmcnt(0)
    v_mfma_f32_16x16x32_bf16 v[84:87], v[252:255], v[128:131], 0
    v_mfma_f32_16x16x32_bf16 v[92:95], v[252:255], v[144:147], 0
    s_nop 3
    v_add_u32 v239, s44, v225
    v_subrev_u32 v239, s44, v239
    ds_read_b128 v[252:255], v239 offset:12288
    s_waitcnt lgkmcnt(0)
    v_mfma_f32_16x16x32_bf16 v[84:87], v[252:255], v[132:135], v[84:87]
    v_mfma_f32_16x16x32_bf16 v[92:95], v[252:255], v[148:151], v[92:95]
    s_nop 3
    v_add_u32 v239, s44, v226
    v_subrev_u32 v239, s44, v239
    ds_read_b128 v[252:255], v239 offset:12288
    s_waitcnt lgkmcnt(0)
    v_mfma_f32_16x16x32_bf16 v[84:87], v[252:255], v[136:139], v[84:87]
    v_mfma_f32_16x16x32_bf16 v[92:95], v[252:255], v[152:155], v[92:95]
    s_nop 3
    v_add_u32 v239, s44, v227
    v_subrev_u32 v239, s44, v239
    ds_read_b128 v[252:255], v239 offset:12288
    s_waitcnt lgkmcnt(0)
    v_mfma_f32_16x16x32_bf16 v[84:87], v[252:255], v[140:143], v[84:87]
    v_mfma_f32_16x16x32_bf16 v[92:95], v[252:255], v[156:159], v[92:95]
    s_nop 3
    s_nop 15
    v_max3_f32 v252, v64, v65, v66
    v_max3_f32 v254, v72, v73, v74
    v_max3_f32 v252, v252, v67, v68
    v_max3_f32 v254, v254, v75, v76
    v_max3_f32 v252, v252, v69, v70
    v_max3_f32 v254, v254, v77, v78
    v_max3_f32 v252, v252, v71, v80
    v_max3_f32 v254, v254, v79, v88
    v_max3_f32 v252, v252, v81, v82
    v_max3_f32 v254, v254, v89, v90
    v_max3_f32 v252, v252, v83, v84
    v_max3_f32 v254, v254, v91, v92
    v_max3_f32 v252, v252, v85, v86
    v_max3_f32 v254, v254, v93, v94
    v_max_f32 v252, v252, v87
    v_max_f32 v254, v254, v95
    v_mov_b32 v253, v252
    v_mov_b32 v255, v254
    s_nop 0
    v_permlane16_swap_b32 v252, v253
    v_permlane16_swap_b32 v254, v255
    v_max_f32 v252, v252, v253
    v_max_f32 v254, v254, v255
    v_mov_b32 v253, v252
    v_mov_b32 v255, v254
    s_nop 0
    v_permlane32_swap_b32 v252, v253
    v_permlane32_swap_b32 v254, v255
    v_max_f32 v252, v252, v253
    v_max_f32 v254, v254, v255
    v_sub_f32 v252, 0, v252
    v_min_f32 v252, v252, v240
    v_sub_f32 v253, v252, v240
    v_exp_f32 v250, v253
    v_mov_b32 v240, v252
    v_mov_b32 v241, v252
    v_mov_b32 v242, v252
    v_mov_b32 v243, v252
    v_mul_f32 v248, v248, v250
    v_mul_f32 v0, v0, v250
    v_mul_f32 v1, v1, v250
    v_mul_f32 v2, v2, v250
    v_mul_f32 v3, v3, v250
    v_mul_f32 v4, v4, v250
    v_mul_f32 v5, v5, v250
    v_mul_f32 v6, v6, v250
    v_mul_f32 v7, v7, v250
    v_mul_f32 v16, v16, v250
    v_mul_f32 v17, v17, v250
    v_mul_f32 v18, v18, v250
    v_mul_f32 v19, v19, v250
    v_mul_f32 v20, v20, v250
    v_mul_f32 v21, v21, v250
    v_mul_f32 v22, v22, v250
    v_mul_f32 v23, v23, v250
    v_mul_f32 v32, v32, v250
    v_mul_f32 v33, v33, v250
    v_mul_f32 v34, v34, v250
    v_mul_f32 v35, v35, v250
    v_mul_f32 v36, v36, v250
    v_mul_f32 v37, v37, v250
    v_mul_f32 v38, v38, v250
    v_mul_f32 v39, v39, v250
    v_mul_f32 v48, v48, v250
    v_mul_f32 v49, v49, v250
    v_mul_f32 v50, v50, v250
    v_mul_f32 v51, v51, v250
    v_mul_f32 v52, v52, v250
    v_mul_f32 v53, v53, v250
    v_mul_f32 v54, v54, v250
    v_mul_f32 v55, v55, v250
    v_add_f32 v96, v96, v253
    v_add_f32 v97, v97, v253
    v_add_f32 v98, v98, v253
    v_add_f32 v99, v99, v253
    v_add_f32 v100, v100, v253
    v_add_f32 v101, v101, v253
    v_add_f32 v102, v102, v253
    v_add_f32 v103, v103, v253
    v_add_f32 v112, v112, v253
    v_add_f32 v113, v113, v253
    v_add_f32 v114, v114, v253
    v_add_f32 v115, v115, v253
    v_add_f32 v116, v116, v253
    v_add_f32 v117, v117, v253
    v_add_f32 v118, v118, v253
    v_add_f32 v119, v119, v253
    v_sub_f32 v254, 0, v254
    v_min_f32 v254, v254, v244
    v_sub_f32 v255, v254, v244
    v_exp_f32 v251, v255
    v_mov_b32 v244, v254
    v_mov_b32 v245, v254
    v_mov_b32 v246, v254
    v_mov_b32 v247, v254
    v_mul_f32 v249, v249, v251
    v_mul_f32 v8, v8, v251
    v_mul_f32 v9, v9, v251
    v_mul_f32 v10, v10, v251
    v_mul_f32 v11, v11, v251
    v_mul_f32 v12, v12, v251
    v_mul_f32 v13, v13, v251
    v_mul_f32 v14, v14, v251
    v_mul_f32 v15, v15, v251
    v_mul_f32 v24, v24, v251
    v_mul_f32 v25, v25, v251
    v_mul_f32 v26, v26, v251
    v_mul_f32 v27, v27, v251
    v_mul_f32 v28, v28, v251
    v_mul_f32 v29, v29, v251
    v_mul_f32 v30, v30, v251
    v_mul_f32 v31, v31, v251
    v_mul_f32 v40, v40, v251
    v_mul_f32 v41, v41, v251
    v_mul_f32 v42, v42, v251
    v_mul_f32 v43, v43, v251
    v_mul_f32 v44, v44, v251
    v_mul_f32 v45, v45, v251
    v_mul_f32 v46, v46, v251
    v_mul_f32 v47, v47, v251
    v_mul_f32 v56, v56, v251
    v_mul_f32 v57, v57, v251
    v_mul_f32 v58, v58, v251
    v_mul_f32 v59, v59, v251
    v_mul_f32 v60, v60, v251
    v_mul_f32 v61, v61, v251
    v_mul_f32 v62, v62, v251
    v_mul_f32 v63, v63, v251
    v_add_f32 v104, v104, v255
    v_add_f32 v105, v105, v255
    v_add_f32 v106, v106, v255
    v_add_f32 v107, v107, v255
    v_add_f32 v108, v108, v255
    v_add_f32 v109, v109, v255
    v_add_f32 v110, v110, v255
    v_add_f32 v111, v111, v255
    v_add_f32 v120, v120, v255
    v_add_f32 v121, v121, v255
    v_add_f32 v122, v122, v255
    v_add_f32 v123, v123, v255
    v_add_f32 v124, v124, v255
    v_add_f32 v125, v125, v255
    v_add_f32 v126, v126, v255
    v_add_f32 v127, v127, v255
    v_add_f32 v64, v64, v241
    v_add_f32 v65, v65, v242
    v_exp_f32 v64, v64
    v_add_f32 v66, v66, v243
    v_exp_f32 v65, v65
    v_add_f32 v67, v67, v240
    v_exp_f32 v66, v66
    v_add_f32 v68, v68, v241
    v_exp_f32 v67, v67
    v_add_f32 v252, v64, v65
    v_cvt_pk_bf16_f32 v64, v64, v65
    v_add_f32 v69, v69, v242
    v_exp_f32 v68, v68
    v_add_f32 v70, v70, v243
    v_exp_f32 v69, v69
    v_add_f32 v253, v66, v67
    v_cvt_pk_bf16_f32 v65, v66, v67
    v_add_f32 v71, v71, v240
    v_exp_f32 v70, v70
    v_add_f32 v252, v252, v68
    v_add_f32 v72, v72, v245
    v_exp_f32 v71, v71
    v_add_f32 v252, v252, v69
    v_cvt_pk_bf16_f32 v66, v68, v69
    v_add_f32 v73, v73, v246
    v_exp_f32 v72, v72
    v_add_f32 v253, v253, v70
    v_add_f32 v74, v74, v247
    v_exp_f32 v73, v73
    v_add_f32 v253, v253, v71
    v_cvt_pk_bf16_f32 v67, v70, v71
    v_add_f32 v75, v75, v244
    v_exp_f32 v74, v74
    v_add_f32 v76, v76, v245
    v_exp_f32 v75, v75
    v_add_f32 v254, v72, v73
    v_cvt_pk_bf16_f32 v72, v72, v73
    v_add_f32 v77, v77, v246
    v_exp_f32 v76, v76
    v_add_f32 v78, v78, v247
    v_exp_f32 v77, v77
    v_add_f32 v255, v74, v75
    v_cvt_pk_bf16_f32 v73, v74, v75
    v_add_f32 v79, v79, v244
    v_exp_f32 v78, v78
    v_add_f32 v254, v254, v76
    v_add_f32 v80, v80, v241
    v_exp_f32 v79, v79
    v_add_f32 v254, v254, v77
    v_cvt_pk_bf16_f32 v74, v76, v77
    v_add_f32 v81, v81, v242
    v_exp_f32 v80, v80
    v_add_f32 v255, v255, v78
    v_add_f32 v82, v82, v243
    v_exp_f32 v81, v81
    v_add_f32 v255, v255, v79
    v_cvt_pk_bf16_f32 v75, v78, v79
    v_add_f32 v83, v83, v240
    v_exp_f32 v82, v82
    v_add_f32 v252, v252, v80
    v_add_f32 v84, v84, v241
    v_exp_f32 v83, v83
    v_add_f32 v252, v252, v81
    v_cvt_pk_bf16_f32 v80, v80, v81
    v_add_f32 v85, v85, v242
    v_exp_f32 v84, v84
    v_add_f32 v253, v253, v82
    v_add_f32 v86, v86, v243
    v_exp_f32 v85, v85
    v_add_f32 v253, v253, v83
    v_cvt_pk_bf16_f32 v81, v82, v83
    v_add_f32 v87, v87, v240
    v_exp_f32 v86, v86
    v_add_f32 v252, v252, v84
    v_add_f32 v88, v88, v245
    v_exp_f32 v87, v87
    v_add_f32 v252, v252, v85
    v_cvt_pk_bf16_f32 v82, v84, v85
    v_add_f32 v89, v89, v246
    v_exp_f32 v88, v88
    v_add_f32 v253, v253, v86
    v_add_f32 v90, v90, v247
    v_exp_f32 v89, v89
    v_add_f32 v253, v253, v87
    v_cvt_pk_bf16_f32 v83, v86, v87
    v_add_f32 v91, v91, v244
    v_exp_f32 v90, v90
    v_add_f32 v254, v254, v88
    v_add_f32 v92, v92, v245
    v_exp_f32 v91, v91
    v_add_f32 v254, v254, v89
    v_cvt_pk_bf16_f32 v88, v88, v89
    v_add_f32 v93, v93, v246
    v_exp_f32 v92, v92
    v_add_f32 v255, v255, v90
    v_add_f32 v94, v94, v247
    v_exp_f32 v93, v93
    v_add_f32 v255, v255, v91
    v_cvt_pk_bf16_f32 v89, v90, v91
    v_add_f32 v95, v95, v244
    v_exp_f32 v94, v94
    v_add_f32 v254, v254, v92
    v_exp_f32 v95, v95
    v_add_f32 v254, v254, v93
    v_cvt_pk_bf16_f32 v90, v92, v93
    v_add_f32 v255, v255, v94
    v_add_f32 v255, v255, v95
    v_cvt_pk_bf16_f32 v91, v94, v95
    v_add_f32 v252, v252, v253
    v_add_f32 v254, v254, v255
    s_nop 3
    s_branch L_back_0_4
L_slow_0_5:
    s_nop 15
    v_add_u32 v239, s44, v224
    v_subrev_u32 v239, s42, v239
    ds_read_b128 v[252:255], v239 offset:16384
    s_waitcnt lgkmcnt(0)
    v_mfma_f32_16x16x32_bf16 v[96:99], v[252:255], v[128:131], 0
    v_mfma_f32_16x16x32_bf16 v[104:107], v[252:255], v[144:147], 0
    s_nop 3
    v_add_u32 v239, s44, v225
    v_subrev_u32 v239, s42, v239
    ds_read_b128 v[252:255], v239 offset:16384
    s_waitcnt lgkmcnt(0)
    v_mfma_f32_16x16x32_bf16 v[96:99], v[252:255], v[132:135], v[96:99]
    v_mfma_f32_16x16x32_bf16 v[104:107], v[252:255], v[148:151], v[104:107]
    s_nop 3
    v_add_u32 v239, s44, v226
    v_subrev_u32 v239, s42, v239
    ds_read_b128 v[252:255], v239 offset:16384
    s_waitcnt lgkmcnt(0)
    v_mfma_f32_16x16x32_bf16 v[96:99], v[252:255], v[136:139], v[96:99]
    v_mfma_f32_16x16x32_bf16 v[104:107], v[252:255], v[152:155], v[104:107]
    s_nop 3
    v_add_u32 v239, s44, v227
    v_subrev_u32 v239, s42, v239
    ds_read_b128 v[252:255], v239 offset:16384
    s_waitcnt lgkmcnt(0)
    v_mfma_f32_16x16x32_bf16 v[96:99], v[252:255], v[140:143], v[96:99]
    v_mfma_f32_16x16x32_bf16 v[104:107], v[252:255], v[156:159], v[104:107]
    s_nop 3
    v_add_u32 v239, s44, v224
    v_subrev_u32 v239, s42, v239
    ds_read_b128 v[252:255], v239 offset:20480
    s_waitcnt lgkmcnt(0)
    v_mfma_f32_16x16x32_bf16 v[100:103], v[252:255], v[128:131], 0
    v_mfma_f32_16x16x32_bf16 v[108:111], v[252:255], v[144:147], 0
    s_nop 3
    v_add_u32 v239, s44, v225
    v_subrev_u32 v239, s42, v239
    ds_read_b128 v[252:255], v239 offset:20480
    s_waitcnt lgkmcnt(0)
    v_mfma_f32_16x16x32_bf16 v[100:103], v[252:255], v[132:135], v[100:103]
    v_mfma_f32_16x16x32_bf16 v[108:111], v[252:255], v[148:151], v[108:111]
    s_nop 3
    v_add_u32 v239, s44, v226
    v_subrev_u32 v239, s42, v239
    ds_read_b128 v[252:255], v239 offset:20480
    s_waitcnt lgkmcnt(0)
    v_mfma_f32_16x16x32_bf16 v[100:103], v[252:255], v[136:139], v[100:103]
    v_mfma_f32_16x16x32_bf16 v[108:111], v[252:255], v[152:155], v[108:111]
    s_nop 3
    v_add_u32 v239, s44, v227
    v_subrev_u32 v239, s42, v239
    ds_read_b128 v[252:255], v239 offset:20480
    s_waitcnt lgkmcnt(0)
    v_mfma_f32_16x16x32_bf16 v[100:103], v[252:255], v[140:143], v[100:103]
    v_mfma_f32_16x16x32_bf16 v[108:111], v[252:255], v[156:159], v[108:111]
    s_nop 3
    v_add_u32 v239, s44, v224
    v_subrev_u32 v239, s42, v239
    ds_read_b128 v[252:255], v239 offset:24576
    s_waitcnt lgkmcnt(0)
    v_mfma_f32_16x16x32_bf16 v[112:115], v[252:255], v[128:131], 0
    v_mfma_f32_16x16x32_bf16 v[120:123], v[252:255], v[144:147], 0
    s_nop 3
    v_add_u32 v239, s44, v225
    v_subrev_u32 v239, s42, v239
    ds_read_b128 v[252:255], v239 offset:24576
    s_waitcnt lgkmcnt(0)
    v_mfma_f32_16x16x32_bf16 v[112:115], v[252:255], v[132:135], v[112:115]
    v_mfma_f32_16x16x32_bf16 v[120:123], v[252:255], v[148:151], v[120:123]
    s_nop 3
    v_add_u32 v239, s44, v226
    v_subrev_u32 v239, s42, v239
    ds_read_b128 v[252:255], v239 offset:24576
    s_waitcnt lgkmcnt(0)
    v_mfma_f32_16x16x32_bf16 v[112:115], v[252:255], v[136:139], v[112:115]
    v_mfma_f32_16x16x32_bf16 v[120:123], v[252:255], v[152:155], v[120:123]
    s_nop 3
    v_add_u32 v239, s44, v227
    v_subrev_u32 v239, s42, v239
    ds_read_b128 v[252:255], v239 offset:24576
    s_waitcnt lgkmcnt(0)
    v_mfma_f32_16x16x32_bf16 v[112:115], v[252:255], v[140:143], v[112:115]
    v_mfma_f32_16x16x32_bf16 v[120:123], v[252:255], v[156:159], v[120:123]
    s_nop 3
    v_add_u32 v239, s44, v224
    v_subrev_u32 v239, s42, v239
    ds_read_b128 v[252:255], v239 offset:28672
    s_waitcnt lgkmcnt(0)
    v_mfma_f32_16x16x32_bf16 v[116:119], v[252:255], v[128:131], 0
    v_mfma_f32_16x16x32_bf16 v[124:127], v[252:255], v[144:147], 0
    s_nop 3
    v_add_u32 v239, s44, v225
    v_subrev_u32 v239, s42, v239
    ds_read_b128 v[252:255], v239 offset:28672
    s_waitcnt lgkmcnt(0)
    v_mfma_f32_16x16x32_bf16 v[116:119], v[252:255], v[132:135], v[116:119]
    v_mfma_f32_16x16x32_bf16 v[124:127], v[252:255], v[148:151], v[124:127]
    s_nop 3
    v_add_u32 v239, s44, v226
    v_subrev_u32 v239, s42, v239
    ds_read_b128 v[252:255], v239 offset:28672
    s_waitcnt lgkmcnt(0)
    v_mfma_f32_16x16x32_bf16 v[116:119], v[252:255], v[136:139], v[116:119]
    v_mfma_f32_16x16x32_bf16 v[124:127], v[252:255], v[152:155], v[124:127]
    s_nop 3
    v_add_u32 v239, s44, v227
    v_subrev_u32 v239, s42, v239
    ds_read_b128 v[252:255], v239 offset:28672
    s_waitcnt lgkmcnt(0)
    v_mfma_f32_16x16x32_bf16 v[116:119], v[252:255], v[140:143], v[116:119]
    v_mfma_f32_16x16x32_bf16 v[124:127], v[252:255], v[156:159], v[124:127]
    s_nop 3
    s_nop 15
    v_max3_f32 v252, v96, v97, v98
    v_max3_f32 v254, v104, v105, v106
    v_max3_f32 v252, v252, v99, v100
    v_max3_f32 v254, v254, v107, v108
    v_max3_f32 v252, v252, v101, v102
    v_max3_f32 v254, v254, v109, v110
    v_max3_f32 v252, v252, v103, v112
    v_max3_f32 v254, v254, v111, v120
    v_max3_f32 v252, v252, v113, v114
    v_max3_f32 v254, v254, v121, v122
    v_max3_f32 v252, v252, v115, v116
    v_max3_f32 v254, v254, v123, v124
    v_max3_f32 v252, v252, v117, v118
    v_max3_f32 v254, v254, v125, v126
    v_max_f32 v252, v252, v119
    v_max_f32 v254, v254, v127
    v_mov_b32 v253, v252
    v_mov_b32 v255, v254
    s_nop 0
    v_permlane16_swap_b32 v252, v253
    v_permlane16_swap_b32 v254, v255
    v_max_f32 v252, v252, v253
    v_max_f32 v254, v254, v255
    v_mov_b32 v253, v252
    v_mov_b32 v255, v254
    s_nop 0
    v_permlane32_swap_b32 v252, v253
    v_permlane32_swap_b32 v254, v255
    v_max_f32 v252, v252, v253
    v_max_f32 v254, v254, v255
    v_sub_f32 v252, 0, v252
    v_min_f32 v252, v252, v240
    v_sub_f32 v253, v252, v240
    v_exp_f32 v250, v253
    v_mov_b32 v240, v252
    v_mov_b32 v241, v252
    v_mov_b32 v242, v252
    v_mov_b32 v243, v252
    v_mul_f32 v248, v248, v250
    v_mul_f32 v0, v0, v250
    v_mul_f32 v1, v1, v250
    v_mul_f32 v2, v2, v250
    v_mul_f32 v3, v3, v250
    v_mul_f32 v4, v4, v250
    v_mul_f32 v5, v5, v250
    v_mul_f32 v6, v6, v250
    v_mul_f32 v7, v7, v250
    v_mul_f32 v16, v16, v250
    v_mul_f32 v17, v17, v250
    v_mul_f32 v18, v18, v250
    v_mul_f32 v19, v19, v250
    v_mul_f32 v20, v20, v250
    v_mul_f32 v21, v21, v250
    v_mul_f32 v22, v22, v250
    v_mul_f32 v23, v23, v250
    v_mul_f32 v32, v32, v250
    v_mul_f32 v33, v33, v250
    v_mul_f32 v34, v34, v250
    v_mul_f32 v35, v35, v250
    v_mul_f32 v36, v36, v250
    v_mul_f32 v37, v37, v250
    v_mul_f32 v38, v38, v250
    v_mul_f32 v39, v39, v250
    v_mul_f32 v48, v48, v250
    v_mul_f32 v49, v49, v250
    v_mul_f32 v50, v50, v250
    v_mul_f32 v51, v51, v250
    v_mul_f32 v52, v52, v250
    v_mul_f32 v53, v53, v250
    v_mul_f32 v54, v54, v250
    v_mul_f32 v55, v55, v250
    v_sub_f32 v254, 0, v254
    v_min_f32 v254, v254, v244
    v_sub_f32 v255, v254, v244
    v_exp_f32 v251, v255
    v_mov_b32 v244, v254
    v_mov_b32 v245, v254
    v_mov_b32 v246, v254
    v_mov_b32 v247, v254
    v_mul_f32 v249, v249, v251
    v_mul_f32 v8, v8, v251
    v_mul_f32 v9, v9, v251
    v_mul_f32 v10, v10, v251
    v_mul_f32 v11, v11, v251
    v_mul_f32 v12, v12, v251
    v_mul_f32 v13, v13, v251
    v_mul_f32 v14, v14, v251
    v_mul_f32 v15, v15, v251
    v_mul_f32 v24, v24, v251
    v_mul_f32 v25, v25, v251
    v_mul_f32 v26, v26, v251
    v_mul_f32 v27, v27, v251
    v_mul_f32 v28, v28, v251
    v_mul_f32 v29, v29, v251
    v_mul_f32 v30, v30, v251
    v_mul_f32 v31, v31, v251
    v_mul_f32 v40, v40, v251
    v_mul_f32 v41, v41, v251
    v_mul_f32 v42, v42, v251
    v_mul_f32 v43, v43, v251
    v_mul_f32 v44, v44, v251
    v_mul_f32 v45, v45, v251
    v_mul_f32 v46, v46, v251
    v_mul_f32 v47, v47, v251
    v_mul_f32 v56, v56, v251
    v_mul_f32 v57, v57, v251
    v_mul_f32 v58, v58, v251
    v_mul_f32 v59, v59, v251
    v_mul_f32 v60, v60, v251
    v_mul_f32 v61, v61, v251
    v_mul_f32 v62, v62, v251
    v_mul_f32 v63, v63, v251
    v_add_f32 v96, v96, v241
    v_add_f32 v97, v97, v242
    v_exp_f32 v96, v96
    v_add_f32 v98, v98, v243
    v_exp_f32 v97, v97
    v_add_f32 v99, v99, v240
    v_exp_f32 v98, v98
    v_add_f32 v100, v100, v241
    v_exp_f32 v99, v99
    v_add_f32 v252, v96, v97
    v_cvt_pk_bf16_f32 v96, v96, v97
    v_add_f32 v101, v101, v242
    v_exp_f32 v100, v100
    v_add_f32 v102, v102, v243
    v_exp_f32 v101, v101
    v_add_f32 v253, v98, v99
    v_cvt_pk_bf16_f32 v97, v98, v99
    v_add_f32 v103, v103, v240
    v_exp_f32 v102, v102
    v_add_f32 v252, v252, v100
    v_add_f32 v104, v104, v245
    v_exp_f32 v103, v103
    v_add_f32 v252, v252, v101
    v_cvt_pk_bf16_f32 v98, v100, v101
    v_add_f32 v105, v105, v246
    v_exp_f32 v104, v104
    v_add_f32 v253, v253, v102
    v_add_f32 v106, v106, v247
    v_exp_f32 v105, v105
    v_add_f32 v253, v253, v103
    v_cvt_pk_bf16_f32 v99, v102, v103
    v_add_f32 v107, v107, v244
    v_exp_f32 v106, v106
    v_add_f32 v108, v108, v245
    v_exp_f32 v107, v107
    v_add_f32 v254, v104, v105
    v_cvt_pk_bf16_f32 v104, v104, v105
    v_add_f32 v109, v109, v246
    v_exp_f32 v108, v108
    v_add_f32 v110, v110, v247
    v_exp_f32 v109, v109
    v_add_f32 v255, v106, v107
    v_cvt_pk_bf16_f32 v105, v106, v107
    v_add_f32 v111, v111, v244
    v_exp_f32 v110, v110
    v_add_f32 v254, v254, v108
    v_add_f32 v112, v112, v241
    v_exp_f32 v111, v111
    v_add_f32 v254, v254, v109
    v_cvt_pk_bf16_f32 v106, v108, v109
    v_add_f32 v113, v113, v242
    v_exp_f32 v112, v112
    v_add_f32 v255, v255, v110
    v_add_f32 v114, v114, v243
    v_exp_f32 v113, v113
    v_add_f32 v255, v255, v111
    v_cvt_pk_bf16_f32 v107, v110, v111
    v_add_f32 v115, v115, v240
    v_exp_f32 v114, v114
    v_add_f32 v252, v252, v112
    v_add_f32 v116, v116, v241
    v_exp_f32 v115, v115
    v_add_f32 v252, v252, v113
    v_cvt_pk_bf16_f32 v112, v112, v113
    v_add_f32 v117, v117, v242
    v_exp_f32 v116, v116
    v_add_f32 v253, v253, v114
    v_add_f32 v118, v118, v243
    v_exp_f32 v117, v117
    v_add_f32 v253, v253, v115
    v_cvt_pk_bf16_f32 v113, v114, v115
    v_add_f32 v119, v119, v240
    v_exp_f32 v118, v118
    v_add_f32 v252, v252, v116
    v_add_f32 v120, v120, v245
    v_exp_f32 v119, v119
    v_add_f32 v252, v252, v117
    v_cvt_pk_bf16_f32 v114, v116, v117
    v_add_f32 v121, v121, v246
    v_exp_f32 v120, v120
    v_add_f32 v253, v253, v118
    v_add_f32 v122, v122, v247
    v_exp_f32 v121, v121
    v_add_f32 v253, v253, v119
    v_cvt_pk_bf16_f32 v115, v118, v119
    v_add_f32 v123, v123, v244
    v_exp_f32 v122, v122
    v_add_f32 v254, v254, v120
    v_add_f32 v124, v124, v245
    v_exp_f32 v123, v123
    v_add_f32 v254, v254, v121
    v_cvt_pk_bf16_f32 v120, v120, v121
    v_add_f32 v125, v125, v246
    v_exp_f32 v124, v124
    v_add_f32 v255, v255, v122
    v_add_f32 v126, v126, v247
    v_exp_f32 v125, v125
    v_add_f32 v255, v255, v123
    v_cvt_pk_bf16_f32 v121, v122, v123
    v_add_f32 v127, v127, v244
    v_exp_f32 v126, v126
    v_add_f32 v254, v254, v124
    v_exp_f32 v127, v127
    v_add_f32 v254, v254, v125
    v_cvt_pk_bf16_f32 v122, v124, v125
    v_add_f32 v255, v255, v126
    v_add_f32 v255, v255, v127
    v_cvt_pk_bf16_f32 v123, v126, v127
    v_add_f32 v252, v252, v253
    v_add_f32 v254, v254, v255
    s_nop 3
    s_branch L_back_0_5
L_slow_1_1:
    s_nop 15
    v_add_u32 v239, s42, v224
    v_subrev_u32 v239, s43, v239
    ds_read_b128 v[252:255], v239 offset:16384
    s_waitcnt lgkmcnt(0)
    v_mfma_f32_16x16x32_bf16 v[96:99], v[252:255], v[160:163], 0
    v_mfma_f32_16x16x32_bf16 v[104:107], v[252:255], v[176:179], 0
    s_nop 3
    v_add_u32 v239, s42, v225
    v_subrev_u32 v239, s43, v239
    ds_read_b128 v[252:255], v239 offset:16384
    s_waitcnt lgkmcnt(0)
    v_mfma_f32_16x16x32_bf16 v[96:99], v[252:255], v[164:167], v[96:99]
    v_mfma_f32_16x16x32_bf16 v[104:107], v[252:255], v[180:183], v[104:107]
    s_nop 3
    v_add_u32 v239, s42, v226
    v_subrev_u32 v239, s43, v239
    ds_read_b128 v[252:255], v239 offset:16384
    s_waitcnt lgkmcnt(0)
    v_mfma_f32_16x16x32_bf16 v[96:99], v[252:255], v[168:171], v[96:99]
    v_mfma_f32_16x16x32_bf16 v[104:107], v[252:255], v[184:187], v[104:107]
    s_nop 3
    v_add_u32 v239, s42, v227
    v_subrev_u32 v239, s43, v239
    ds_read_b128 v[252:255], v239 offset:16384
    s_waitcnt lgkmcnt(0)
    v_mfma_f32_16x16x32_bf16 v[96:99], v[252:255], v[172:175], v[96:99]
    v_mfma_f32_16x16x32_bf16 v[104:107], v[252:255], v[188:191], v[104:107]
    s_nop 3
    v_add_u32 v239, s42, v224
    v_subrev_u32 v239, s43, v239
    ds_read_b128 v[252:255], v239 offset:20480
    s_waitcnt lgkmcnt(0)
    v_mfma_f32_16x16x32_bf16 v[100:103], v[252:255], v[160:163], 0
    v_mfma_f32_16x16x32_bf16 v[108:111], v[252:255], v[176:179], 0
    s_nop 3
    v_add_u32 v239, s42, v225
    v_subrev_u32 v239, s43, v239
    ds_read_b128 v[252:255], v239 offset:20480
    s_waitcnt lgkmcnt(0)
    v_mfma_f32_16x16x32_bf16 v[100:103], v[252:255], v[164:167], v[100:103]
    v_mfma_f32_16x16x32_bf16 v[108:111], v[252:255], v[180:183], v[108:111]
    s_nop 3
    v_add_u32 v239, s42, v226
    v_subrev_u32 v239, s43, v239
    ds_read_b128 v[252:255], v239 offset:20480
    s_waitcnt lgkmcnt(0)
    v_mfma_f32_16x16x32_bf16 v[100:103], v[252:255], v[168:171], v[100:103]
    v_mfma_f32_16x16x32_bf16 v[108:111], v[252:255], v[184:187], v[108:111]
    s_nop 3
    v_add_u32 v239, s42, v227
    v_subrev_u32 v239, s43, v239
    ds_read_b128 v[252:255], v239 offset:20480
    s_waitcnt lgkmcnt(0)
    v_mfma_f32_16x16x32_bf16 v[100:103], v[252:255], v[172:175], v[100:103]
    v_mfma_f32_16x16x32_bf16 v[108:111], v[252:255], v[188:191], v[108:111]
    s_nop 3
    v_add_u32 v239, s42, v224
    v_subrev_u32 v239, s43, v239
    ds_read_b128 v[252:255], v239 offset:24576
    s_waitcnt lgkmcnt(0)
    v_mfma_f32_16x16x32_bf16 v[112:115], v[252:255], v[160:163], 0
    v_mfma_f32_16x16x32_bf16 v[120:123], v[252:255], v[176:179], 0
    s_nop 3
    v_add_u32 v239, s42, v225
    v_subrev_u32 v239, s43, v239
    ds_read_b128 v[252:255], v239 offset:24576
    s_waitcnt lgkmcnt(0)
    v_mfma_f32_16x16x32_bf16 v[112:115], v[252:255], v[164:167], v[112:115]
    v_mfma_f32_16x16x32_bf16 v[120:123], v[252:255], v[180:183], v[120:123]
    s_nop 3
    v_add_u32 v239, s42, v226
    v_subrev_u32 v239, s43, v239
    ds_read_b128 v[252:255], v239 offset:24576
    s_waitcnt lgkmcnt(0)
    v_mfma_f32_16x16x32_bf16 v[112:115], v[252:255], v[168:171], v[112:115]
    v_mfma_f32_16x16x32_bf16 v[120:123], v[252:255], v[184:187], v[120:123]
    s_nop 3
    v_add_u32 v239, s42, v227
    v_subrev_u32 v239, s43, v239
    ds_read_b128 v[252:255], v239 offset:24576
    s_waitcnt lgkmcnt(0)
    v_mfma_f32_16x16x32_bf16 v[112:115], v[252:255], v[172:175], v[112:115]
    v_mfma_f32_16x16x32_bf16 v[120:123], v[252:255], v[188:191], v[120:123]
    s_nop 3
    v_add_u32 v239, s42, v224
    v_subrev_u32 v239, s43, v239
    ds_read_b128 v[252:255], v239 offset:28672
    s_waitcnt lgkmcnt(0)
    v_mfma_f32_16x16x32_bf16 v[116:119], v[252:255], v[160:163], 0
    v_mfma_f32_16x16x32_bf16 v[124:127], v[252:255], v[176:179], 0
    s_nop 3
    v_add_u32 v239, s42, v225
    v_subrev_u32 v239, s43, v239
    ds_read_b128 v[252:255], v239 offset:28672
    s_waitcnt lgkmcnt(0)
    v_mfma_f32_16x16x32_bf16 v[116:119], v[252:255], v[164:167], v[116:119]
    v_mfma_f32_16x16x32_bf16 v[124:127], v[252:255], v[180:183], v[124:127]
    s_nop 3
    v_add_u32 v239, s42, v226
    v_subrev_u32 v239, s43, v239
    ds_read_b128 v[252:255], v239 offset:28672
    s_waitcnt lgkmcnt(0)
    v_mfma_f32_16x16x32_bf16 v[116:119], v[252:255], v[168:171], v[116:119]
    v_mfma_f32_16x16x32_bf16 v[124:127], v[252:255], v[184:187], v[124:127]
    s_nop 3
    v_add_u32 v239, s42, v227
    v_subrev_u32 v239, s43, v239
    ds_read_b128 v[252:255], v239 offset:28672
    s_waitcnt lgkmcnt(0)
    v_mfma_f32_16x16x32_bf16 v[116:119], v[252:255], v[172:175], v[116:119]
    v_mfma_f32_16x16x32_bf16 v[124:127], v[252:255], v[188:191], v[124:127]
    s_nop 3
    s_nop 15
    v_max3_f32 v252, v96, v97, v98
    v_max3_f32 v254, v104, v105, v106
    v_max3_f32 v252, v252, v99, v100
    v_max3_f32 v254, v254, v107, v108
    v_max3_f32 v252, v252, v101, v102
    v_max3_f32 v254, v254, v109, v110
    v_max3_f32 v252, v252, v103, v112
    v_max3_f32 v254, v254, v111, v120
    v_max3_f32 v252, v252, v113, v114
    v_max3_f32 v254, v254, v121, v122
    v_max3_f32 v252, v252, v115, v116
    v_max3_f32 v254, v254, v123, v124
    v_max3_f32 v252, v252, v117, v118
    v_max3_f32 v254, v254, v125, v126
    v_max_f32 v252, v252, v119
    v_max_f32 v254, v254, v127
    v_mov_b32 v253, v252
    v_mov_b32 v255, v254
    s_nop 0
    v_permlane16_swap_b32 v252, v253
    v_permlane16_swap_b32 v254, v255
    v_max_f32 v252, v252, v253
    v_max_f32 v254, v254, v255
    v_mov_b32 v253, v252
    v_mov_b32 v255, v254
    s_nop 0
    v_permlane32_swap_b32 v252, v253
    v_permlane32_swap_b32 v254, v255
    v_max_f32 v252, v252, v253
    v_max_f32 v254, v254, v255
    v_sub_f32 v252, 0, v252
    v_min_f32 v252, v252, v240
    v_sub_f32 v253, v252, v240
    v_exp_f32 v250, v253
    v_mov_b32 v240, v252
    v_mov_b32 v241, v252
    v_mov_b32 v242, v252
    v_mov_b32 v243, v252
    v_mul_f32 v248, v248, v250
    v_mul_f32 v0, v0, v250
    v_mul_f32 v1, v1, v250
    v_mul_f32 v2, v2, v250
    v_mul_f32 v3, v3, v250
    v_mul_f32 v4, v4, v250
    v_mul_f32 v5, v5, v250
    v_mul_f32 v6, v6, v250
    v_mul_f32 v7, v7, v250
    v_mul_f32 v16, v16, v250
    v_mul_f32 v17, v17, v250
    v_mul_f32 v18, v18, v250
    v_mul_f32 v19, v19, v250
    v_mul_f32 v20, v20, v250
    v_mul_f32 v21, v21, v250
    v_mul_f32 v22, v22, v250
    v_mul_f32 v23, v23, v250
    v_mul_f32 v32, v32, v250
    v_mul_f32 v33, v33, v250
    v_mul_f32 v34, v34, v250
    v_mul_f32 v35, v35, v250
    v_mul_f32 v36, v36, v250
    v_mul_f32 v37, v37, v250
    v_mul_f32 v38, v38, v250
    v_mul_f32 v39, v39, v250
    v_mul_f32 v48, v48, v250
    v_mul_f32 v49, v49, v250
    v_mul_f32 v50, v50, v250
    v_mul_f32 v51, v51, v250
    v_mul_f32 v52, v52, v250
    v_mul_f32 v53, v53, v250
    v_mul_f32 v54, v54, v250
    v_mul_f32 v55, v55, v250
    v_add_f32 v64, v64, v253
    v_add_f32 v65, v65, v253
    v_add_f32 v66, v66, v253
    v_add_f32 v67, v67, v253
    v_add_f32 v68, v68, v253
    v_add_f32 v69, v69, v253
    v_add_f32 v70, v70, v253
    v_add_f32 v71, v71, v253
    v_add_f32 v80, v80, v253
    v_add_f32 v81, v81, v253
    v_add_f32 v82, v82, v253
    v_add_f32 v83, v83, v253
    v_add_f32 v84, v84, v253
    v_add_f32 v85, v85, v253
    v_add_f32 v86, v86, v253
    v_add_f32 v87, v87, v253
    v_sub_f32 v254, 0, v254
    v_min_f32 v254, v254, v244
    v_sub_f32 v255, v254, v244
    v_exp_f32 v251, v255
    v_mov_b32 v244, v254
    v_mov_b32 v245, v254
    v_mov_b32 v246, v254
    v_mov_b32 v247, v254
    v_mul_f32 v249, v249, v251
    v_mul_f32 v8, v8, v251
    v_mul_f32 v9, v9, v251
    v_mul_f32 v10, v10, v251
    v_mul_f32 v11, v11, v251
    v_mul_f32 v12, v12, v251
    v_mul_f32 v13, v13, v251
    v_mul_f32 v14, v14, v251
    v_mul_f32 v15, v15, v251
    v_mul_f32 v24, v24, v251
    v_mul_f32 v25, v25, v251
    v_mul_f32 v26, v26, v251
    v_mul_f32 v27, v27, v251
    v_mul_f32 v28, v28, v251
    v_mul_f32 v29, v29, v251
    v_mul_f32 v30, v30, v251
    v_mul_f32 v31, v31, v251
    v_mul_f32 v40, v40, v251
    v_mul_f32 v41, v41, v251
    v_mul_f32 v42, v42, v251
    v_mul_f32 v43, v43, v251
    v_mul_f32 v44, v44, v251
    v_mul_f32 v45, v45, v251
    v_mul_f32 v46, v46, v251
    v_mul_f32 v47, v47, v251
    v_mul_f32 v56, v56, v251
    v_mul_f32 v57, v57, v251
    v_mul_f32 v58, v58, v251
    v_mul_f32 v59, v59, v251
    v_mul_f32 v60, v60, v251
    v_mul_f32 v61, v61, v251
    v_mul_f32 v62, v62, v251
    v_mul_f32 v63, v63, v251
    v_add_f32 v72, v72, v255
    v_add_f32 v73, v73, v255
    v_add_f32 v74, v74, v255
    v_add_f32 v75, v75, v255
    v_add_f32 v76, v76, v255
    v_add_f32 v77, v77, v255
    v_add_f32 v78, v78, v255
    v_add_f32 v79, v79, v255
    v_add_f32 v88, v88, v255
    v_add_f32 v89, v89, v255
    v_add_f32 v90, v90, v255
    v_add_f32 v91, v91, v255
    v_add_f32 v92, v92, v255
    v_add_f32 v93, v93, v255
    v_add_f32 v94, v94, v255
    v_add_f32 v95, v95, v255
    v_add_f32 v96, v96, v241
    v_add_f32 v97, v97, v242
    v_exp_f32 v96, v96
    v_add_f32 v98, v98, v243
    v_exp_f32 v97, v97
    v_add_f32 v99, v99, v240
    v_exp_f32 v98, v98
    v_add_f32 v100, v100, v241
    v_exp_f32 v99, v99
    v_add_f32 v252, v96, v97
    v_cvt_pk_bf16_f32 v96, v96, v97
    v_add_f32 v101, v101, v242
    v_exp_f32 v100, v100
    v_add_f32 v102, v102, v243
    v_exp_f32 v101, v101
    v_add_f32 v253, v98, v99
    v_cvt_pk_bf16_f32 v97, v98, v99
    v_add_f32 v103, v103, v240
    v_exp_f32 v102, v102
    v_add_f32 v252, v252, v100
    v_add_f32 v104, v104, v245
    v_exp_f32 v103, v103
    v_add_f32 v252, v252, v101
    v_cvt_pk_bf16_f32 v98, v100, v101
    v_add_f32 v105, v105, v246
    v_exp_f32 v104, v104
    v_add_f32 v253, v253, v102
    v_add_f32 v106, v106, v247
    v_exp_f32 v105, v105
    v_add_f32 v253, v253, v103
    v_cvt_pk_bf16_f32 v99, v102, v103
    v_add_f32 v107, v107, v244
    v_exp_f32 v106, v106
    v_add_f32 v108, v108, v245
    v_exp_f32 v107, v107
    v_add_f32 v254, v104, v105
    v_cvt_pk_bf16_f32 v104, v104, v105
    v_add_f32 v109, v109, v246
    v_exp_f32 v108, v108
    v_add_f32 v110, v110, v247
    v_exp_f32 v109, v109
    v_add_f32 v255, v106, v107
    v_cvt_pk_bf16_f32 v105, v106, v107
    v_add_f32 v111, v111, v244
    v_exp_f32 v110, v110
    v_add_f32 v254, v254, v108
    v_add_f32 v112, v112, v241
    v_exp_f32 v111, v111
    v_add_f32 v254, v254, v109
    v_cvt_pk_bf16_f32 v106, v108, v109
    v_add_f32 v113, v113, v242
    v_exp_f32 v112, v112
    v_add_f32 v255, v255, v110
    v_add_f32 v114, v114, v243
    v_exp_f32 v113, v113
    v_add_f32 v255, v255, v111
    v_cvt_pk_bf16_f32 v107, v110, v111
    v_add_f32 v115, v115, v240
    v_exp_f32 v114, v114
    v_add_f32 v252, v252, v112
    v_add_f32 v116, v116, v241
    v_exp_f32 v115, v115
    v_add_f32 v252, v252, v113
    v_cvt_pk_bf16_f32 v112, v112, v113
    v_add_f32 v117, v117, v242
    v_exp_f32 v116, v116
    v_add_f32 v253, v253, v114
    v_add_f32 v118, v118, v243
    v_exp_f32 v117, v117
    v_add_f32 v253, v253, v115
    v_cvt_pk_bf16_f32 v113, v114, v115
    v_add_f32 v119, v119, v240
    v_exp_f32 v118, v118
    v_add_f32 v252, v252, v116
    v_add_f32 v120, v120, v245
    v_exp_f32 v119, v119
    v_add_f32 v252, v252, v117
    v_cvt_pk_bf16_f32 v114, v116, v117
    v_add_f32 v121, v121, v246
    v_exp_f32 v120, v120
    v_add_f32 v253, v253, v118
    v_add_f32 v122, v122, v247
    v_exp_f32 v121, v121
    v_add_f32 v253, v253, v119
    v_cvt_pk_bf16_f32 v115, v118, v119
    v_add_f32 v123, v123, v244
    v_exp_f32 v122, v122
    v_add_f32 v254, v254, v120
    v_add_f32 v124, v124, v245
    v_exp_f32 v123, v123
    v_add_f32 v254, v254, v121
    v_cvt_pk_bf16_f32 v120, v120, v121
    v_add_f32 v125, v125, v246
    v_exp_f32 v124, v124
    v_add_f32 v255, v255, v122
    v_add_f32 v126, v126, v247
    v_exp_f32 v125, v125
    v_add_f32 v255, v255, v123
    v_cvt_pk_bf16_f32 v121, v122, v123
    v_add_f32 v127, v127, v244
    v_exp_f32 v126, v126
    v_add_f32 v254, v254, v124
    v_exp_f32 v127, v127
    v_add_f32 v254, v254, v125
    v_cvt_pk_bf16_f32 v122, v124, v125
    v_add_f32 v255, v255, v126
    v_add_f32 v255, v255, v127
    v_cvt_pk_bf16_f32 v123, v126, v127
    v_add_f32 v252, v252, v253
    v_add_f32 v254, v254, v255
    s_nop 3
    s_branch L_back_1_1
L_slow_1_2:
    s_nop 15
    v_add_u32 v239, s43, v224
    v_subrev_u32 v239, s43, v239
    ds_read_b128 v[252:255], v239 offset:0
    s_waitcnt lgkmcnt(0)
    v_mfma_f32_16x16x32_bf16 v[64:67], v[252:255], v[160:163], 0
    v_mfma_f32_16x16x32_bf16 v[72:75], v[252:255], v[176:179], 0
    s_nop 3
    v_add_u32 v239, s43, v225
    v_subrev_u32 v239, s43, v239
    ds_read_b128 v[252:255], v239 offset:0
    s_waitcnt lgkmcnt(0)
    v_mfma_f32_16x16x32_bf16 v[64:67], v[252:255], v[164:167], v[64:67]
    v_mfma_f32_16x16x32_bf16 v[72:75], v[252:255], v[180:183], v[72:75]
    s_nop 3
    v_add_u32 v239, s43, v226
    v_subrev_u32 v239, s43, v239
    ds_read_b128 v[252:255], v239 offset:0
    s_waitcnt lgkmcnt(0)
    v_mfma_f32_16x16x32_bf16 v[64:67], v[252:255], v[168:171], v[64:67]
    v_mfma_f32_16x16x32_bf16 v[72:75], v[252:255], v[184:187], v[72:75]
    s_nop 3
    v_add_u32 v239, s43, v227
    v_subrev_u32 v239, s43, v239
    ds_read_b128 v[252:255], v239 offset:0
    s_waitcnt lgkmcnt(0)
    v_mfma_f32_16x16x32_bf16 v[64:67], v[252:255], v[172:175], v[64:67]
    v_mfma_f32_16x16x32_bf16 v[72:75], v[252:255], v[188:191], v[72:75]
    s_nop 3
    v_add_u32 v239, s43, v224
    v_subrev_u32 v239, s43, v239
    ds_read_b128 v[252:255], v239 offset:4096
    s_waitcnt lgkmcnt(0)
    v_mfma_f32_16x16x32_bf16 v[68:71], v[252:255], v[160:163], 0
    v_mfma_f32_16x16x32_bf16 v[76:79], v[252:255], v[176:179], 0
    s_nop 3
    v_add_u32 v239, s43, v225
    v_subrev_u32 v239, s43, v239
    ds_read_b128 v[252:255], v239 offset:4096
    s_waitcnt lgkmcnt(0)
    v_mfma_f32_16x16x32_bf16 v[68:71], v[252:255], v[164:167], v[68:71]
    v_mfma_f32_16x16x32_bf16 v[76:79], v[252:255], v[180:183], v[76:79]
    s_nop 3
    v_add_u32 v239, s43, v226
    v_subrev_u32 v239, s43, v239
    ds_read_b128 v[252:255], v239 offset:4096
    s_waitcnt lgkmcnt(0)
    v_mfma_f32_16x16x32_bf16 v[68:71], v[252:255], v[168:171], v[68:71]
    v_mfma_f32_16x16x32_bf16 v[76:79], v[252:255], v[184:187], v[76:79]
    s_nop 3
    v_add_u32 v239, s43, v227
    v_subrev_u32 v239, s43, v239
    ds_read_b128 v[252:255], v239 offset:4096
    s_waitcnt lgkmcnt(0)
    v_mfma_f32_16x16x32_bf16 v[68:71], v[252:255], v[172:175], v[68:71]
    v_mfma_f32_16x16x32_bf16 v[76:79], v[252:255], v[188:191], v[76:79]
    s_nop 3
    v_add_u32 v239, s43, v224
    v_subrev_u32 v239, s43, v239
    ds_read_b128 v[252:255], v239 offset:8192
    s_waitcnt lgkmcnt(0)
    v_mfma_f32_16x16x32_bf16 v[80:83], v[252:255], v[160:163], 0
    v_mfma_f32_16x16x32_bf16 v[88:91], v[252:255], v[176:179], 0
    s_nop 3
    v_add_u32 v239, s43, v225
    v_subrev_u32 v239, s43, v239
    ds_read_b128 v[252:255], v239 offset:8192
    s_waitcnt lgkmcnt(0)
    v_mfma_f32_16x16x32_bf16 v[80:83], v[252:255], v[164:167], v[80:83]
    v_mfma_f32_16x16x32_bf16 v[88:91], v[252:255], v[180:183], v[88:91]
    s_nop 3
    v_add_u32 v239, s43, v226
    v_subrev_u32 v239, s43, v239
    ds_read_b128 v[252:255], v239 offset:8192
    s_waitcnt lgkmcnt(0)
    v_mfma_f32_16x16x32_bf16 v[80:83], v[252:255], v[168:171], v[80:83]
    v_mfma_f32_16x16x32_bf16 v[88:91], v[252:255], v[184:187], v[88:91]
    s_nop 3
    v_add_u32 v239, s43, v227
    v_subrev_u32 v239, s43, v239
    ds_read_b128 v[252:255], v239 offset:8192
    s_waitcnt lgkmcnt(0)
    v_mfma_f32_16x16x32_bf16 v[80:83], v[252:255], v[172:175], v[80:83]
    v_mfma_f32_16x16x32_bf16 v[88:91], v[252:255], v[188:191], v[88:91]
    s_nop 3
    v_add_u32 v239, s43, v224
    v_subrev_u32 v239, s43, v239
    ds_read_b128 v[252:255], v239 offset:12288
    s_waitcnt lgkmcnt(0)
    v_mfma_f32_16x16x32_bf16 v[84:87], v[252:255], v[160:163], 0
    v_mfma_f32_16x16x32_bf16 v[92:95], v[252:255], v[176:179], 0
    s_nop 3
    v_add_u32 v239, s43, v225
    v_subrev_u32 v239, s43, v239
    ds_read_b128 v[252:255], v239 offset:12288
    s_waitcnt lgkmcnt(0)
    v_mfma_f32_16x16x32_bf16 v[84:87], v[252:255], v[164:167], v[84:87]
    v_mfma_f32_16x16x32_bf16 v[92:95], v[252:255], v[180:183], v[92:95]
    s_nop 3
    v_add_u32 v239, s43, v226
    v_subrev_u32 v239, s43, v239
    ds_read_b128 v[252:255], v239 offset:12288
    s_waitcnt lgkmcnt(0)
    v_mfma_f32_16x16x32_bf16 v[84:87], v[252:255], v[168:171], v[84:87]
    v_mfma_f32_16x16x32_bf16 v[92:95], v[252:255], v[184:187], v[92:95]
    s_nop 3
    v_add_u32 v239, s43, v227
    v_subrev_u32 v239, s43, v239
    ds_read_b128 v[252:255], v239 offset:12288
    s_waitcnt lgkmcnt(0)
    v_mfma_f32_16x16x32_bf16 v[84:87], v[252:255], v[172:175], v[84:87]
    v_mfma_f32_16x16x32_bf16 v[92:95], v[252:255], v[188:191], v[92:95]
    s_nop 3
    s_nop 15
    v_max3_f32 v252, v64, v65, v66
    v_max3_f32 v254, v72, v73, v74
    v_max3_f32 v252, v252, v67, v68
    v_max3_f32 v254, v254, v75, v76
    v_max3_f32 v252, v252, v69, v70
    v_max3_f32 v254, v254, v77, v78
    v_max3_f32 v252, v252, v71, v80
    v_max3_f32 v254, v254, v79, v88
    v_max3_f32 v252, v252, v81, v82
    v_max3_f32 v254, v254, v89, v90
    v_max3_f32 v252, v252, v83, v84
    v_max3_f32 v254, v254, v91, v92
    v_max3_f32 v252, v252, v85, v86
    v_max3_f32 v254, v254, v93, v94
    v_max_f32 v252, v252, v87
    v_max_f32 v254, v254, v95
    v_mov_b32 v253, v252
    v_mov_b32 v255, v254
    s_nop 0
    v_permlane16_swap_b32 v252, v253
    v_permlane16_swap_b32 v254, v255
    v_max_f32 v252, v252, v253
    v_max_f32 v254, v254, v255
    v_mov_b32 v253, v252
    v_mov_b32 v255, v254
    s_nop 0
    v_permlane32_swap_b32 v252, v253
    v_permlane32_swap_b32 v254, v255
    v_max_f32 v252, v252, v253
    v_max_f32 v254, v254, v255
    v_sub_f32 v252, 0, v252
    v_min_f32 v252, v252, v240
    v_sub_f32 v253, v252, v240
    v_exp_f32 v250, v253
    v_mov_b32 v240, v252
    v_mov_b32 v241, v252
    v_mov_b32 v242, v252
    v_mov_b32 v243, v252
    v_mul_f32 v248, v248, v250
    v_mul_f32 v0, v0, v250
    v_mul_f32 v1, v1, v250
    v_mul_f32 v2, v2, v250
    v_mul_f32 v3, v3, v250
    v_mul_f32 v4, v4, v250
    v_mul_f32 v5, v5, v250
    v_mul_f32 v6, v6, v250
    v_mul_f32 v7, v7, v250
    v_mul_f32 v16, v16, v250
    v_mul_f32 v17, v17, v250
    v_mul_f32 v18, v18, v250
    v_mul_f32 v19, v19, v250
    v_mul_f32 v20, v20, v250
    v_mul_f32 v21, v21, v250
    v_mul_f32 v22, v22, v250
    v_mul_f32 v23, v23, v250
    v_mul_f32 v32, v32, v250
    v_mul_f32 v33, v33, v250
    v_mul_f32 v34, v34, v250
    v_mul_f32 v35, v35, v250
    v_mul_f32 v36, v36, v250
    v_mul_f32 v37, v37, v250
    v_mul_f32 v38, v38, v250
    v_mul_f32 v39, v39, v250
    v_mul_f32 v48, v48, v250
    v_mul_f32 v49, v49, v250
    v_mul_f32 v50, v50, v250
    v_mul_f32 v51, v51, v250
    v_mul_f32 v52, v52, v250
    v_mul_f32 v53, v53, v250
    v_mul_f32 v54, v54, v250
    v_mul_f32 v55, v55, v250
    v_add_f32 v96, v96, v253
    v_add_f32 v97, v97, v253
    v_add_f32 v98, v98, v253
    v_add_f32 v99, v99, v253
    v_add_f32 v100, v100, v253
    v_add_f32 v101, v101, v253
    v_add_f32 v102, v102, v253
    v_add_f32 v103, v103, v253
    v_add_f32 v112, v112, v253
    v_add_f32 v113, v113, v253
    v_add_f32 v114, v114, v253
    v_add_f32 v115, v115, v253
    v_add_f32 v116, v116, v253
    v_add_f32 v117, v117, v253
    v_add_f32 v118, v118, v253
    v_add_f32 v119, v119, v253
    v_sub_f32 v254, 0, v254
    v_min_f32 v254, v254, v244
    v_sub_f32 v255, v254, v244
    v_exp_f32 v251, v255
    v_mov_b32 v244, v254
    v_mov_b32 v245, v254
    v_mov_b32 v246, v254
    v_mov_b32 v247, v254
    v_mul_f32 v249, v249, v251
    v_mul_f32 v8, v8, v251
    v_mul_f32 v9, v9, v251
    v_mul_f32 v10, v10, v251
    v_mul_f32 v11, v11, v251
    v_mul_f32 v12, v12, v251
    v_mul_f32 v13, v13, v251
    v_mul_f32 v14, v14, v251
    v_mul_f32 v15, v15, v251
    v_mul_f32 v24, v24, v251
    v_mul_f32 v25, v25, v251
    v_mul_f32 v26, v26, v251
    v_mul_f32 v27, v27, v251
    v_mul_f32 v28, v28, v251
    v_mul_f32 v29, v29, v251
    v_mul_f32 v30, v30, v251
    v_mul_f32 v31, v31, v251
    v_mul_f32 v40, v40, v251
    v_mul_f32 v41, v41, v251
    v_mul_f32 v42, v42, v251
    v_mul_f32 v43, v43, v251
    v_mul_f32 v44, v44, v251
    v_mul_f32 v45, v45, v251
    v_mul_f32 v46, v46, v251
    v_mul_f32 v47, v47, v251
    v_mul_f32 v56, v56, v251
    v_mul_f32 v57, v57, v251
    v_mul_f32 v58, v58, v251
    v_mul_f32 v59, v59, v251
    v_mul_f32 v60, v60, v251
    v_mul_f32 v61, v61, v251
    v_mul_f32 v62, v62, v251
    v_mul_f32 v63, v63, v251
    v_add_f32 v104, v104, v255
    v_add_f32 v105, v105, v255
    v_add_f32 v106, v106, v255
    v_add_f32 v107, v107, v255
    v_add_f32 v108, v108, v255
    v_add_f32 v109, v109, v255
    v_add_f32 v110, v110, v255
    v_add_f32 v111, v111, v255
    v_add_f32 v120, v120, v255
    v_add_f32 v121, v121, v255
    v_add_f32 v122, v122, v255
    v_add_f32 v123, v123, v255
    v_add_f32 v124, v124, v255
    v_add_f32 v125, v125, v255
    v_add_f32 v126, v126, v255
    v_add_f32 v127, v127, v255
    v_add_f32 v64, v64, v241
    v_add_f32 v65, v65, v242
    v_exp_f32 v64, v64
    v_add_f32 v66, v66, v243
    v_exp_f32 v65, v65
    v_add_f32 v67, v67, v240
    v_exp_f32 v66, v66
    v_add_f32 v68, v68, v241
    v_exp_f32 v67, v67
    v_add_f32 v252, v64, v65
    v_cvt_pk_bf16_f32 v64, v64, v65
    v_add_f32 v69, v69, v242
    v_exp_f32 v68, v68
    v_add_f32 v70, v70, v243
    v_exp_f32 v69, v69
    v_add_f32 v253, v66, v67
    v_cvt_pk_bf16_f32 v65, v66, v67
    v_add_f32 v71, v71, v240
    v_exp_f32 v70, v70
    v_add_f32 v252, v252, v68
    v_add_f32 v72, v72, v245
    v_exp_f32 v71, v71
    v_add_f32 v252, v252, v69
    v_cvt_pk_bf16_f32 v66, v68, v69
    v_add_f32 v73, v73, v246
    v_exp_f32 v72, v72
    v_add_f32 v253, v253, v70
    v_add_f32 v74, v74, v247
    v_exp_f32 v73, v73
    v_add_f32 v253, v253, v71
    v_cvt_pk_bf16_f32 v67, v70, v71
    v_add_f32 v75, v75, v244
    v_exp_f32 v74, v74
    v_add_f32 v76, v76, v245
    v_exp_f32 v75, v75
    v_add_f32 v254, v72, v73
    v_cvt_pk_bf16_f32 v72, v72, v73
    v_add_f32 v77, v77, v246
    v_exp_f32 v76, v76
    v_add_f32 v78, v78, v247
    v_exp_f32 v77, v77
    v_add_f32 v255, v74, v75
    v_cvt_pk_bf16_f32 v73, v74, v75
    v_add_f32 v79, v79, v244
    v_exp_f32 v78, v78
    v_add_f32 v254, v254, v76
    v_add_f32 v80, v80, v241
    v_exp_f32 v79, v79
    v_add_f32 v254, v254, v77
    v_cvt_pk_bf16_f32 v74, v76, v77
    v_add_f32 v81, v81, v242
    v_exp_f32 v80, v80
    v_add_f32 v255, v255, v78
    v_add_f32 v82, v82, v243
    v_exp_f32 v81, v81
    v_add_f32 v255, v255, v79
    v_cvt_pk_bf16_f32 v75, v78, v79
    v_add_f32 v83, v83, v240
    v_exp_f32 v82, v82
    v_add_f32 v252, v252, v80
    v_add_f32 v84, v84, v241
    v_exp_f32 v83, v83
    v_add_f32 v252, v252, v81
    v_cvt_pk_bf16_f32 v80, v80, v81
    v_add_f32 v85, v85, v242
    v_exp_f32 v84, v84
    v_add_f32 v253, v253, v82
    v_add_f32 v86, v86, v243
    v_exp_f32 v85, v85
    v_add_f32 v253, v253, v83
    v_cvt_pk_bf16_f32 v81, v82, v83
    v_add_f32 v87, v87, v240
    v_exp_f32 v86, v86
    v_add_f32 v252, v252, v84
    v_add_f32 v88, v88, v245
    v_exp_f32 v87, v87
    v_add_f32 v252, v252, v85
    v_cvt_pk_bf16_f32 v82, v84, v85
    v_add_f32 v89, v89, v246
    v_exp_f32 v88, v88
    v_add_f32 v253, v253, v86
    v_add_f32 v90, v90, v247
    v_exp_f32 v89, v89
    v_add_f32 v253, v253, v87
    v_cvt_pk_bf16_f32 v83, v86, v87
    v_add_f32 v91, v91, v244
    v_exp_f32 v90, v90
    v_add_f32 v254, v254, v88
    v_add_f32 v92, v92, v245
    v_exp_f32 v91, v91
    v_add_f32 v254, v254, v89
    v_cvt_pk_bf16_f32 v88, v88, v89
    v_add_f32 v93, v93, v246
    v_exp_f32 v92, v92
    v_add_f32 v255, v255, v90
    v_add_f32 v94, v94, v247
    v_exp_f32 v93, v93
    v_add_f32 v255, v255, v91
    v_cvt_pk_bf16_f32 v89, v90, v91
    v_add_f32 v95, v95, v244
    v_exp_f32 v94, v94
    v_add_f32 v254, v254, v92
    v_exp_f32 v95, v95
    v_add_f32 v254, v254, v93
    v_cvt_pk_bf16_f32 v90, v92, v93
    v_add_f32 v255, v255, v94
    v_add_f32 v255, v255, v95
    v_cvt_pk_bf16_f32 v91, v94, v95
    v_add_f32 v252, v252, v253
    v_add_f32 v254, v254, v255
    s_nop 3
    s_branch L_back_1_2
L_slow_1_3:
    s_nop 15
    v_add_u32 v239, s43, v224
    v_subrev_u32 v239, s44, v239
    ds_read_b128 v[252:255], v239 offset:16384
    s_waitcnt lgkmcnt(0)
    v_mfma_f32_16x16x32_bf16 v[96:99], v[252:255], v[160:163], 0
    v_mfma_f32_16x16x32_bf16 v[104:107], v[252:255], v[176:179], 0
    s_nop 3
    v_add_u32 v239, s43, v225
    v_subrev_u32 v239, s44, v239
    ds_read_b128 v[252:255], v239 offset:16384
    s_waitcnt lgkmcnt(0)
    v_mfma_f32_16x16x32_bf16 v[96:99], v[252:255], v[164:167], v[96:99]
    v_mfma_f32_16x16x32_bf16 v[104:107], v[252:255], v[180:183], v[104:107]
    s_nop 3
    v_add_u32 v239, s43, v226
    v_subrev_u32 v239, s44, v239
    ds_read_b128 v[252:255], v239 offset:16384
    s_waitcnt lgkmcnt(0)
    v_mfma_f32_16x16x32_bf16 v[96:99], v[252:255], v[168:171], v[96:99]
    v_mfma_f32_16x16x32_bf16 v[104:107], v[252:255], v[184:187], v[104:107]
    s_nop 3
    v_add_u32 v239, s43, v227
    v_subrev_u32 v239, s44, v239
    ds_read_b128 v[252:255], v239 offset:16384
    s_waitcnt lgkmcnt(0)
    v_mfma_f32_16x16x32_bf16 v[96:99], v[252:255], v[172:175], v[96:99]
    v_mfma_f32_16x16x32_bf16 v[104:107], v[252:255], v[188:191], v[104:107]
    s_nop 3
    v_add_u32 v239, s43, v224
    v_subrev_u32 v239, s44, v239
    ds_read_b128 v[252:255], v239 offset:20480
    s_waitcnt lgkmcnt(0)
    v_mfma_f32_16x16x32_bf16 v[100:103], v[252:255], v[160:163], 0
    v_mfma_f32_16x16x32_bf16 v[108:111], v[252:255], v[176:179], 0
    s_nop 3
    v_add_u32 v239, s43, v225
    v_subrev_u32 v239, s44, v239
    ds_read_b128 v[252:255], v239 offset:20480
    s_waitcnt lgkmcnt(0)
    v_mfma_f32_16x16x32_bf16 v[100:103], v[252:255], v[164:167], v[100:103]
    v_mfma_f32_16x16x32_bf16 v[108:111], v[252:255], v[180:183], v[108:111]
    s_nop 3
    v_add_u32 v239, s43, v226
    v_subrev_u32 v239, s44, v239
    ds_read_b128 v[252:255], v239 offset:20480
    s_waitcnt lgkmcnt(0)
    v_mfma_f32_16x16x32_bf16 v[100:103], v[252:255], v[168:171], v[100:103]
    v_mfma_f32_16x16x32_bf16 v[108:111], v[252:255], v[184:187], v[108:111]
    s_nop 3
    v_add_u32 v239, s43, v227
    v_subrev_u32 v239, s44, v239
    ds_read_b128 v[252:255], v239 offset:20480
    s_waitcnt lgkmcnt(0)
    v_mfma_f32_16x16x32_bf16 v[100:103], v[252:255], v[172:175], v[100:103]
    v_mfma_f32_16x16x32_bf16 v[108:111], v[252:255], v[188:191], v[108:111]
    s_nop 3
    v_add_u32 v239, s43, v224
    v_subrev_u32 v239, s44, v239
    ds_read_b128 v[252:255], v239 offset:24576
    s_waitcnt lgkmcnt(0)
    v_mfma_f32_16x16x32_bf16 v[112:115], v[252:255], v[160:163], 0
    v_mfma_f32_16x16x32_bf16 v[120:123], v[252:255], v[176:179], 0
    s_nop 3
    v_add_u32 v239, s43, v225
    v_subrev_u32 v239, s44, v239
    ds_read_b128 v[252:255], v239 offset:24576
    s_waitcnt lgkmcnt(0)
    v_mfma_f32_16x16x32_bf16 v[112:115], v[252:255], v[164:167], v[112:115]
    v_mfma_f32_16x16x32_bf16 v[120:123], v[252:255], v[180:183], v[120:123]
    s_nop 3
    v_add_u32 v239, s43, v226
    v_subrev_u32 v239, s44, v239
    ds_read_b128 v[252:255], v239 offset:24576
    s_waitcnt lgkmcnt(0)
    v_mfma_f32_16x16x32_bf16 v[112:115], v[252:255], v[168:171], v[112:115]
    v_mfma_f32_16x16x32_bf16 v[120:123], v[252:255], v[184:187], v[120:123]
    s_nop 3
    v_add_u32 v239, s43, v227
    v_subrev_u32 v239, s44, v239
    ds_read_b128 v[252:255], v239 offset:24576
    s_waitcnt lgkmcnt(0)
    v_mfma_f32_16x16x32_bf16 v[112:115], v[252:255], v[172:175], v[112:115]
    v_mfma_f32_16x16x32_bf16 v[120:123], v[252:255], v[188:191], v[120:123]
    s_nop 3
    v_add_u32 v239, s43, v224
    v_subrev_u32 v239, s44, v239
    ds_read_b128 v[252:255], v239 offset:28672
    s_waitcnt lgkmcnt(0)
    v_mfma_f32_16x16x32_bf16 v[116:119], v[252:255], v[160:163], 0
    v_mfma_f32_16x16x32_bf16 v[124:127], v[252:255], v[176:179], 0
    s_nop 3
    v_add_u32 v239, s43, v225
    v_subrev_u32 v239, s44, v239
    ds_read_b128 v[252:255], v239 offset:28672
    s_waitcnt lgkmcnt(0)
    v_mfma_f32_16x16x32_bf16 v[116:119], v[252:255], v[164:167], v[116:119]
    v_mfma_f32_16x16x32_bf16 v[124:127], v[252:255], v[180:183], v[124:127]
    s_nop 3
    v_add_u32 v239, s43, v226
    v_subrev_u32 v239, s44, v239
    ds_read_b128 v[252:255], v239 offset:28672
    s_waitcnt lgkmcnt(0)
    v_mfma_f32_16x16x32_bf16 v[116:119], v[252:255], v[168:171], v[116:119]
    v_mfma_f32_16x16x32_bf16 v[124:127], v[252:255], v[184:187], v[124:127]
    s_nop 3
    v_add_u32 v239, s43, v227
    v_subrev_u32 v239, s44, v239
    ds_read_b128 v[252:255], v239 offset:28672
    s_waitcnt lgkmcnt(0)
    v_mfma_f32_16x16x32_bf16 v[116:119], v[252:255], v[172:175], v[116:119]
    v_mfma_f32_16x16x32_bf16 v[124:127], v[252:255], v[188:191], v[124:127]
    s_nop 3
    s_nop 15
    v_max3_f32 v252, v96, v97, v98
    v_max3_f32 v254, v104, v105, v106
    v_max3_f32 v252, v252, v99, v100
    v_max3_f32 v254, v254, v107, v108
    v_max3_f32 v252, v252, v101, v102
    v_max3_f32 v254, v254, v109, v110
    v_max3_f32 v252, v252, v103, v112
    v_max3_f32 v254, v254, v111, v120
    v_max3_f32 v252, v252, v113, v114
    v_max3_f32 v254, v254, v121, v122
    v_max3_f32 v252, v252, v115, v116
    v_max3_f32 v254, v254, v123, v124
    v_max3_f32 v252, v252, v117, v118
    v_max3_f32 v254, v254, v125, v126
    v_max_f32 v252, v252, v119
    v_max_f32 v254, v254, v127
    v_mov_b32 v253, v252
    v_mov_b32 v255, v254
    s_nop 0
    v_permlane16_swap_b32 v252, v253
    v_permlane16_swap_b32 v254, v255
    v_max_f32 v252, v252, v253
    v_max_f32 v254, v254, v255
    v_mov_b32 v253, v252
    v_mov_b32 v255, v254
    s_nop 0
    v_permlane32_swap_b32 v252, v253
    v_permlane32_swap_b32 v254, v255
    v_max_f32 v252, v252, v253
    v_max_f32 v254, v254, v255
    v_sub_f32 v252, 0, v252
    v_min_f32 v252, v252, v240
    v_sub_f32 v253, v252, v240
    v_exp_f32 v250, v253
    v_mov_b32 v240, v252
    v_mov_b32 v241, v252
    v_mov_b32 v242, v252
    v_mov_b32 v243, v252
    v_mul_f32 v248, v248, v250
    v_mul_f32 v0, v0, v250
    v_mul_f32 v1, v1, v250
    v_mul_f32 v2, v2, v250
    v_mul_f32 v3, v3, v250
    v_mul_f32 v4, v4, v250
    v_mul_f32 v5, v5, v250
    v_mul_f32 v6, v6, v250
    v_mul_f32 v7, v7, v250
    v_mul_f32 v16, v16, v250
    v_mul_f32 v17, v17, v250
    v_mul_f32 v18, v18, v250
    v_mul_f32 v19, v19, v250
    v_mul_f32 v20, v20, v250
    v_mul_f32 v21, v21, v250
    v_mul_f32 v22, v22, v250
    v_mul_f32 v23, v23, v250
    v_mul_f32 v32, v32, v250
    v_mul_f32 v33, v33, v250
    v_mul_f32 v34, v34, v250
    v_mul_f32 v35, v35, v250
    v_mul_f32 v36, v36, v250
    v_mul_f32 v37, v37, v250
    v_mul_f32 v38, v38, v250
    v_mul_f32 v39, v39, v250
    v_mul_f32 v48, v48, v250
    v_mul_f32 v49, v49, v250
    v_mul_f32 v50, v50, v250
    v_mul_f32 v51, v51, v250
    v_mul_f32 v52, v52, v250
    v_mul_f32 v53, v53, v250
    v_mul_f32 v54, v54, v250
    v_mul_f32 v55, v55, v250
    v_add_f32 v64, v64, v253
    v_add_f32 v65, v65, v253
    v_add_f32 v66, v66, v253
    v_add_f32 v67, v67, v253
    v_add_f32 v68, v68, v253
    v_add_f32 v69, v69, v253
    v_add_f32 v70, v70, v253
    v_add_f32 v71, v71, v253
    v_add_f32 v80, v80, v253
    v_add_f32 v81, v81, v253
    v_add_f32 v82, v82, v253
    v_add_f32 v83, v83, v253
    v_add_f32 v84, v84, v253
    v_add_f32 v85, v85, v253
    v_add_f32 v86, v86, v253
    v_add_f32 v87, v87, v253
    v_sub_f32 v254, 0, v254
    v_min_f32 v254, v254, v244
    v_sub_f32 v255, v254, v244
    v_exp_f32 v251, v255
    v_mov_b32 v244, v254
    v_mov_b32 v245, v254
    v_mov_b32 v246, v254
    v_mov_b32 v247, v254
    v_mul_f32 v249, v249, v251
    v_mul_f32 v8, v8, v251
    v_mul_f32 v9, v9, v251
    v_mul_f32 v10, v10, v251
    v_mul_f32 v11, v11, v251
    v_mul_f32 v12, v12, v251
    v_mul_f32 v13, v13, v251
    v_mul_f32 v14, v14, v251
    v_mul_f32 v15, v15, v251
    v_mul_f32 v24, v24, v251
    v_mul_f32 v25, v25, v251
    v_mul_f32 v26, v26, v251
    v_mul_f32 v27, v27, v251
    v_mul_f32 v28, v28, v251
    v_mul_f32 v29, v29, v251
    v_mul_f32 v30, v30, v251
    v_mul_f32 v31, v31, v251
    v_mul_f32 v40, v40, v251
    v_mul_f32 v41, v41, v251
    v_mul_f32 v42, v42, v251
    v_mul_f32 v43, v43, v251
    v_mul_f32 v44, v44, v251
    v_mul_f32 v45, v45, v251
    v_mul_f32 v46, v46, v251
    v_mul_f32 v47, v47, v251
    v_mul_f32 v56, v56, v251
    v_mul_f32 v57, v57, v251
    v_mul_f32 v58, v58, v251
    v_mul_f32 v59, v59, v251
    v_mul_f32 v60, v60, v251
    v_mul_f32 v61, v61, v251
    v_mul_f32 v62, v62, v251
    v_mul_f32 v63, v63, v251
    v_add_f32 v72, v72, v255
    v_add_f32 v73, v73, v255
    v_add_f32 v74, v74, v255
    v_add_f32 v75, v75, v255
    v_add_f32 v76, v76, v255
    v_add_f32 v77, v77, v255
    v_add_f32 v78, v78, v255
    v_add_f32 v79, v79, v255
    v_add_f32 v88, v88, v255
    v_add_f32 v89, v89, v255
    v_add_f32 v90, v90, v255
    v_add_f32 v91, v91, v255
    v_add_f32 v92, v92, v255
    v_add_f32 v93, v93, v255
    v_add_f32 v94, v94, v255
    v_add_f32 v95, v95, v255
    v_add_f32 v96, v96, v241
    v_add_f32 v97, v97, v242
    v_exp_f32 v96, v96
    v_add_f32 v98, v98, v243
    v_exp_f32 v97, v97
    v_add_f32 v99, v99, v240
    v_exp_f32 v98, v98
    v_add_f32 v100, v100, v241
    v_exp_f32 v99, v99
    v_add_f32 v252, v96, v97
    v_cvt_pk_bf16_f32 v96, v96, v97
    v_add_f32 v101, v101, v242
    v_exp_f32 v100, v100
    v_add_f32 v102, v102, v243
    v_exp_f32 v101, v101
    v_add_f32 v253, v98, v99
    v_cvt_pk_bf16_f32 v97, v98, v99
    v_add_f32 v103, v103, v240
    v_exp_f32 v102, v102
    v_add_f32 v252, v252, v100
    v_add_f32 v104, v104, v245
    v_exp_f32 v103, v103
    v_add_f32 v252, v252, v101
    v_cvt_pk_bf16_f32 v98, v100, v101
    v_add_f32 v105, v105, v246
    v_exp_f32 v104, v104
    v_add_f32 v253, v253, v102
    v_add_f32 v106, v106, v247
    v_exp_f32 v105, v105
    v_add_f32 v253, v253, v103
    v_cvt_pk_bf16_f32 v99, v102, v103
    v_add_f32 v107, v107, v244
    v_exp_f32 v106, v106
    v_add_f32 v108, v108, v245
    v_exp_f32 v107, v107
    v_add_f32 v254, v104, v105
    v_cvt_pk_bf16_f32 v104, v104, v105
    v_add_f32 v109, v109, v246
    v_exp_f32 v108, v108
    v_add_f32 v110, v110, v247
    v_exp_f32 v109, v109
    v_add_f32 v255, v106, v107
    v_cvt_pk_bf16_f32 v105, v106, v107
    v_add_f32 v111, v111, v244
    v_exp_f32 v110, v110
    v_add_f32 v254, v254, v108
    v_add_f32 v112, v112, v241
    v_exp_f32 v111, v111
    v_add_f32 v254, v254, v109
    v_cvt_pk_bf16_f32 v106, v108, v109
    v_add_f32 v113, v113, v242
    v_exp_f32 v112, v112
    v_add_f32 v255, v255, v110
    v_add_f32 v114, v114, v243
    v_exp_f32 v113, v113
    v_add_f32 v255, v255, v111
    v_cvt_pk_bf16_f32 v107, v110, v111
    v_add_f32 v115, v115, v240
    v_exp_f32 v114, v114
    v_add_f32 v252, v252, v112
    v_add_f32 v116, v116, v241
    v_exp_f32 v115, v115
    v_add_f32 v252, v252, v113
    v_cvt_pk_bf16_f32 v112, v112, v113
    v_add_f32 v117, v117, v242
    v_exp_f32 v116, v116
    v_add_f32 v253, v253, v114
    v_add_f32 v118, v118, v243
    v_exp_f32 v117, v117
    v_add_f32 v253, v253, v115
    v_cvt_pk_bf16_f32 v113, v114, v115
    v_add_f32 v119, v119, v240
    v_exp_f32 v118, v118
    v_add_f32 v252, v252, v116
    v_add_f32 v120, v120, v245
    v_exp_f32 v119, v119
    v_add_f32 v252, v252, v117
    v_cvt_pk_bf16_f32 v114, v116, v117
    v_add_f32 v121, v121, v246
    v_exp_f32 v120, v120
    v_add_f32 v253, v253, v118
    v_add_f32 v122, v122, v247
    v_exp_f32 v121, v121
    v_add_f32 v253, v253, v119
    v_cvt_pk_bf16_f32 v115, v118, v119
    v_add_f32 v123, v123, v244
    v_exp_f32 v122, v122
    v_add_f32 v254, v254, v120
    v_add_f32 v124, v124, v245
    v_exp_f32 v123, v123
    v_add_f32 v254, v254, v121
    v_cvt_pk_bf16_f32 v120, v120, v121
    v_add_f32 v125, v125, v246
    v_exp_f32 v124, v124
    v_add_f32 v255, v255, v122
    v_add_f32 v126, v126, v247
    v_exp_f32 v125, v125
    v_add_f32 v255, v255, v123
    v_cvt_pk_bf16_f32 v121, v122, v123
    v_add_f32 v127, v127, v244
    v_exp_f32 v126, v126
    v_add_f32 v254, v254, v124
    v_exp_f32 v127, v127
    v_add_f32 v254, v254, v125
    v_cvt_pk_bf16_f32 v122, v124, v125
    v_add_f32 v255, v255, v126
    v_add_f32 v255, v255, v127
    v_cvt_pk_bf16_f32 v123, v126, v127
    v_add_f32 v252, v252, v253
    v_add_f32 v254, v254, v255
    s_nop 3
    s_branch L_back_1_3
L_slow_1_4:
    s_nop 15
    v_add_u32 v239, s44, v224
    v_subrev_u32 v239, s44, v239
    ds_read_b128 v[252:255], v239 offset:0
    s_waitcnt lgkmcnt(0)
    v_mfma_f32_16x16x32_bf16 v[64:67], v[252:255], v[160:163], 0
    v_mfma_f32_16x16x32_bf16 v[72:75], v[252:255], v[176:179], 0
    s_nop 3
    v_add_u32 v239, s44, v225
    v_subrev_u32 v239, s44, v239
    ds_read_b128 v[252:255], v239 offset:0
    s_waitcnt lgkmcnt(0)
    v_mfma_f32_16x16x32_bf16 v[64:67], v[252:255], v[164:167], v[64:67]
    v_mfma_f32_16x16x32_bf16 v[72:75], v[252:255], v[180:183], v[72:75]
    s_nop 3
    v_add_u32 v239, s44, v226
    v_subrev_u32 v239, s44, v239
    ds_read_b128 v[252:255], v239 offset:0
    s_waitcnt lgkmcnt(0)
    v_mfma_f32_16x16x32_bf16 v[64:67], v[252:255], v[168:171], v[64:67]
    v_mfma_f32_16x16x32_bf16 v[72:75], v[252:255], v[184:187], v[72:75]
    s_nop 3
    v_add_u32 v239, s44, v227
    v_subrev_u32 v239, s44, v239
    ds_read_b128 v[252:255], v239 offset:0
    s_waitcnt lgkmcnt(0)
    v_mfma_f32_16x16x32_bf16 v[64:67], v[252:255], v[172:175], v[64:67]
    v_mfma_f32_16x16x32_bf16 v[72:75], v[252:255], v[188:191], v[72:75]
    s_nop 3
    v_add_u32 v239, s44, v224
    v_subrev_u32 v239, s44, v239
    ds_read_b128 v[252:255], v239 offset:4096
    s_waitcnt lgkmcnt(0)
    v_mfma_f32_16x16x32_bf16 v[68:71], v[252:255], v[160:163], 0
    v_mfma_f32_16x16x32_bf16 v[76:79], v[252:255], v[176:179], 0
    s_nop 3
    v_add_u32 v239, s44, v225
    v_subrev_u32 v239, s44, v239
    ds_read_b128 v[252:255], v239 offset:4096
    s_waitcnt lgkmcnt(0)
    v_mfma_f32_16x16x32_bf16 v[68:71], v[252:255], v[164:167], v[68:71]
    v_mfma_f32_16x16x32_bf16 v[76:79], v[252:255], v[180:183], v[76:79]
    s_nop 3
    v_add_u32 v239, s44, v226
    v_subrev_u32 v239, s44, v239
    ds_read_b128 v[252:255], v239 offset:4096
    s_waitcnt lgkmcnt(0)
    v_mfma_f32_16x16x32_bf16 v[68:71], v[252:255], v[168:171], v[68:71]
    v_mfma_f32_16x16x32_bf16 v[76:79], v[252:255], v[184:187], v[76:79]
    s_nop 3
    v_add_u32 v239, s44, v227
    v_subrev_u32 v239, s44, v239
    ds_read_b128 v[252:255], v239 offset:4096
    s_waitcnt lgkmcnt(0)
    v_mfma_f32_16x16x32_bf16 v[68:71], v[252:255], v[172:175], v[68:71]
    v_mfma_f32_16x16x32_bf16 v[76:79], v[252:255], v[188:191], v[76:79]
    s_nop 3
    v_add_u32 v239, s44, v224
    v_subrev_u32 v239, s44, v239
    ds_read_b128 v[252:255], v239 offset:8192
    s_waitcnt lgkmcnt(0)
    v_mfma_f32_16x16x32_bf16 v[80:83], v[252:255], v[160:163], 0
    v_mfma_f32_16x16x32_bf16 v[88:91], v[252:255], v[176:179], 0
    s_nop 3
    v_add_u32 v239, s44, v225
    v_subrev_u32 v239, s44, v239
    ds_read_b128 v[252:255], v239 offset:8192
    s_waitcnt lgkmcnt(0)
    v_mfma_f32_16x16x32_bf16 v[80:83], v[252:255], v[164:167], v[80:83]
    v_mfma_f32_16x16x32_bf16 v[88:91], v[252:255], v[180:183], v[88:91]
    s_nop 3
    v_add_u32 v239, s44, v226
    v_subrev_u32 v239, s44, v239
    ds_read_b128 v[252:255], v239 offset:8192
    s_waitcnt lgkmcnt(0)
    v_mfma_f32_16x16x32_bf16 v[80:83], v[252:255], v[168:171], v[80:83]
    v_mfma_f32_16x16x32_bf16 v[88:91], v[252:255], v[184:187], v[88:91]
    s_nop 3
    v_add_u32 v239, s44, v227
    v_subrev_u32 v239, s44, v239
    ds_read_b128 v[252:255], v239 offset:8192
    s_waitcnt lgkmcnt(0)
    v_mfma_f32_16x16x32_bf16 v[80:83], v[252:255], v[172:175], v[80:83]
    v_mfma_f32_16x16x32_bf16 v[88:91], v[252:255], v[188:191], v[88:91]
    s_nop 3
    v_add_u32 v239, s44, v224
    v_subrev_u32 v239, s44, v239
    ds_read_b128 v[252:255], v239 offset:12288
    s_waitcnt lgkmcnt(0)
    v_mfma_f32_16x16x32_bf16 v[84:87], v[252:255], v[160:163], 0
    v_mfma_f32_16x16x32_bf16 v[92:95], v[252:255], v[176:179], 0
    s_nop 3
    v_add_u32 v239, s44, v225
    v_subrev_u32 v239, s44, v239
    ds_read_b128 v[252:255], v239 offset:12288
    s_waitcnt lgkmcnt(0)
    v_mfma_f32_16x16x32_bf16 v[84:87], v[252:255], v[164:167], v[84:87]
    v_mfma_f32_16x16x32_bf16 v[92:95], v[252:255], v[180:183], v[92:95]
    s_nop 3
    v_add_u32 v239, s44, v226
    v_subrev_u32 v239, s44, v239
    ds_read_b128 v[252:255], v239 offset:12288
    s_waitcnt lgkmcnt(0)
    v_mfma_f32_16x16x32_bf16 v[84:87], v[252:255], v[168:171], v[84:87]
    v_mfma_f32_16x16x32_bf16 v[92:95], v[252:255], v[184:187], v[92:95]
    s_nop 3
    v_add_u32 v239, s44, v227
    v_subrev_u32 v239, s44, v239
    ds_read_b128 v[252:255], v239 offset:12288
    s_waitcnt lgkmcnt(0)
    v_mfma_f32_16x16x32_bf16 v[84:87], v[252:255], v[172:175], v[84:87]
    v_mfma_f32_16x16x32_bf16 v[92:95], v[252:255], v[188:191], v[92:95]
    s_nop 3
    s_nop 15
    v_max3_f32 v252, v64, v65, v66
    v_max3_f32 v254, v72, v73, v74
    v_max3_f32 v252, v252, v67, v68
    v_max3_f32 v254, v254, v75, v76
    v_max3_f32 v252, v252, v69, v70
    v_max3_f32 v254, v254, v77, v78
    v_max3_f32 v252, v252, v71, v80
    v_max3_f32 v254, v254, v79, v88
    v_max3_f32 v252, v252, v81, v82
    v_max3_f32 v254, v254, v89, v90
    v_max3_f32 v252, v252, v83, v84
    v_max3_f32 v254, v254, v91, v92
    v_max3_f32 v252, v252, v85, v86
    v_max3_f32 v254, v254, v93, v94
    v_max_f32 v252, v252, v87
    v_max_f32 v254, v254, v95
    v_mov_b32 v253, v252
    v_mov_b32 v255, v254
    s_nop 0
    v_permlane16_swap_b32 v252, v253
    v_permlane16_swap_b32 v254, v255
    v_max_f32 v252, v252, v253
    v_max_f32 v254, v254, v255
    v_mov_b32 v253, v252
    v_mov_b32 v255, v254
    s_nop 0
    v_permlane32_swap_b32 v252, v253
    v_permlane32_swap_b32 v254, v255
    v_max_f32 v252, v252, v253
    v_max_f32 v254, v254, v255
    v_sub_f32 v252, 0, v252
    v_min_f32 v252, v252, v240
    v_sub_f32 v253, v252, v240
    v_exp_f32 v250, v253
    v_mov_b32 v240, v252
    v_mov_b32 v241, v252
    v_mov_b32 v242, v252
    v_mov_b32 v243, v252
    v_mul_f32 v248, v248, v250
    v_mul_f32 v0, v0, v250
    v_mul_f32 v1, v1, v250
    v_mul_f32 v2, v2, v250
    v_mul_f32 v3, v3, v250
    v_mul_f32 v4, v4, v250
    v_mul_f32 v5, v5, v250
    v_mul_f32 v6, v6, v250
    v_mul_f32 v7, v7, v250
    v_mul_f32 v16, v16, v250
    v_mul_f32 v17, v17, v250
    v_mul_f32 v18, v18, v250
    v_mul_f32 v19, v19, v250
    v_mul_f32 v20, v20, v250
    v_mul_f32 v21, v21, v250
    v_mul_f32 v22, v22, v250
    v_mul_f32 v23, v23, v250
    v_mul_f32 v32, v32, v250
    v_mul_f32 v33, v33, v250
    v_mul_f32 v34, v34, v250
    v_mul_f32 v35, v35, v250
    v_mul_f32 v36, v36, v250
    v_mul_f32 v37, v37, v250
    v_mul_f32 v38, v38, v250
    v_mul_f32 v39, v39, v250
    v_mul_f32 v48, v48, v250
    v_mul_f32 v49, v49, v250
    v_mul_f32 v50, v50, v250
    v_mul_f32 v51, v51, v250
    v_mul_f32 v52, v52, v250
    v_mul_f32 v53, v53, v250
    v_mul_f32 v54, v54, v250
    v_mul_f32 v55, v55, v250
    v_add_f32 v96, v96, v253
    v_add_f32 v97, v97, v253
    v_add_f32 v98, v98, v253
    v_add_f32 v99, v99, v253
    v_add_f32 v100, v100, v253
    v_add_f32 v101, v101, v253
    v_add_f32 v102, v102, v253
    v_add_f32 v103, v103, v253
    v_add_f32 v112, v112, v253
    v_add_f32 v113, v113, v253
    v_add_f32 v114, v114, v253
    v_add_f32 v115, v115, v253
    v_add_f32 v116, v116, v253
    v_add_f32 v117, v117, v253
    v_add_f32 v118, v118, v253
    v_add_f32 v119, v119, v253
    v_sub_f32 v254, 0, v254
    v_min_f32 v254, v254, v244
    v_sub_f32 v255, v254, v244
    v_exp_f32 v251, v255
    v_mov_b32 v244, v254
    v_mov_b32 v245, v254
    v_mov_b32 v246, v254
    v_mov_b32 v247, v254
    v_mul_f32 v249, v249, v251
    v_mul_f32 v8, v8, v251
    v_mul_f32 v9, v9, v251
    v_mul_f32 v10, v10, v251
    v_mul_f32 v11, v11, v251
    v_mul_f32 v12, v12, v251
    v_mul_f32 v13, v13, v251
    v_mul_f32 v14, v14, v251
    v_mul_f32 v15, v15, v251
    v_mul_f32 v24, v24, v251
    v_mul_f32 v25, v25, v251
    v_mul_f32 v26, v26, v251
    v_mul_f32 v27, v27, v251
    v_mul_f32 v28, v28, v251
    v_mul_f32 v29, v29, v251
    v_mul_f32 v30, v30, v251
    v_mul_f32 v31, v31, v251
    v_mul_f32 v40, v40, v251
    v_mul_f32 v41, v41, v251
    v_mul_f32 v42, v42, v251
    v_mul_f32 v43, v43, v251
    v_mul_f32 v44, v44, v251
    v_mul_f32 v45, v45, v251
    v_mul_f32 v46, v46, v251
    v_mul_f32 v47, v47, v251
    v_mul_f32 v56, v56, v251
    v_mul_f32 v57, v57, v251
    v_mul_f32 v58, v58, v251
    v_mul_f32 v59, v59, v251
    v_mul_f32 v60, v60, v251
    v_mul_f32 v61, v61, v251
    v_mul_f32 v62, v62, v251
    v_mul_f32 v63, v63, v251
    v_add_f32 v104, v104, v255
    v_add_f32 v105, v105, v255
    v_add_f32 v106, v106, v255
    v_add_f32 v107, v107, v255
    v_add_f32 v108, v108, v255
    v_add_f32 v109, v109, v255
    v_add_f32 v110, v110, v255
    v_add_f32 v111, v111, v255
    v_add_f32 v120, v120, v255
    v_add_f32 v121, v121, v255
    v_add_f32 v122, v122, v255
    v_add_f32 v123, v123, v255
    v_add_f32 v124, v124, v255
    v_add_f32 v125, v125, v255
    v_add_f32 v126, v126, v255
    v_add_f32 v127, v127, v255
    v_add_f32 v64, v64, v241
    v_add_f32 v65, v65, v242
    v_exp_f32 v64, v64
    v_add_f32 v66, v66, v243
    v_exp_f32 v65, v65
    v_add_f32 v67, v67, v240
    v_exp_f32 v66, v66
    v_add_f32 v68, v68, v241
    v_exp_f32 v67, v67
    v_add_f32 v252, v64, v65
    v_cvt_pk_bf16_f32 v64, v64, v65
    v_add_f32 v69, v69, v242
    v_exp_f32 v68, v68
    v_add_f32 v70, v70, v243
    v_exp_f32 v69, v69
    v_add_f32 v253, v66, v67
    v_cvt_pk_bf16_f32 v65, v66, v67
    v_add_f32 v71, v71, v240
    v_exp_f32 v70, v70
    v_add_f32 v252, v252, v68
    v_add_f32 v72, v72, v245
    v_exp_f32 v71, v71
    v_add_f32 v252, v252, v69
    v_cvt_pk_bf16_f32 v66, v68, v69
    v_add_f32 v73, v73, v246
    v_exp_f32 v72, v72
    v_add_f32 v253, v253, v70
    v_add_f32 v74, v74, v247
    v_exp_f32 v73, v73
    v_add_f32 v253, v253, v71
    v_cvt_pk_bf16_f32 v67, v70, v71
    v_add_f32 v75, v75, v244
    v_exp_f32 v74, v74
    v_add_f32 v76, v76, v245
    v_exp_f32 v75, v75
    v_add_f32 v254, v72, v73
    v_cvt_pk_bf16_f32 v72, v72, v73
    v_add_f32 v77, v77, v246
    v_exp_f32 v76, v76
    v_add_f32 v78, v78, v247
    v_exp_f32 v77, v77
    v_add_f32 v255, v74, v75
    v_cvt_pk_bf16_f32 v73, v74, v75
    v_add_f32 v79, v79, v244
    v_exp_f32 v78, v78
    v_add_f32 v254, v254, v76
    v_add_f32 v80, v80, v241
    v_exp_f32 v79, v79
    v_add_f32 v254, v254, v77
    v_cvt_pk_bf16_f32 v74, v76, v77
    v_add_f32 v81, v81, v242
    v_exp_f32 v80, v80
    v_add_f32 v255, v255, v78
    v_add_f32 v82, v82, v243
    v_exp_f32 v81, v81
    v_add_f32 v255, v255, v79
    v_cvt_pk_bf16_f32 v75, v78, v79
    v_add_f32 v83, v83, v240
    v_exp_f32 v82, v82
    v_add_f32 v252, v252, v80
    v_add_f32 v84, v84, v241
    v_exp_f32 v83, v83
    v_add_f32 v252, v252, v81
    v_cvt_pk_bf16_f32 v80, v80, v81
    v_add_f32 v85, v85, v242
    v_exp_f32 v84, v84
    v_add_f32 v253, v253, v82
    v_add_f32 v86, v86, v243
    v_exp_f32 v85, v85
    v_add_f32 v253, v253, v83
    v_cvt_pk_bf16_f32 v81, v82, v83
    v_add_f32 v87, v87, v240
    v_exp_f32 v86, v86
    v_add_f32 v252, v252, v84
    v_add_f32 v88, v88, v245
    v_exp_f32 v87, v87
    v_add_f32 v252, v252, v85
    v_cvt_pk_bf16_f32 v82, v84, v85
    v_add_f32 v89, v89, v246
    v_exp_f32 v88, v88
    v_add_f32 v253, v253, v86
    v_add_f32 v90, v90, v247
    v_exp_f32 v89, v89
    v_add_f32 v253, v253, v87
    v_cvt_pk_bf16_f32 v83, v86, v87
    v_add_f32 v91, v91, v244
    v_exp_f32 v90, v90
    v_add_f32 v254, v254, v88
    v_add_f32 v92, v92, v245
    v_exp_f32 v91, v91
    v_add_f32 v254, v254, v89
    v_cvt_pk_bf16_f32 v88, v88, v89
    v_add_f32 v93, v93, v246
    v_exp_f32 v92, v92
    v_add_f32 v255, v255, v90
    v_add_f32 v94, v94, v247
    v_exp_f32 v93, v93
    v_add_f32 v255, v255, v91
    v_cvt_pk_bf16_f32 v89, v90, v91
    v_add_f32 v95, v95, v244
    v_exp_f32 v94, v94
    v_add_f32 v254, v254, v92
    v_exp_f32 v95, v95
    v_add_f32 v254, v254, v93
    v_cvt_pk_bf16_f32 v90, v92, v93
    v_add_f32 v255, v255, v94
    v_add_f32 v255, v255, v95
    v_cvt_pk_bf16_f32 v91, v94, v95
    v_add_f32 v252, v252, v253
    v_add_f32 v254, v254, v255
    s_nop 3
    s_branch L_back_1_4
L_slow_1_5:
    s_nop 15
    v_add_u32 v239, s44, v224
    v_subrev_u32 v239, s42, v239
    ds_read_b128 v[252:255], v239 offset:16384
    s_waitcnt lgkmcnt(0)
    v_mfma_f32_16x16x32_bf16 v[96:99], v[252:255], v[160:163], 0
    v_mfma_f32_16x16x32_bf16 v[104:107], v[252:255], v[176:179], 0
    s_nop 3
    v_add_u32 v239, s44, v225
    v_subrev_u32 v239, s42, v239
    ds_read_b128 v[252:255], v239 offset:16384
    s_waitcnt lgkmcnt(0)
    v_mfma_f32_16x16x32_bf16 v[96:99], v[252:255], v[164:167], v[96:99]
    v_mfma_f32_16x16x32_bf16 v[104:107], v[252:255], v[180:183], v[104:107]
    s_nop 3
    v_add_u32 v239, s44, v226
    v_subrev_u32 v239, s42, v239
    ds_read_b128 v[252:255], v239 offset:16384
    s_waitcnt lgkmcnt(0)
    v_mfma_f32_16x16x32_bf16 v[96:99], v[252:255], v[168:171], v[96:99]
    v_mfma_f32_16x16x32_bf16 v[104:107], v[252:255], v[184:187], v[104:107]
    s_nop 3
    v_add_u32 v239, s44, v227
    v_subrev_u32 v239, s42, v239
    ds_read_b128 v[252:255], v239 offset:16384
    s_waitcnt lgkmcnt(0)
    v_mfma_f32_16x16x32_bf16 v[96:99], v[252:255], v[172:175], v[96:99]
    v_mfma_f32_16x16x32_bf16 v[104:107], v[252:255], v[188:191], v[104:107]
    s_nop 3
    v_add_u32 v239, s44, v224
    v_subrev_u32 v239, s42, v239
    ds_read_b128 v[252:255], v239 offset:20480
    s_waitcnt lgkmcnt(0)
    v_mfma_f32_16x16x32_bf16 v[100:103], v[252:255], v[160:163], 0
    v_mfma_f32_16x16x32_bf16 v[108:111], v[252:255], v[176:179], 0
    s_nop 3
    v_add_u32 v239, s44, v225
    v_subrev_u32 v239, s42, v239
    ds_read_b128 v[252:255], v239 offset:20480
    s_waitcnt lgkmcnt(0)
    v_mfma_f32_16x16x32_bf16 v[100:103], v[252:255], v[164:167], v[100:103]
    v_mfma_f32_16x16x32_bf16 v[108:111], v[252:255], v[180:183], v[108:111]
    s_nop 3
    v_add_u32 v239, s44, v226
    v_subrev_u32 v239, s42, v239
    ds_read_b128 v[252:255], v239 offset:20480
    s_waitcnt lgkmcnt(0)
    v_mfma_f32_16x16x32_bf16 v[100:103], v[252:255], v[168:171], v[100:103]
    v_mfma_f32_16x16x32_bf16 v[108:111], v[252:255], v[184:187], v[108:111]
    s_nop 3
    v_add_u32 v239, s44, v227
    v_subrev_u32 v239, s42, v239
    ds_read_b128 v[252:255], v239 offset:20480
    s_waitcnt lgkmcnt(0)
    v_mfma_f32_16x16x32_bf16 v[100:103], v[252:255], v[172:175], v[100:103]
    v_mfma_f32_16x16x32_bf16 v[108:111], v[252:255], v[188:191], v[108:111]
    s_nop 3
    v_add_u32 v239, s44, v224
    v_subrev_u32 v239, s42, v239
    ds_read_b128 v[252:255], v239 offset:24576
    s_waitcnt lgkmcnt(0)
    v_mfma_f32_16x16x32_bf16 v[112:115], v[252:255], v[160:163], 0
    v_mfma_f32_16x16x32_bf16 v[120:123], v[252:255], v[176:179], 0
    s_nop 3
    v_add_u32 v239, s44, v225
    v_subrev_u32 v239, s42, v239
    ds_read_b128 v[252:255], v239 offset:24576
    s_waitcnt lgkmcnt(0)
    v_mfma_f32_16x16x32_bf16 v[112:115], v[252:255], v[164:167], v[112:115]
    v_mfma_f32_16x16x32_bf16 v[120:123], v[252:255], v[180:183], v[120:123]
    s_nop 3
    v_add_u32 v239, s44, v226
    v_subrev_u32 v239, s42, v239
    ds_read_b128 v[252:255], v239 offset:24576
    s_waitcnt lgkmcnt(0)
    v_mfma_f32_16x16x32_bf16 v[112:115], v[252:255], v[168:171], v[112:115]
    v_mfma_f32_16x16x32_bf16 v[120:123], v[252:255], v[184:187], v[120:123]
    s_nop 3
    v_add_u32 v239, s44, v227
    v_subrev_u32 v239, s42, v239
    ds_read_b128 v[252:255], v239 offset:24576
    s_waitcnt lgkmcnt(0)
    v_mfma_f32_16x16x32_bf16 v[112:115], v[252:255], v[172:175], v[112:115]
    v_mfma_f32_16x16x32_bf16 v[120:123], v[252:255], v[188:191], v[120:123]
    s_nop 3
    v_add_u32 v239, s44, v224
    v_subrev_u32 v239, s42, v239
    ds_read_b128 v[252:255], v239 offset:28672
    s_waitcnt lgkmcnt(0)
    v_mfma_f32_16x16x32_bf16 v[116:119], v[252:255], v[160:163], 0
    v_mfma_f32_16x16x32_bf16 v[124:127], v[252:255], v[176:179], 0
    s_nop 3
    v_add_u32 v239, s44, v225
    v_subrev_u32 v239, s42, v239
    ds_read_b128 v[252:255], v239 offset:28672
    s_waitcnt lgkmcnt(0)
    v_mfma_f32_16x16x32_bf16 v[116:119], v[252:255], v[164:167], v[116:119]
    v_mfma_f32_16x16x32_bf16 v[124:127], v[252:255], v[180:183], v[124:127]
    s_nop 3
    v_add_u32 v239, s44, v226
    v_subrev_u32 v239, s42, v239
    ds_read_b128 v[252:255], v239 offset:28672
    s_waitcnt lgkmcnt(0)
    v_mfma_f32_16x16x32_bf16 v[116:119], v[252:255], v[168:171], v[116:119]
    v_mfma_f32_16x16x32_bf16 v[124:127], v[252:255], v[184:187], v[124:127]
    s_nop 3
    v_add_u32 v239, s44, v227
    v_subrev_u32 v239, s42, v239
    ds_read_b128 v[252:255], v239 offset:28672
    s_waitcnt lgkmcnt(0)
    v_mfma_f32_16x16x32_bf16 v[116:119], v[252:255], v[172:175], v[116:119]
    v_mfma_f32_16x16x32_bf16 v[124:127], v[252:255], v[188:191], v[124:127]
    s_nop 3
    s_nop 15
    v_max3_f32 v252, v96, v97, v98
    v_max3_f32 v254, v104, v105, v106
    v_max3_f32 v252, v252, v99, v100
    v_max3_f32 v254, v254, v107, v108
    v_max3_f32 v252, v252, v101, v102
    v_max3_f32 v254, v254, v109, v110
    v_max3_f32 v252, v252, v103, v112
    v_max3_f32 v254, v254, v111, v120
    v_max3_f32 v252, v252, v113, v114
    v_max3_f32 v254, v254, v121, v122
    v_max3_f32 v252, v252, v115, v116
    v_max3_f32 v254, v254, v123, v124
    v_max3_f32 v252, v252, v117, v118
    v_max3_f32 v254, v254, v125, v126
    v_max_f32 v252, v252, v119
    v_max_f32 v254, v254, v127
    v_mov_b32 v253, v252
    v_mov_b32 v255, v254
    s_nop 0
    v_permlane16_swap_b32 v252, v253
    v_permlane16_swap_b32 v254, v255
    v_max_f32 v252, v252, v253
    v_max_f32 v254, v254, v255
    v_mov_b32 v253, v252
    v_mov_b32 v255, v254
    s_nop 0
    v_permlane32_swap_b32 v252, v253
    v_permlane32_swap_b32 v254, v255
    v_max_f32 v252, v252, v253
    v_max_f32 v254, v254, v255
    v_sub_f32 v252, 0, v252
    v_min_f32 v252, v252, v240
    v_sub_f32 v253, v252, v240
    v_exp_f32 v250, v253
    v_mov_b32 v240, v252
    v_mov_b32 v241, v252
    v_mov_b32 v242, v252
    v_mov_b32 v243, v252
    v_mul_f32 v248, v248, v250
    v_mul_f32 v0, v0, v250
    v_mul_f32 v1, v1, v250
    v_mul_f32 v2, v2, v250
    v_mul_f32 v3, v3, v250
    v_mul_f32 v4, v4, v250
    v_mul_f32 v5, v5, v250
    v_mul_f32 v6, v6, v250
    v_mul_f32 v7, v7, v250
    v_mul_f32 v16, v16, v250
    v_mul_f32 v17, v17, v250
    v_mul_f32 v18, v18, v250
    v_mul_f32 v19, v19, v250
    v_mul_f32 v20, v20, v250
    v_mul_f32 v21, v21, v250
    v_mul_f32 v22, v22, v250
    v_mul_f32 v23, v23, v250
    v_mul_f32 v32, v32, v250
    v_mul_f32 v33, v33, v250
    v_mul_f32 v34, v34, v250
    v_mul_f32 v35, v35, v250
    v_mul_f32 v36, v36, v250
    v_mul_f32 v37, v37, v250
    v_mul_f32 v38, v38, v250
    v_mul_f32 v39, v39, v250
    v_mul_f32 v48, v48, v250
    v_mul_f32 v49, v49, v250
    v_mul_f32 v50, v50, v250
    v_mul_f32 v51, v51, v250
    v_mul_f32 v52, v52, v250
    v_mul_f32 v53, v53, v250
    v_mul_f32 v54, v54, v250
    v_mul_f32 v55, v55, v250
    v_sub_f32 v254, 0, v254
    v_min_f32 v254, v254, v244
    v_sub_f32 v255, v254, v244
    v_exp_f32 v251, v255
    v_mov_b32 v244, v254
    v_mov_b32 v245, v254
    v_mov_b32 v246, v254
    v_mov_b32 v247, v254
    v_mul_f32 v249, v249, v251
    v_mul_f32 v8, v8, v251
    v_mul_f32 v9, v9, v251
    v_mul_f32 v10, v10, v251
    v_mul_f32 v11, v11, v251
    v_mul_f32 v12, v12, v251
    v_mul_f32 v13, v13, v251
    v_mul_f32 v14, v14, v251
    v_mul_f32 v15, v15, v251
    v_mul_f32 v24, v24, v251
    v_mul_f32 v25, v25, v251
    v_mul_f32 v26, v26, v251
    v_mul_f32 v27, v27, v251
    v_mul_f32 v28, v28, v251
    v_mul_f32 v29, v29, v251
    v_mul_f32 v30, v30, v251
    v_mul_f32 v31, v31, v251
    v_mul_f32 v40, v40, v251
    v_mul_f32 v41, v41, v251
    v_mul_f32 v42, v42, v251
    v_mul_f32 v43, v43, v251
    v_mul_f32 v44, v44, v251
    v_mul_f32 v45, v45, v251
    v_mul_f32 v46, v46, v251
    v_mul_f32 v47, v47, v251
    v_mul_f32 v56, v56, v251
    v_mul_f32 v57, v57, v251
    v_mul_f32 v58, v58, v251
    v_mul_f32 v59, v59, v251
    v_mul_f32 v60, v60, v251
    v_mul_f32 v61, v61, v251
    v_mul_f32 v62, v62, v251
    v_mul_f32 v63, v63, v251
    v_add_f32 v96, v96, v241
    v_add_f32 v97, v97, v242
    v_exp_f32 v96, v96
    v_add_f32 v98, v98, v243
    v_exp_f32 v97, v97
    v_add_f32 v99, v99, v240
    v_exp_f32 v98, v98
    v_add_f32 v100, v100, v241
    v_exp_f32 v99, v99
    v_add_f32 v252, v96, v97
    v_cvt_pk_bf16_f32 v96, v96, v97
    v_add_f32 v101, v101, v242
    v_exp_f32 v100, v100
    v_add_f32 v102, v102, v243
    v_exp_f32 v101, v101
    v_add_f32 v253, v98, v99
    v_cvt_pk_bf16_f32 v97, v98, v99
    v_add_f32 v103, v103, v240
    v_exp_f32 v102, v102
    v_add_f32 v252, v252, v100
    v_add_f32 v104, v104, v245
    v_exp_f32 v103, v103
    v_add_f32 v252, v252, v101
    v_cvt_pk_bf16_f32 v98, v100, v101
    v_add_f32 v105, v105, v246
    v_exp_f32 v104, v104
    v_add_f32 v253, v253, v102
    v_add_f32 v106, v106, v247
    v_exp_f32 v105, v105
    v_add_f32 v253, v253, v103
    v_cvt_pk_bf16_f32 v99, v102, v103
    v_add_f32 v107, v107, v244
    v_exp_f32 v106, v106
    v_add_f32 v108, v108, v245
    v_exp_f32 v107, v107
    v_add_f32 v254, v104, v105
    v_cvt_pk_bf16_f32 v104, v104, v105
    v_add_f32 v109, v109, v246
    v_exp_f32 v108, v108
    v_add_f32 v110, v110, v247
    v_exp_f32 v109, v109
    v_add_f32 v255, v106, v107
    v_cvt_pk_bf16_f32 v105, v106, v107
    v_add_f32 v111, v111, v244
    v_exp_f32 v110, v110
    v_add_f32 v254, v254, v108
    v_add_f32 v112, v112, v241
    v_exp_f32 v111, v111
    v_add_f32 v254, v254, v109
    v_cvt_pk_bf16_f32 v106, v108, v109
    v_add_f32 v113, v113, v242
    v_exp_f32 v112, v112
    v_add_f32 v255, v255, v110
    v_add_f32 v114, v114, v243
    v_exp_f32 v113, v113
    v_add_f32 v255, v255, v111
    v_cvt_pk_bf16_f32 v107, v110, v111
    v_add_f32 v115, v115, v240
    v_exp_f32 v114, v114
    v_add_f32 v252, v252, v112
    v_add_f32 v116, v116, v241
    v_exp_f32 v115, v115
    v_add_f32 v252, v252, v113
    v_cvt_pk_bf16_f32 v112, v112, v113
    v_add_f32 v117, v117, v242
    v_exp_f32 v116, v116
    v_add_f32 v253, v253, v114
    v_add_f32 v118, v118, v243
    v_exp_f32 v117, v117
    v_add_f32 v253, v253, v115
    v_cvt_pk_bf16_f32 v113, v114, v115
    v_add_f32 v119, v119, v240
    v_exp_f32 v118, v118
    v_add_f32 v252, v252, v116
    v_add_f32 v120, v120, v245
    v_exp_f32 v119, v119
    v_add_f32 v252, v252, v117
    v_cvt_pk_bf16_f32 v114, v116, v117
    v_add_f32 v121, v121, v246
    v_exp_f32 v120, v120
    v_add_f32 v253, v253, v118
    v_add_f32 v122, v122, v247
    v_exp_f32 v121, v121
    v_add_f32 v253, v253, v119
    v_cvt_pk_bf16_f32 v115, v118, v119
    v_add_f32 v123, v123, v244
    v_exp_f32 v122, v122
    v_add_f32 v254, v254, v120
    v_add_f32 v124, v124, v245
    v_exp_f32 v123, v123
    v_add_f32 v254, v254, v121
    v_cvt_pk_bf16_f32 v120, v120, v121
    v_add_f32 v125, v125, v246
    v_exp_f32 v124, v124
    v_add_f32 v255, v255, v122
    v_add_f32 v126, v126, v247
    v_exp_f32 v125, v125
    v_add_f32 v255, v255, v123
    v_cvt_pk_bf16_f32 v121, v122, v123
    v_add_f32 v127, v127, v244
    v_exp_f32 v126, v126
    v_add_f32 v254, v254, v124
    v_exp_f32 v127, v127
    v_add_f32 v254, v254, v125
    v_cvt_pk_bf16_f32 v122, v124, v125
    v_add_f32 v255, v255, v126
    v_add_f32 v255, v255, v127
    v_cvt_pk_bf16_f32 v123, v126, v127
    v_add_f32 v252, v252, v253
    v_add_f32 v254, v254, v255
    s_nop 3
    s_branch L_back_1_5
L_slow_2_1:
    s_nop 15
    v_add_u32 v239, s42, v224
    v_subrev_u32 v239, s43, v239
    ds_read_b128 v[252:255], v239 offset:16384
    s_waitcnt lgkmcnt(0)
    v_mfma_f32_16x16x32_bf16 v[96:99], v[252:255], v[128:131], 0
    v_mfma_f32_16x16x32_bf16 v[104:107], v[252:255], v[144:147], 0
    s_nop 3
    v_add_u32 v239, s42, v225
    v_subrev_u32 v239, s43, v239
    ds_read_b128 v[252:255], v239 offset:16384
    s_waitcnt lgkmcnt(0)
    v_mfma_f32_16x16x32_bf16 v[96:99], v[252:255], v[132:135], v[96:99]
    v_mfma_f32_16x16x32_bf16 v[104:107], v[252:255], v[148:151], v[104:107]
    s_nop 3
    v_add_u32 v239, s42, v226
    v_subrev_u32 v239, s43, v239
    ds_read_b128 v[252:255], v239 offset:16384
    s_waitcnt lgkmcnt(0)
    v_mfma_f32_16x16x32_bf16 v[96:99], v[252:255], v[136:139], v[96:99]
    v_mfma_f32_16x16x32_bf16 v[104:107], v[252:255], v[152:155], v[104:107]
    s_nop 3
    v_add_u32 v239, s42, v227
    v_subrev_u32 v239, s43, v239
    ds_read_b128 v[252:255], v239 offset:16384
    s_waitcnt lgkmcnt(0)
    v_mfma_f32_16x16x32_bf16 v[96:99], v[252:255], v[140:143], v[96:99]
    v_mfma_f32_16x16x32_bf16 v[104:107], v[252:255], v[156:159], v[104:107]
    s_nop 3
    v_add_u32 v239, s42, v224
    v_subrev_u32 v239, s43, v239
    ds_read_b128 v[252:255], v239 offset:20480
    s_waitcnt lgkmcnt(0)
    v_mfma_f32_16x16x32_bf16 v[100:103], v[252:255], v[128:131], 0
    v_mfma_f32_16x16x32_bf16 v[108:111], v[252:255], v[144:147], 0
    s_nop 3
    v_add_u32 v239, s42, v225
    v_subrev_u32 v239, s43, v239
    ds_read_b128 v[252:255], v239 offset:20480
    s_waitcnt lgkmcnt(0)
    v_mfma_f32_16x16x32_bf16 v[100:103], v[252:255], v[132:135], v[100:103]
    v_mfma_f32_16x16x32_bf16 v[108:111], v[252:255], v[148:151], v[108:111]
    s_nop 3
    v_add_u32 v239, s42, v226
    v_subrev_u32 v239, s43, v239
    ds_read_b128 v[252:255], v239 offset:20480
    s_waitcnt lgkmcnt(0)
    v_mfma_f32_16x16x32_bf16 v[100:103], v[252:255], v[136:139], v[100:103]
    v_mfma_f32_16x16x32_bf16 v[108:111], v[252:255], v[152:155], v[108:111]
    s_nop 3
    v_add_u32 v239, s42, v227
    v_subrev_u32 v239, s43, v239
    ds_read_b128 v[252:255], v239 offset:20480
    s_waitcnt lgkmcnt(0)
    v_mfma_f32_16x16x32_bf16 v[100:103], v[252:255], v[140:143], v[100:103]
    v_mfma_f32_16x16x32_bf16 v[108:111], v[252:255], v[156:159], v[108:111]
    s_nop 3
    v_add_u32 v239, s42, v224
    v_subrev_u32 v239, s43, v239
    ds_read_b128 v[252:255], v239 offset:24576
    s_waitcnt lgkmcnt(0)
    v_mfma_f32_16x16x32_bf16 v[112:115], v[252:255], v[128:131], 0
    v_mfma_f32_16x16x32_bf16 v[120:123], v[252:255], v[144:147], 0
    s_nop 3
    v_add_u32 v239, s42, v225
    v_subrev_u32 v239, s43, v239
    ds_read_b128 v[252:255], v239 offset:24576
    s_waitcnt lgkmcnt(0)
    v_mfma_f32_16x16x32_bf16 v[112:115], v[252:255], v[132:135], v[112:115]
    v_mfma_f32_16x16x32_bf16 v[120:123], v[252:255], v[148:151], v[120:123]
    s_nop 3
    v_add_u32 v239, s42, v226
    v_subrev_u32 v239, s43, v239
    ds_read_b128 v[252:255], v239 offset:24576
    s_waitcnt lgkmcnt(0)
    v_mfma_f32_16x16x32_bf16 v[112:115], v[252:255], v[136:139], v[112:115]
    v_mfma_f32_16x16x32_bf16 v[120:123], v[252:255], v[152:155], v[120:123]
    s_nop 3
    v_add_u32 v239, s42, v227
    v_subrev_u32 v239, s43, v239
    ds_read_b128 v[252:255], v239 offset:24576
    s_waitcnt lgkmcnt(0)
    v_mfma_f32_16x16x32_bf16 v[112:115], v[252:255], v[140:143], v[112:115]
    v_mfma_f32_16x16x32_bf16 v[120:123], v[252:255], v[156:159], v[120:123]
    s_nop 3
    v_add_u32 v239, s42, v224
    v_subrev_u32 v239, s43, v239
    ds_read_b128 v[252:255], v239 offset:28672
    s_waitcnt lgkmcnt(0)
    v_mfma_f32_16x16x32_bf16 v[116:119], v[252:255], v[128:131], 0
    v_mfma_f32_16x16x32_bf16 v[124:127], v[252:255], v[144:147], 0
    s_nop 3
    v_add_u32 v239, s42, v225
    v_subrev_u32 v239, s43, v239
    ds_read_b128 v[252:255], v239 offset:28672
    s_waitcnt lgkmcnt(0)
    v_mfma_f32_16x16x32_bf16 v[116:119], v[252:255], v[132:135], v[116:119]
    v_mfma_f32_16x16x32_bf16 v[124:127], v[252:255], v[148:151], v[124:127]
    s_nop 3
    v_add_u32 v239, s42, v226
    v_subrev_u32 v239, s43, v239
    ds_read_b128 v[252:255], v239 offset:28672
    s_waitcnt lgkmcnt(0)
    v_mfma_f32_16x16x32_bf16 v[116:119], v[252:255], v[136:139], v[116:119]
    v_mfma_f32_16x16x32_bf16 v[124:127], v[252:255], v[152:155], v[124:127]
    s_nop 3
    v_add_u32 v239, s42, v227
    v_subrev_u32 v239, s43, v239
    ds_read_b128 v[252:255], v239 offset:28672
    s_waitcnt lgkmcnt(0)
    v_mfma_f32_16x16x32_bf16 v[116:119], v[252:255], v[140:143], v[116:119]
    v_mfma_f32_16x16x32_bf16 v[124:127], v[252:255], v[156:159], v[124:127]
    s_nop 3
    s_nop 15
    v_max3_f32 v252, v96, v97, v98
    v_max3_f32 v254, v104, v105, v106
    v_max3_f32 v252, v252, v99, v100
    v_max3_f32 v254, v254, v107, v108
    v_max3_f32 v252, v252, v101, v102
    v_max3_f32 v254, v254, v109, v110
    v_max3_f32 v252, v252, v103, v112
    v_max3_f32 v254, v254, v111, v120
    v_max3_f32 v252, v252, v113, v114
    v_max3_f32 v254, v254, v121, v122
    v_max3_f32 v252, v252, v115, v116
    v_max3_f32 v254, v254, v123, v124
    v_max3_f32 v252, v252, v117, v118
    v_max3_f32 v254, v254, v125, v126
    v_max_f32 v252, v252, v119
    v_max_f32 v254, v254, v127
    v_mov_b32 v253, v252
    v_mov_b32 v255, v254
    s_nop 0
    v_permlane16_swap_b32 v252, v253
    v_permlane16_swap_b32 v254, v255
    v_max_f32 v252, v252, v253
    v_max_f32 v254, v254, v255
    v_mov_b32 v253, v252
    v_mov_b32 v255, v254
    s_nop 0
    v_permlane32_swap_b32 v252, v253
    v_permlane32_swap_b32 v254, v255
    v_max_f32 v252, v252, v253
    v_max_f32 v254, v254, v255
    v_sub_f32 v252, 0, v252
    v_min_f32 v252, v252, v240
    v_sub_f32 v253, v252, v240
    v_exp_f32 v250, v253
    v_mov_b32 v240, v252
    v_mov_b32 v241, v252
    v_mov_b32 v242, v252
    v_mov_b32 v243, v252
    v_mul_f32 v248, v248, v250
    v_mul_f32 v0, v0, v250
    v_mul_f32 v1, v1, v250
    v_mul_f32 v2, v2, v250
    v_mul_f32 v3, v3, v250
    v_mul_f32 v4, v4, v250
    v_mul_f32 v5, v5, v250
    v_mul_f32 v6, v6, v250
    v_mul_f32 v7, v7, v250
    v_mul_f32 v16, v16, v250
    v_mul_f32 v17, v17, v250
    v_mul_f32 v18, v18, v250
    v_mul_f32 v19, v19, v250
    v_mul_f32 v20, v20, v250
    v_mul_f32 v21, v21, v250
    v_mul_f32 v22, v22, v250
    v_mul_f32 v23, v23, v250
    v_mul_f32 v32, v32, v250
    v_mul_f32 v33, v33, v250
    v_mul_f32 v34, v34, v250
    v_mul_f32 v35, v35, v250
    v_mul_f32 v36, v36, v250
    v_mul_f32 v37, v37, v250
    v_mul_f32 v38, v38, v250
    v_mul_f32 v39, v39, v250
    v_mul_f32 v48, v48, v250
    v_mul_f32 v49, v49, v250
    v_mul_f32 v50, v50, v250
    v_mul_f32 v51, v51, v250
    v_mul_f32 v52, v52, v250
    v_mul_f32 v53, v53, v250
    v_mul_f32 v54, v54, v250
    v_mul_f32 v55, v55, v250
    v_add_f32 v64, v64, v253
    v_add_f32 v65, v65, v253
    v_add_f32 v66, v66, v253
    v_add_f32 v67, v67, v253
    v_add_f32 v68, v68, v253
    v_add_f32 v69, v69, v253
    v_add_f32 v70, v70, v253
    v_add_f32 v71, v71, v253
    v_add_f32 v80, v80, v253
    v_add_f32 v81, v81, v253
    v_add_f32 v82, v82, v253
    v_add_f32 v83, v83, v253
    v_add_f32 v84, v84, v253
    v_add_f32 v85, v85, v253
    v_add_f32 v86, v86, v253
    v_add_f32 v87, v87, v253
    v_sub_f32 v254, 0, v254
    v_min_f32 v254, v254, v244
    v_sub_f32 v255, v254, v244
    v_exp_f32 v251, v255
    v_mov_b32 v244, v254
    v_mov_b32 v245, v254
    v_mov_b32 v246, v254
    v_mov_b32 v247, v254
    v_mul_f32 v249, v249, v251
    v_mul_f32 v8, v8, v251
    v_mul_f32 v9, v9, v251
    v_mul_f32 v10, v10, v251
    v_mul_f32 v11, v11, v251
    v_mul_f32 v12, v12, v251
    v_mul_f32 v13, v13, v251
    v_mul_f32 v14, v14, v251
    v_mul_f32 v15, v15, v251
    v_mul_f32 v24, v24, v251
    v_mul_f32 v25, v25, v251
    v_mul_f32 v26, v26, v251
    v_mul_f32 v27, v27, v251
    v_mul_f32 v28, v28, v251
    v_mul_f32 v29, v29, v251
    v_mul_f32 v30, v30, v251
    v_mul_f32 v31, v31, v251
    v_mul_f32 v40, v40, v251
    v_mul_f32 v41, v41, v251
    v_mul_f32 v42, v42, v251
    v_mul_f32 v43, v43, v251
    v_mul_f32 v44, v44, v251
    v_mul_f32 v45, v45, v251
    v_mul_f32 v46, v46, v251
    v_mul_f32 v47, v47, v251
    v_mul_f32 v56, v56, v251
    v_mul_f32 v57, v57, v251
    v_mul_f32 v58, v58, v251
    v_mul_f32 v59, v59, v251
    v_mul_f32 v60, v60, v251
    v_mul_f32 v61, v61, v251
    v_mul_f32 v62, v62, v251
    v_mul_f32 v63, v63, v251
    v_add_f32 v72, v72, v255
    v_add_f32 v73, v73, v255
    v_add_f32 v74, v74, v255
    v_add_f32 v75, v75, v255
    v_add_f32 v76, v76, v255
    v_add_f32 v77, v77, v255
    v_add_f32 v78, v78, v255
    v_add_f32 v79, v79, v255
    v_add_f32 v88, v88, v255
    v_add_f32 v89, v89, v255
    v_add_f32 v90, v90, v255
    v_add_f32 v91, v91, v255
    v_add_f32 v92, v92, v255
    v_add_f32 v93, v93, v255
    v_add_f32 v94, v94, v255
    v_add_f32 v95, v95, v255
    v_add_f32 v96, v96, v241
    v_add_f32 v97, v97, v242
    v_exp_f32 v96, v96
    v_add_f32 v98, v98, v243
    v_exp_f32 v97, v97
    v_add_f32 v99, v99, v240
    v_exp_f32 v98, v98
    v_add_f32 v100, v100, v241
    v_exp_f32 v99, v99
    v_add_f32 v252, v96, v97
    v_cvt_pk_bf16_f32 v96, v96, v97
    v_add_f32 v101, v101, v242
    v_exp_f32 v100, v100
    v_add_f32 v102, v102, v243
    v_exp_f32 v101, v101
    v_add_f32 v253, v98, v99
    v_cvt_pk_bf16_f32 v97, v98, v99
    v_add_f32 v103, v103, v240
    v_exp_f32 v102, v102
    v_add_f32 v252, v252, v100
    v_add_f32 v104, v104, v245
    v_exp_f32 v103, v103
    v_add_f32 v252, v252, v101
    v_cvt_pk_bf16_f32 v98, v100, v101
    v_add_f32 v105, v105, v246
    v_exp_f32 v104, v104
    v_add_f32 v253, v253, v102
    v_add_f32 v106, v106, v247
    v_exp_f32 v105, v105
    v_add_f32 v253, v253, v103
    v_cvt_pk_bf16_f32 v99, v102, v103
    v_add_f32 v107, v107, v244
    v_exp_f32 v106, v106
    v_add_f32 v108, v108, v245
    v_exp_f32 v107, v107
    v_add_f32 v254, v104, v105
    v_cvt_pk_bf16_f32 v104, v104, v105
    v_add_f32 v109, v109, v246
    v_exp_f32 v108, v108
    v_add_f32 v110, v110, v247
    v_exp_f32 v109, v109
    v_add_f32 v255, v106, v107
    v_cvt_pk_bf16_f32 v105, v106, v107
    v_add_f32 v111, v111, v244
    v_exp_f32 v110, v110
    v_add_f32 v254, v254, v108
    v_add_f32 v112, v112, v241
    v_exp_f32 v111, v111
    v_add_f32 v254, v254, v109
    v_cvt_pk_bf16_f32 v106, v108, v109
    v_add_f32 v113, v113, v242
    v_exp_f32 v112, v112
    v_add_f32 v255, v255, v110
    v_add_f32 v114, v114, v243
    v_exp_f32 v113, v113
    v_add_f32 v255, v255, v111
    v_cvt_pk_bf16_f32 v107, v110, v111
    v_add_f32 v115, v115, v240
    v_exp_f32 v114, v114
    v_add_f32 v252, v252, v112
    v_add_f32 v116, v116, v241
    v_exp_f32 v115, v115
    v_add_f32 v252, v252, v113
    v_cvt_pk_bf16_f32 v112, v112, v113
    v_add_f32 v117, v117, v242
    v_exp_f32 v116, v116
    v_add_f32 v253, v253, v114
    v_add_f32 v118, v118, v243
    v_exp_f32 v117, v117
    v_add_f32 v253, v253, v115
    v_cvt_pk_bf16_f32 v113, v114, v115
    v_add_f32 v119, v119, v240
    v_exp_f32 v118, v118
    v_add_f32 v252, v252, v116
    v_add_f32 v120, v120, v245
    v_exp_f32 v119, v119
    v_add_f32 v252, v252, v117
    v_cvt_pk_bf16_f32 v114, v116, v117
    v_add_f32 v121, v121, v246
    v_exp_f32 v120, v120
    v_add_f32 v253, v253, v118
    v_add_f32 v122, v122, v247
    v_exp_f32 v121, v121
    v_add_f32 v253, v253, v119
    v_cvt_pk_bf16_f32 v115, v118, v119
    v_add_f32 v123, v123, v244
    v_exp_f32 v122, v122
    v_add_f32 v254, v254, v120
    v_add_f32 v124, v124, v245
    v_exp_f32 v123, v123
    v_add_f32 v254, v254, v121
    v_cvt_pk_bf16_f32 v120, v120, v121
    v_add_f32 v125, v125, v246
    v_exp_f32 v124, v124
    v_add_f32 v255, v255, v122
    v_add_f32 v126, v126, v247
    v_exp_f32 v125, v125
    v_add_f32 v255, v255, v123
    v_cvt_pk_bf16_f32 v121, v122, v123
    v_add_f32 v127, v127, v244
    v_exp_f32 v126, v126
    v_add_f32 v254, v254, v124
    v_exp_f32 v127, v127
    v_add_f32 v254, v254, v125
    v_cvt_pk_bf16_f32 v122, v124, v125
    v_add_f32 v255, v255, v126
    v_add_f32 v255, v255, v127
    v_cvt_pk_bf16_f32 v123, v126, v127
    v_add_f32 v252, v252, v253
    v_add_f32 v254, v254, v255
    s_nop 3
    s_branch L_back_2_1
L_slow_2_2:
    s_nop 15
    v_add_u32 v239, s43, v224
    v_subrev_u32 v239, s43, v239
    ds_read_b128 v[252:255], v239 offset:0
    s_waitcnt lgkmcnt(0)
    v_mfma_f32_16x16x32_bf16 v[64:67], v[252:255], v[128:131], 0
    v_mfma_f32_16x16x32_bf16 v[72:75], v[252:255], v[144:147], 0
    s_nop 3
    v_add_u32 v239, s43, v225
    v_subrev_u32 v239, s43, v239
    ds_read_b128 v[252:255], v239 offset:0
    s_waitcnt lgkmcnt(0)
    v_mfma_f32_16x16x32_bf16 v[64:67], v[252:255], v[132:135], v[64:67]
    v_mfma_f32_16x16x32_bf16 v[72:75], v[252:255], v[148:151], v[72:75]
    s_nop 3
    v_add_u32 v239, s43, v226
    v_subrev_u32 v239, s43, v239
    ds_read_b128 v[252:255], v239 offset:0
    s_waitcnt lgkmcnt(0)
    v_mfma_f32_16x16x32_bf16 v[64:67], v[252:255], v[136:139], v[64:67]
    v_mfma_f32_16x16x32_bf16 v[72:75], v[252:255], v[152:155], v[72:75]
    s_nop 3
    v_add_u32 v239, s43, v227
    v_subrev_u32 v239, s43, v239
    ds_read_b128 v[252:255], v239 offset:0
    s_waitcnt lgkmcnt(0)
    v_mfma_f32_16x16x32_bf16 v[64:67], v[252:255], v[140:143], v[64:67]
    v_mfma_f32_16x16x32_bf16 v[72:75], v[252:255], v[156:159], v[72:75]
    s_nop 3
    v_add_u32 v239, s43, v224
    v_subrev_u32 v239, s43, v239
    ds_read_b128 v[252:255], v239 offset:4096
    s_waitcnt lgkmcnt(0)
    v_mfma_f32_16x16x32_bf16 v[68:71], v[252:255], v[128:131], 0
    v_mfma_f32_16x16x32_bf16 v[76:79], v[252:255], v[144:147], 0
    s_nop 3
    v_add_u32 v239, s43, v225
    v_subrev_u32 v239, s43, v239
    ds_read_b128 v[252:255], v239 offset:4096
    s_waitcnt lgkmcnt(0)
    v_mfma_f32_16x16x32_bf16 v[68:71], v[252:255], v[132:135], v[68:71]
    v_mfma_f32_16x16x32_bf16 v[76:79], v[252:255], v[148:151], v[76:79]
    s_nop 3
    v_add_u32 v239, s43, v226
    v_subrev_u32 v239, s43, v239
    ds_read_b128 v[252:255], v239 offset:4096
    s_waitcnt lgkmcnt(0)
    v_mfma_f32_16x16x32_bf16 v[68:71], v[252:255], v[136:139], v[68:71]
    v_mfma_f32_16x16x32_bf16 v[76:79], v[252:255], v[152:155], v[76:79]
    s_nop 3
    v_add_u32 v239, s43, v227
    v_subrev_u32 v239, s43, v239
    ds_read_b128 v[252:255], v239 offset:4096
    s_waitcnt lgkmcnt(0)
    v_mfma_f32_16x16x32_bf16 v[68:71], v[252:255], v[140:143], v[68:71]
    v_mfma_f32_16x16x32_bf16 v[76:79], v[252:255], v[156:159], v[76:79]
    s_nop 3
    v_add_u32 v239, s43, v224
    v_subrev_u32 v239, s43, v239
    ds_read_b128 v[252:255], v239 offset:8192
    s_waitcnt lgkmcnt(0)
    v_mfma_f32_16x16x32_bf16 v[80:83], v[252:255], v[128:131], 0
    v_mfma_f32_16x16x32_bf16 v[88:91], v[252:255], v[144:147], 0
    s_nop 3
    v_add_u32 v239, s43, v225
    v_subrev_u32 v239, s43, v239
    ds_read_b128 v[252:255], v239 offset:8192
    s_waitcnt lgkmcnt(0)
    v_mfma_f32_16x16x32_bf16 v[80:83], v[252:255], v[132:135], v[80:83]
    v_mfma_f32_16x16x32_bf16 v[88:91], v[252:255], v[148:151], v[88:91]
    s_nop 3
    v_add_u32 v239, s43, v226
    v_subrev_u32 v239, s43, v239
    ds_read_b128 v[252:255], v239 offset:8192
    s_waitcnt lgkmcnt(0)
    v_mfma_f32_16x16x32_bf16 v[80:83], v[252:255], v[136:139], v[80:83]
    v_mfma_f32_16x16x32_bf16 v[88:91], v[252:255], v[152:155], v[88:91]
    s_nop 3
    v_add_u32 v239, s43, v227
    v_subrev_u32 v239, s43, v239
    ds_read_b128 v[252:255], v239 offset:8192
    s_waitcnt lgkmcnt(0)
    v_mfma_f32_16x16x32_bf16 v[80:83], v[252:255], v[140:143], v[80:83]
    v_mfma_f32_16x16x32_bf16 v[88:91], v[252:255], v[156:159], v[88:91]
    s_nop 3
    v_add_u32 v239, s43, v224
    v_subrev_u32 v239, s43, v239
    ds_read_b128 v[252:255], v239 offset:12288
    s_waitcnt lgkmcnt(0)
    v_mfma_f32_16x16x32_bf16 v[84:87], v[252:255], v[128:131], 0
    v_mfma_f32_16x16x32_bf16 v[92:95], v[252:255], v[144:147], 0
    s_nop 3
    v_add_u32 v239, s43, v225
    v_subrev_u32 v239, s43, v239
    ds_read_b128 v[252:255], v239 offset:12288
    s_waitcnt lgkmcnt(0)
    v_mfma_f32_16x16x32_bf16 v[84:87], v[252:255], v[132:135], v[84:87]
    v_mfma_f32_16x16x32_bf16 v[92:95], v[252:255], v[148:151], v[92:95]
    s_nop 3
    v_add_u32 v239, s43, v226
    v_subrev_u32 v239, s43, v239
    ds_read_b128 v[252:255], v239 offset:12288
    s_waitcnt lgkmcnt(0)
    v_mfma_f32_16x16x32_bf16 v[84:87], v[252:255], v[136:139], v[84:87]
    v_mfma_f32_16x16x32_bf16 v[92:95], v[252:255], v[152:155], v[92:95]
    s_nop 3
    v_add_u32 v239, s43, v227
    v_subrev_u32 v239, s43, v239
    ds_read_b128 v[252:255], v239 offset:12288
    s_waitcnt lgkmcnt(0)
    v_mfma_f32_16x16x32_bf16 v[84:87], v[252:255], v[140:143], v[84:87]
    v_mfma_f32_16x16x32_bf16 v[92:95], v[252:255], v[156:159], v[92:95]
    s_nop 3
    s_nop 15
    v_max3_f32 v252, v64, v65, v66
    v_max3_f32 v254, v72, v73, v74
    v_max3_f32 v252, v252, v67, v68
    v_max3_f32 v254, v254, v75, v76
    v_max3_f32 v252, v252, v69, v70
    v_max3_f32 v254, v254, v77, v78
    v_max3_f32 v252, v252, v71, v80
    v_max3_f32 v254, v254, v79, v88
    v_max3_f32 v252, v252, v81, v82
    v_max3_f32 v254, v254, v89, v90
    v_max3_f32 v252, v252, v83, v84
    v_max3_f32 v254, v254, v91, v92
    v_max3_f32 v252, v252, v85, v86
    v_max3_f32 v254, v254, v93, v94
    v_max_f32 v252, v252, v87
    v_max_f32 v254, v254, v95
    v_mov_b32 v253, v252
    v_mov_b32 v255, v254
    s_nop 0
    v_permlane16_swap_b32 v252, v253
    v_permlane16_swap_b32 v254, v255
    v_max_f32 v252, v252, v253
    v_max_f32 v254, v254, v255
    v_mov_b32 v253, v252
    v_mov_b32 v255, v254
    s_nop 0
    v_permlane32_swap_b32 v252, v253
    v_permlane32_swap_b32 v254, v255
    v_max_f32 v252, v252, v253
    v_max_f32 v254, v254, v255
    v_sub_f32 v252, 0, v252
    v_min_f32 v252, v252, v240
    v_sub_f32 v253, v252, v240
    v_exp_f32 v250, v253
    v_mov_b32 v240, v252
    v_mov_b32 v241, v252
    v_mov_b32 v242, v252
    v_mov_b32 v243, v252
    v_mul_f32 v248, v248, v250
    v_mul_f32 v0, v0, v250
    v_mul_f32 v1, v1, v250
    v_mul_f32 v2, v2, v250
    v_mul_f32 v3, v3, v250
    v_mul_f32 v4, v4, v250
    v_mul_f32 v5, v5, v250
    v_mul_f32 v6, v6, v250
    v_mul_f32 v7, v7, v250
    v_mul_f32 v16, v16, v250
    v_mul_f32 v17, v17, v250
    v_mul_f32 v18, v18, v250
    v_mul_f32 v19, v19, v250
    v_mul_f32 v20, v20, v250
    v_mul_f32 v21, v21, v250
    v_mul_f32 v22, v22, v250
    v_mul_f32 v23, v23, v250
    v_mul_f32 v32, v32, v250
    v_mul_f32 v33, v33, v250
    v_mul_f32 v34, v34, v250
    v_mul_f32 v35, v35, v250
    v_mul_f32 v36, v36, v250
    v_mul_f32 v37, v37, v250
    v_mul_f32 v38, v38, v250
    v_mul_f32 v39, v39, v250
    v_mul_f32 v48, v48, v250
    v_mul_f32 v49, v49, v250
    v_mul_f32 v50, v50, v250
    v_mul_f32 v51, v51, v250
    v_mul_f32 v52, v52, v250
    v_mul_f32 v53, v53, v250
    v_mul_f32 v54, v54, v250
    v_mul_f32 v55, v55, v250
    v_add_f32 v96, v96, v253
    v_add_f32 v97, v97, v253
    v_add_f32 v98, v98, v253
    v_add_f32 v99, v99, v253
    v_add_f32 v100, v100, v253
    v_add_f32 v101, v101, v253
    v_add_f32 v102, v102, v253
    v_add_f32 v103, v103, v253
    v_add_f32 v112, v112, v253
    v_add_f32 v113, v113, v253
    v_add_f32 v114, v114, v253
    v_add_f32 v115, v115, v253
    v_add_f32 v116, v116, v253
    v_add_f32 v117, v117, v253
    v_add_f32 v118, v118, v253
    v_add_f32 v119, v119, v253
    v_sub_f32 v254, 0, v254
    v_min_f32 v254, v254, v244
    v_sub_f32 v255, v254, v244
    v_exp_f32 v251, v255
    v_mov_b32 v244, v254
    v_mov_b32 v245, v254
    v_mov_b32 v246, v254
    v_mov_b32 v247, v254
    v_mul_f32 v249, v249, v251
    v_mul_f32 v8, v8, v251
    v_mul_f32 v9, v9, v251
    v_mul_f32 v10, v10, v251
    v_mul_f32 v11, v11, v251
    v_mul_f32 v12, v12, v251
    v_mul_f32 v13, v13, v251
    v_mul_f32 v14, v14, v251
    v_mul_f32 v15, v15, v251
    v_mul_f32 v24, v24, v251
    v_mul_f32 v25, v25, v251
    v_mul_f32 v26, v26, v251
    v_mul_f32 v27, v27, v251
    v_mul_f32 v28, v28, v251
    v_mul_f32 v29, v29, v251
    v_mul_f32 v30, v30, v251
    v_mul_f32 v31, v31, v251
    v_mul_f32 v40, v40, v251
    v_mul_f32 v41, v41, v251
    v_mul_f32 v42, v42, v251
    v_mul_f32 v43, v43, v251
    v_mul_f32 v44, v44, v251
    v_mul_f32 v45, v45, v251
    v_mul_f32 v46, v46, v251
    v_mul_f32 v47, v47, v251
    v_mul_f32 v56, v56, v251
    v_mul_f32 v57, v57, v251
    v_mul_f32 v58, v58, v251
    v_mul_f32 v59, v59, v251
    v_mul_f32 v60, v60, v251
    v_mul_f32 v61, v61, v251
    v_mul_f32 v62, v62, v251
    v_mul_f32 v63, v63, v251
    v_add_f32 v104, v104, v255
    v_add_f32 v105, v105, v255
    v_add_f32 v106, v106, v255
    v_add_f32 v107, v107, v255
    v_add_f32 v108, v108, v255
    v_add_f32 v109, v109, v255
    v_add_f32 v110, v110, v255
    v_add_f32 v111, v111, v255
    v_add_f32 v120, v120, v255
    v_add_f32 v121, v121, v255
    v_add_f32 v122, v122, v255
    v_add_f32 v123, v123, v255
    v_add_f32 v124, v124, v255
    v_add_f32 v125, v125, v255
    v_add_f32 v126, v126, v255
    v_add_f32 v127, v127, v255
    v_add_f32 v64, v64, v241
    v_add_f32 v65, v65, v242
    v_exp_f32 v64, v64
    v_add_f32 v66, v66, v243
    v_exp_f32 v65, v65
    v_add_f32 v67, v67, v240
    v_exp_f32 v66, v66
    v_add_f32 v68, v68, v241
    v_exp_f32 v67, v67
    v_add_f32 v252, v64, v65
    v_cvt_pk_bf16_f32 v64, v64, v65
    v_add_f32 v69, v69, v242
    v_exp_f32 v68, v68
    v_add_f32 v70, v70, v243
    v_exp_f32 v69, v69
    v_add_f32 v253, v66, v67
    v_cvt_pk_bf16_f32 v65, v66, v67
    v_add_f32 v71, v71, v240
    v_exp_f32 v70, v70
    v_add_f32 v252, v252, v68
    v_add_f32 v72, v72, v245
    v_exp_f32 v71, v71
    v_add_f32 v252, v252, v69
    v_cvt_pk_bf16_f32 v66, v68, v69
    v_add_f32 v73, v73, v246
    v_exp_f32 v72, v72
    v_add_f32 v253, v253, v70
    v_add_f32 v74, v74, v247
    v_exp_f32 v73, v73
    v_add_f32 v253, v253, v71
    v_cvt_pk_bf16_f32 v67, v70, v71
    v_add_f32 v75, v75, v244
    v_exp_f32 v74, v74
    v_add_f32 v76, v76, v245
    v_exp_f32 v75, v75
    v_add_f32 v254, v72, v73
    v_cvt_pk_bf16_f32 v72, v72, v73
    v_add_f32 v77, v77, v246
    v_exp_f32 v76, v76
    v_add_f32 v78, v78, v247
    v_exp_f32 v77, v77
    v_add_f32 v255, v74, v75
    v_cvt_pk_bf16_f32 v73, v74, v75
    v_add_f32 v79, v79, v244
    v_exp_f32 v78, v78
    v_add_f32 v254, v254, v76
    v_add_f32 v80, v80, v241
    v_exp_f32 v79, v79
    v_add_f32 v254, v254, v77
    v_cvt_pk_bf16_f32 v74, v76, v77
    v_add_f32 v81, v81, v242
    v_exp_f32 v80, v80
    v_add_f32 v255, v255, v78
    v_add_f32 v82, v82, v243
    v_exp_f32 v81, v81
    v_add_f32 v255, v255, v79
    v_cvt_pk_bf16_f32 v75, v78, v79
    v_add_f32 v83, v83, v240
    v_exp_f32 v82, v82
    v_add_f32 v252, v252, v80
    v_add_f32 v84, v84, v241
    v_exp_f32 v83, v83
    v_add_f32 v252, v252, v81
    v_cvt_pk_bf16_f32 v80, v80, v81
    v_add_f32 v85, v85, v242
    v_exp_f32 v84, v84
    v_add_f32 v253, v253, v82
    v_add_f32 v86, v86, v243
    v_exp_f32 v85, v85
    v_add_f32 v253, v253, v83
    v_cvt_pk_bf16_f32 v81, v82, v83
    v_add_f32 v87, v87, v240
    v_exp_f32 v86, v86
    v_add_f32 v252, v252, v84
    v_add_f32 v88, v88, v245
    v_exp_f32 v87, v87
    v_add_f32 v252, v252, v85
    v_cvt_pk_bf16_f32 v82, v84, v85
    v_add_f32 v89, v89, v246
    v_exp_f32 v88, v88
    v_add_f32 v253, v253, v86
    v_add_f32 v90, v90, v247
    v_exp_f32 v89, v89
    v_add_f32 v253, v253, v87
    v_cvt_pk_bf16_f32 v83, v86, v87
    v_add_f32 v91, v91, v244
    v_exp_f32 v90, v90
    v_add_f32 v254, v254, v88
    v_add_f32 v92, v92, v245
    v_exp_f32 v91, v91
    v_add_f32 v254, v254, v89
    v_cvt_pk_bf16_f32 v88, v88, v89
    v_add_f32 v93, v93, v246
    v_exp_f32 v92, v92
    v_add_f32 v255, v255, v90
    v_add_f32 v94, v94, v247
    v_exp_f32 v93, v93
    v_add_f32 v255, v255, v91
    v_cvt_pk_bf16_f32 v89, v90, v91
    v_add_f32 v95, v95, v244
    v_exp_f32 v94, v94
    v_add_f32 v254, v254, v92
    v_exp_f32 v95, v95
    v_add_f32 v254, v254, v93
    v_cvt_pk_bf16_f32 v90, v92, v93
    v_add_f32 v255, v255, v94
    v_add_f32 v255, v255, v95
    v_cvt_pk_bf16_f32 v91, v94, v95
    v_add_f32 v252, v252, v253
    v_add_f32 v254, v254, v255
    s_nop 3
    s_branch L_back_2_2
L_slow_2_3:
    s_nop 15
    v_add_u32 v239, s43, v224
    v_subrev_u32 v239, s44, v239
    ds_read_b128 v[252:255], v239 offset:16384
    s_waitcnt lgkmcnt(0)
    v_mfma_f32_16x16x32_bf16 v[96:99], v[252:255], v[128:131], 0
    v_mfma_f32_16x16x32_bf16 v[104:107], v[252:255], v[144:147], 0
    s_nop 3
    v_add_u32 v239, s43, v225
    v_subrev_u32 v239, s44, v239
    ds_read_b128 v[252:255], v239 offset:16384
    s_waitcnt lgkmcnt(0)
    v_mfma_f32_16x16x32_bf16 v[96:99], v[252:255], v[132:135], v[96:99]
    v_mfma_f32_16x16x32_bf16 v[104:107], v[252:255], v[148:151], v[104:107]
    s_nop 3
    v_add_u32 v239, s43, v226
    v_subrev_u32 v239, s44, v239
    ds_read_b128 v[252:255], v239 offset:16384
    s_waitcnt lgkmcnt(0)
    v_mfma_f32_16x16x32_bf16 v[96:99], v[252:255], v[136:139], v[96:99]
    v_mfma_f32_16x16x32_bf16 v[104:107], v[252:255], v[152:155], v[104:107]
    s_nop 3
    v_add_u32 v239, s43, v227
    v_subrev_u32 v239, s44, v239
    ds_read_b128 v[252:255], v239 offset:16384
    s_waitcnt lgkmcnt(0)
    v_mfma_f32_16x16x32_bf16 v[96:99], v[252:255], v[140:143], v[96:99]
    v_mfma_f32_16x16x32_bf16 v[104:107], v[252:255], v[156:159], v[104:107]
    s_nop 3
    v_add_u32 v239, s43, v224
    v_subrev_u32 v239, s44, v239
    ds_read_b128 v[252:255], v239 offset:20480
    s_waitcnt lgkmcnt(0)
    v_mfma_f32_16x16x32_bf16 v[100:103], v[252:255], v[128:131], 0
    v_mfma_f32_16x16x32_bf16 v[108:111], v[252:255], v[144:147], 0
    s_nop 3
    v_add_u32 v239, s43, v225
    v_subrev_u32 v239, s44, v239
    ds_read_b128 v[252:255], v239 offset:20480
    s_waitcnt lgkmcnt(0)
    v_mfma_f32_16x16x32_bf16 v[100:103], v[252:255], v[132:135], v[100:103]
    v_mfma_f32_16x16x32_bf16 v[108:111], v[252:255], v[148:151], v[108:111]
    s_nop 3
    v_add_u32 v239, s43, v226
    v_subrev_u32 v239, s44, v239
    ds_read_b128 v[252:255], v239 offset:20480
    s_waitcnt lgkmcnt(0)
    v_mfma_f32_16x16x32_bf16 v[100:103], v[252:255], v[136:139], v[100:103]
    v_mfma_f32_16x16x32_bf16 v[108:111], v[252:255], v[152:155], v[108:111]
    s_nop 3
    v_add_u32 v239, s43, v227
    v_subrev_u32 v239, s44, v239
    ds_read_b128 v[252:255], v239 offset:20480
    s_waitcnt lgkmcnt(0)
    v_mfma_f32_16x16x32_bf16 v[100:103], v[252:255], v[140:143], v[100:103]
    v_mfma_f32_16x16x32_bf16 v[108:111], v[252:255], v[156:159], v[108:111]
    s_nop 3
    v_add_u32 v239, s43, v224
    v_subrev_u32 v239, s44, v239
    ds_read_b128 v[252:255], v239 offset:24576
    s_waitcnt lgkmcnt(0)
    v_mfma_f32_16x16x32_bf16 v[112:115], v[252:255], v[128:131], 0
    v_mfma_f32_16x16x32_bf16 v[120:123], v[252:255], v[144:147], 0
    s_nop 3
    v_add_u32 v239, s43, v225
    v_subrev_u32 v239, s44, v239
    ds_read_b128 v[252:255], v239 offset:24576
    s_waitcnt lgkmcnt(0)
    v_mfma_f32_16x16x32_bf16 v[112:115], v[252:255], v[132:135], v[112:115]
    v_mfma_f32_16x16x32_bf16 v[120:123], v[252:255], v[148:151], v[120:123]
    s_nop 3
    v_add_u32 v239, s43, v226
    v_subrev_u32 v239, s44, v239
    ds_read_b128 v[252:255], v239 offset:24576
    s_waitcnt lgkmcnt(0)
    v_mfma_f32_16x16x32_bf16 v[112:115], v[252:255], v[136:139], v[112:115]
    v_mfma_f32_16x16x32_bf16 v[120:123], v[252:255], v[152:155], v[120:123]
    s_nop 3
    v_add_u32 v239, s43, v227
    v_subrev_u32 v239, s44, v239
    ds_read_b128 v[252:255], v239 offset:24576
    s_waitcnt lgkmcnt(0)
    v_mfma_f32_16x16x32_bf16 v[112:115], v[252:255], v[140:143], v[112:115]
    v_mfma_f32_16x16x32_bf16 v[120:123], v[252:255], v[156:159], v[120:123]
    s_nop 3
    v_add_u32 v239, s43, v224
    v_subrev_u32 v239, s44, v239
    ds_read_b128 v[252:255], v239 offset:28672
    s_waitcnt lgkmcnt(0)
    v_mfma_f32_16x16x32_bf16 v[116:119], v[252:255], v[128:131], 0
    v_mfma_f32_16x16x32_bf16 v[124:127], v[252:255], v[144:147], 0
    s_nop 3
    v_add_u32 v239, s43, v225
    v_subrev_u32 v239, s44, v239
    ds_read_b128 v[252:255], v239 offset:28672
    s_waitcnt lgkmcnt(0)
    v_mfma_f32_16x16x32_bf16 v[116:119], v[252:255], v[132:135], v[116:119]
    v_mfma_f32_16x16x32_bf16 v[124:127], v[252:255], v[148:151], v[124:127]
    s_nop 3
    v_add_u32 v239, s43, v226
    v_subrev_u32 v239, s44, v239
    ds_read_b128 v[252:255], v239 offset:28672
    s_waitcnt lgkmcnt(0)
    v_mfma_f32_16x16x32_bf16 v[116:119], v[252:255], v[136:139], v[116:119]
    v_mfma_f32_16x16x32_bf16 v[124:127], v[252:255], v[152:155], v[124:127]
    s_nop 3
    v_add_u32 v239, s43, v227
    v_subrev_u32 v239, s44, v239
    ds_read_b128 v[252:255], v239 offset:28672
    s_waitcnt lgkmcnt(0)
    v_mfma_f32_16x16x32_bf16 v[116:119], v[252:255], v[140:143], v[116:119]
    v_mfma_f32_16x16x32_bf16 v[124:127], v[252:255], v[156:159], v[124:127]
    s_nop 3
    s_nop 15
    v_max3_f32 v252, v96, v97, v98
    v_max3_f32 v254, v104, v105, v106
    v_max3_f32 v252, v252, v99, v100
    v_max3_f32 v254, v254, v107, v108
    v_max3_f32 v252, v252, v101, v102
    v_max3_f32 v254, v254, v109, v110
    v_max3_f32 v252, v252, v103, v112
    v_max3_f32 v254, v254, v111, v120
    v_max3_f32 v252, v252, v113, v114
    v_max3_f32 v254, v254, v121, v122
    v_max3_f32 v252, v252, v115, v116
    v_max3_f32 v254, v254, v123, v124
    v_max3_f32 v252, v252, v117, v118
    v_max3_f32 v254, v254, v125, v126
    v_max_f32 v252, v252, v119
    v_max_f32 v254, v254, v127
    v_mov_b32 v253, v252
    v_mov_b32 v255, v254
    s_nop 0
    v_permlane16_swap_b32 v252, v253
    v_permlane16_swap_b32 v254, v255
    v_max_f32 v252, v252, v253
    v_max_f32 v254, v254, v255
    v_mov_b32 v253, v252
    v_mov_b32 v255, v254
    s_nop 0
    v_permlane32_swap_b32 v252, v253
    v_permlane32_swap_b32 v254, v255
    v_max_f32 v252, v252, v253
    v_max_f32 v254, v254, v255
    v_sub_f32 v252, 0, v252
    v_min_f32 v252, v252, v240
    v_sub_f32 v253, v252, v240
    v_exp_f32 v250, v253
    v_mov_b32 v240, v252
    v_mov_b32 v241, v252
    v_mov_b32 v242, v252
    v_mov_b32 v243, v252
    v_mul_f32 v248, v248, v250
    v_mul_f32 v0, v0, v250
    v_mul_f32 v1, v1, v250
    v_mul_f32 v2, v2, v250
    v_mul_f32 v3, v3, v250
    v_mul_f32 v4, v4, v250
    v_mul_f32 v5, v5, v250
    v_mul_f32 v6, v6, v250
    v_mul_f32 v7, v7, v250
    v_mul_f32 v16, v16, v250
    v_mul_f32 v17, v17, v250
    v_mul_f32 v18, v18, v250
    v_mul_f32 v19, v19, v250
    v_mul_f32 v20, v20, v250
    v_mul_f32 v21, v21, v250
    v_mul_f32 v22, v22, v250
    v_mul_f32 v23, v23, v250
    v_mul_f32 v32, v32, v250
    v_mul_f32 v33, v33, v250
    v_mul_f32 v34, v34, v250
    v_mul_f32 v35, v35, v250
    v_mul_f32 v36, v36, v250
    v_mul_f32 v37, v37, v250
    v_mul_f32 v38, v38, v250
    v_mul_f32 v39, v39, v250
    v_mul_f32 v48, v48, v250
    v_mul_f32 v49, v49, v250
    v_mul_f32 v50, v50, v250
    v_mul_f32 v51, v51, v250
    v_mul_f32 v52, v52, v250
    v_mul_f32 v53, v53, v250
    v_mul_f32 v54, v54, v250
    v_mul_f32 v55, v55, v250
    v_add_f32 v64, v64, v253
    v_add_f32 v65, v65, v253
    v_add_f32 v66, v66, v253
    v_add_f32 v67, v67, v253
    v_add_f32 v68, v68, v253
    v_add_f32 v69, v69, v253
    v_add_f32 v70, v70, v253
    v_add_f32 v71, v71, v253
    v_add_f32 v80, v80, v253
    v_add_f32 v81, v81, v253
    v_add_f32 v82, v82, v253
    v_add_f32 v83, v83, v253
    v_add_f32 v84, v84, v253
    v_add_f32 v85, v85, v253
    v_add_f32 v86, v86, v253
    v_add_f32 v87, v87, v253
    v_sub_f32 v254, 0, v254
    v_min_f32 v254, v254, v244
    v_sub_f32 v255, v254, v244
    v_exp_f32 v251, v255
    v_mov_b32 v244, v254
    v_mov_b32 v245, v254
    v_mov_b32 v246, v254
    v_mov_b32 v247, v254
    v_mul_f32 v249, v249, v251
    v_mul_f32 v8, v8, v251
    v_mul_f32 v9, v9, v251
    v_mul_f32 v10, v10, v251
    v_mul_f32 v11, v11, v251
    v_mul_f32 v12, v12, v251
    v_mul_f32 v13, v13, v251
    v_mul_f32 v14, v14, v251
    v_mul_f32 v15, v15, v251
    v_mul_f32 v24, v24, v251
    v_mul_f32 v25, v25, v251
    v_mul_f32 v26, v26, v251
    v_mul_f32 v27, v27, v251
    v_mul_f32 v28, v28, v251
    v_mul_f32 v29, v29, v251
    v_mul_f32 v30, v30, v251
    v_mul_f32 v31, v31, v251
    v_mul_f32 v40, v40, v251
    v_mul_f32 v41, v41, v251
    v_mul_f32 v42, v42, v251
    v_mul_f32 v43, v43, v251
    v_mul_f32 v44, v44, v251
    v_mul_f32 v45, v45, v251
    v_mul_f32 v46, v46, v251
    v_mul_f32 v47, v47, v251
    v_mul_f32 v56, v56, v251
    v_mul_f32 v57, v57, v251
    v_mul_f32 v58, v58, v251
    v_mul_f32 v59, v59, v251
    v_mul_f32 v60, v60, v251
    v_mul_f32 v61, v61, v251
    v_mul_f32 v62, v62, v251
    v_mul_f32 v63, v63, v251
    v_add_f32 v72, v72, v255
    v_add_f32 v73, v73, v255
    v_add_f32 v74, v74, v255
    v_add_f32 v75, v75, v255
    v_add_f32 v76, v76, v255
    v_add_f32 v77, v77, v255
    v_add_f32 v78, v78, v255
    v_add_f32 v79, v79, v255
    v_add_f32 v88, v88, v255
    v_add_f32 v89, v89, v255
    v_add_f32 v90, v90, v255
    v_add_f32 v91, v91, v255
    v_add_f32 v92, v92, v255
    v_add_f32 v93, v93, v255
    v_add_f32 v94, v94, v255
    v_add_f32 v95, v95, v255
    v_add_f32 v96, v96, v241
    v_add_f32 v97, v97, v242
    v_exp_f32 v96, v96
    v_add_f32 v98, v98, v243
    v_exp_f32 v97, v97
    v_add_f32 v99, v99, v240
    v_exp_f32 v98, v98
    v_add_f32 v100, v100, v241
    v_exp_f32 v99, v99
    v_add_f32 v252, v96, v97
    v_cvt_pk_bf16_f32 v96, v96, v97
    v_add_f32 v101, v101, v242
    v_exp_f32 v100, v100
    v_add_f32 v102, v102, v243
    v_exp_f32 v101, v101
    v_add_f32 v253, v98, v99
    v_cvt_pk_bf16_f32 v97, v98, v99
    v_add_f32 v103, v103, v240
    v_exp_f32 v102, v102
    v_add_f32 v252, v252, v100
    v_add_f32 v104, v104, v245
    v_exp_f32 v103, v103
    v_add_f32 v252, v252, v101
    v_cvt_pk_bf16_f32 v98, v100, v101
    v_add_f32 v105, v105, v246
    v_exp_f32 v104, v104
    v_add_f32 v253, v253, v102
    v_add_f32 v106, v106, v247
    v_exp_f32 v105, v105
    v_add_f32 v253, v253, v103
    v_cvt_pk_bf16_f32 v99, v102, v103
    v_add_f32 v107, v107, v244
    v_exp_f32 v106, v106
    v_add_f32 v108, v108, v245
    v_exp_f32 v107, v107
    v_add_f32 v254, v104, v105
    v_cvt_pk_bf16_f32 v104, v104, v105
    v_add_f32 v109, v109, v246
    v_exp_f32 v108, v108
    v_add_f32 v110, v110, v247
    v_exp_f32 v109, v109
    v_add_f32 v255, v106, v107
    v_cvt_pk_bf16_f32 v105, v106, v107
    v_add_f32 v111, v111, v244
    v_exp_f32 v110, v110
    v_add_f32 v254, v254, v108
    v_add_f32 v112, v112, v241
    v_exp_f32 v111, v111
    v_add_f32 v254, v254, v109
    v_cvt_pk_bf16_f32 v106, v108, v109
    v_add_f32 v113, v113, v242
    v_exp_f32 v112, v112
    v_add_f32 v255, v255, v110
    v_add_f32 v114, v114, v243
    v_exp_f32 v113, v113
    v_add_f32 v255, v255, v111
    v_cvt_pk_bf16_f32 v107, v110, v111
    v_add_f32 v115, v115, v240
    v_exp_f32 v114, v114
    v_add_f32 v252, v252, v112
    v_add_f32 v116, v116, v241
    v_exp_f32 v115, v115
    v_add_f32 v252, v252, v113
    v_cvt_pk_bf16_f32 v112, v112, v113
    v_add_f32 v117, v117, v242
    v_exp_f32 v116, v116
    v_add_f32 v253, v253, v114
    v_add_f32 v118, v118, v243
    v_exp_f32 v117, v117
    v_add_f32 v253, v253, v115
    v_cvt_pk_bf16_f32 v113, v114, v115
    v_add_f32 v119, v119, v240
    v_exp_f32 v118, v118
    v_add_f32 v252, v252, v116
    v_add_f32 v120, v120, v245
    v_exp_f32 v119, v119
    v_add_f32 v252, v252, v117
    v_cvt_pk_bf16_f32 v114, v116, v117
    v_add_f32 v121, v121, v246
    v_exp_f32 v120, v120
    v_add_f32 v253, v253, v118
    v_add_f32 v122, v122, v247
    v_exp_f32 v121, v121
    v_add_f32 v253, v253, v119
    v_cvt_pk_bf16_f32 v115, v118, v119
    v_add_f32 v123, v123, v244
    v_exp_f32 v122, v122
    v_add_f32 v254, v254, v120
    v_add_f32 v124, v124, v245
    v_exp_f32 v123, v123
    v_add_f32 v254, v254, v121
    v_cvt_pk_bf16_f32 v120, v120, v121
    v_add_f32 v125, v125, v246
    v_exp_f32 v124, v124
    v_add_f32 v255, v255, v122
    v_add_f32 v126, v126, v247
    v_exp_f32 v125, v125
    v_add_f32 v255, v255, v123
    v_cvt_pk_bf16_f32 v121, v122, v123
    v_add_f32 v127, v127, v244
    v_exp_f32 v126, v126
    v_add_f32 v254, v254, v124
    v_exp_f32 v127, v127
    v_add_f32 v254, v254, v125
    v_cvt_pk_bf16_f32 v122, v124, v125
    v_add_f32 v255, v255, v126
    v_add_f32 v255, v255, v127
    v_cvt_pk_bf16_f32 v123, v126, v127
    v_add_f32 v252, v252, v253
    v_add_f32 v254, v254, v255
    s_nop 3
    s_branch L_back_2_3
L_slow_2_4:
    s_nop 15
    v_add_u32 v239, s44, v224
    v_subrev_u32 v239, s44, v239
    ds_read_b128 v[252:255], v239 offset:0
    s_waitcnt lgkmcnt(0)
    v_mfma_f32_16x16x32_bf16 v[64:67], v[252:255], v[128:131], 0
    v_mfma_f32_16x16x32_bf16 v[72:75], v[252:255], v[144:147], 0
    s_nop 3
    v_add_u32 v239, s44, v225
    v_subrev_u32 v239, s44, v239
    ds_read_b128 v[252:255], v239 offset:0
    s_waitcnt lgkmcnt(0)
    v_mfma_f32_16x16x32_bf16 v[64:67], v[252:255], v[132:135], v[64:67]
    v_mfma_f32_16x16x32_bf16 v[72:75], v[252:255], v[148:151], v[72:75]
    s_nop 3
    v_add_u32 v239, s44, v226
    v_subrev_u32 v239, s44, v239
    ds_read_b128 v[252:255], v239 offset:0
    s_waitcnt lgkmcnt(0)
    v_mfma_f32_16x16x32_bf16 v[64:67], v[252:255], v[136:139], v[64:67]
    v_mfma_f32_16x16x32_bf16 v[72:75], v[252:255], v[152:155], v[72:75]
    s_nop 3
    v_add_u32 v239, s44, v227
    v_subrev_u32 v239, s44, v239
    ds_read_b128 v[252:255], v239 offset:0
    s_waitcnt lgkmcnt(0)
    v_mfma_f32_16x16x32_bf16 v[64:67], v[252:255], v[140:143], v[64:67]
    v_mfma_f32_16x16x32_bf16 v[72:75], v[252:255], v[156:159], v[72:75]
    s_nop 3
    v_add_u32 v239, s44, v224
    v_subrev_u32 v239, s44, v239
    ds_read_b128 v[252:255], v239 offset:4096
    s_waitcnt lgkmcnt(0)
    v_mfma_f32_16x16x32_bf16 v[68:71], v[252:255], v[128:131], 0
    v_mfma_f32_16x16x32_bf16 v[76:79], v[252:255], v[144:147], 0
    s_nop 3
    v_add_u32 v239, s44, v225
    v_subrev_u32 v239, s44, v239
    ds_read_b128 v[252:255], v239 offset:4096
    s_waitcnt lgkmcnt(0)
    v_mfma_f32_16x16x32_bf16 v[68:71], v[252:255], v[132:135], v[68:71]
    v_mfma_f32_16x16x32_bf16 v[76:79], v[252:255], v[148:151], v[76:79]
    s_nop 3
    v_add_u32 v239, s44, v226
    v_subrev_u32 v239, s44, v239
    ds_read_b128 v[252:255], v239 offset:4096
    s_waitcnt lgkmcnt(0)
    v_mfma_f32_16x16x32_bf16 v[68:71], v[252:255], v[136:139], v[68:71]
    v_mfma_f32_16x16x32_bf16 v[76:79], v[252:255], v[152:155], v[76:79]
    s_nop 3
    v_add_u32 v239, s44, v227
    v_subrev_u32 v239, s44, v239
    ds_read_b128 v[252:255], v239 offset:4096
    s_waitcnt lgkmcnt(0)
    v_mfma_f32_16x16x32_bf16 v[68:71], v[252:255], v[140:143], v[68:71]
    v_mfma_f32_16x16x32_bf16 v[76:79], v[252:255], v[156:159], v[76:79]
    s_nop 3
    v_add_u32 v239, s44, v224
    v_subrev_u32 v239, s44, v239
    ds_read_b128 v[252:255], v239 offset:8192
    s_waitcnt lgkmcnt(0)
    v_mfma_f32_16x16x32_bf16 v[80:83], v[252:255], v[128:131], 0
    v_mfma_f32_16x16x32_bf16 v[88:91], v[252:255], v[144:147], 0
    s_nop 3
    v_add_u32 v239, s44, v225
    v_subrev_u32 v239, s44, v239
    ds_read_b128 v[252:255], v239 offset:8192
    s_waitcnt lgkmcnt(0)
    v_mfma_f32_16x16x32_bf16 v[80:83], v[252:255], v[132:135], v[80:83]
    v_mfma_f32_16x16x32_bf16 v[88:91], v[252:255], v[148:151], v[88:91]
    s_nop 3
    v_add_u32 v239, s44, v226
    v_subrev_u32 v239, s44, v239
    ds_read_b128 v[252:255], v239 offset:8192
    s_waitcnt lgkmcnt(0)
    v_mfma_f32_16x16x32_bf16 v[80:83], v[252:255], v[136:139], v[80:83]
    v_mfma_f32_16x16x32_bf16 v[88:91], v[252:255], v[152:155], v[88:91]
    s_nop 3
    v_add_u32 v239, s44, v227
    v_subrev_u32 v239, s44, v239
    ds_read_b128 v[252:255], v239 offset:8192
    s_waitcnt lgkmcnt(0)
    v_mfma_f32_16x16x32_bf16 v[80:83], v[252:255], v[140:143], v[80:83]
    v_mfma_f32_16x16x32_bf16 v[88:91], v[252:255], v[156:159], v[88:91]
    s_nop 3
    v_add_u32 v239, s44, v224
    v_subrev_u32 v239, s44, v239
    ds_read_b128 v[252:255], v239 offset:12288
    s_waitcnt lgkmcnt(0)
    v_mfma_f32_16x16x32_bf16 v[84:87], v[252:255], v[128:131], 0
    v_mfma_f32_16x16x32_bf16 v[92:95], v[252:255], v[144:147], 0
    s_nop 3
    v_add_u32 v239, s44, v225
    v_subrev_u32 v239, s44, v239
    ds_read_b128 v[252:255], v239 offset:12288
    s_waitcnt lgkmcnt(0)
    v_mfma_f32_16x16x32_bf16 v[84:87], v[252:255], v[132:135], v[84:87]
    v_mfma_f32_16x16x32_bf16 v[92:95], v[252:255], v[148:151], v[92:95]
    s_nop 3
    v_add_u32 v239, s44, v226
    v_subrev_u32 v239, s44, v239
    ds_read_b128 v[252:255], v239 offset:12288
    s_waitcnt lgkmcnt(0)
    v_mfma_f32_16x16x32_bf16 v[84:87], v[252:255], v[136:139], v[84:87]
    v_mfma_f32_16x16x32_bf16 v[92:95], v[252:255], v[152:155], v[92:95]
    s_nop 3
    v_add_u32 v239, s44, v227
    v_subrev_u32 v239, s44, v239
    ds_read_b128 v[252:255], v239 offset:12288
    s_waitcnt lgkmcnt(0)
    v_mfma_f32_16x16x32_bf16 v[84:87], v[252:255], v[140:143], v[84:87]
    v_mfma_f32_16x16x32_bf16 v[92:95], v[252:255], v[156:159], v[92:95]
    s_nop 3
    s_nop 15
    v_max3_f32 v252, v64, v65, v66
    v_max3_f32 v254, v72, v73, v74
    v_max3_f32 v252, v252, v67, v68
    v_max3_f32 v254, v254, v75, v76
    v_max3_f32 v252, v252, v69, v70
    v_max3_f32 v254, v254, v77, v78
    v_max3_f32 v252, v252, v71, v80
    v_max3_f32 v254, v254, v79, v88
    v_max3_f32 v252, v252, v81, v82
    v_max3_f32 v254, v254, v89, v90
    v_max3_f32 v252, v252, v83, v84
    v_max3_f32 v254, v254, v91, v92
    v_max3_f32 v252, v252, v85, v86
    v_max3_f32 v254, v254, v93, v94
    v_max_f32 v252, v252, v87
    v_max_f32 v254, v254, v95
    v_mov_b32 v253, v252
    v_mov_b32 v255, v254
    s_nop 0
    v_permlane16_swap_b32 v252, v253
    v_permlane16_swap_b32 v254, v255
    v_max_f32 v252, v252, v253
    v_max_f32 v254, v254, v255
    v_mov_b32 v253, v252
    v_mov_b32 v255, v254
    s_nop 0
    v_permlane32_swap_b32 v252, v253
    v_permlane32_swap_b32 v254, v255
    v_max_f32 v252, v252, v253
    v_max_f32 v254, v254, v255
    v_sub_f32 v252, 0, v252
    v_min_f32 v252, v252, v240
    v_sub_f32 v253, v252, v240
    v_exp_f32 v250, v253
    v_mov_b32 v240, v252
    v_mov_b32 v241, v252
    v_mov_b32 v242, v252
    v_mov_b32 v243, v252
    v_mul_f32 v248, v248, v250
    v_mul_f32 v0, v0, v250
    v_mul_f32 v1, v1, v250
    v_mul_f32 v2, v2, v250
    v_mul_f32 v3, v3, v250
    v_mul_f32 v4, v4, v250
    v_mul_f32 v5, v5, v250
    v_mul_f32 v6, v6, v250
    v_mul_f32 v7, v7, v250
    v_mul_f32 v16, v16, v250
    v_mul_f32 v17, v17, v250
    v_mul_f32 v18, v18, v250
    v_mul_f32 v19, v19, v250
    v_mul_f32 v20, v20, v250
    v_mul_f32 v21, v21, v250
    v_mul_f32 v22, v22, v250
    v_mul_f32 v23, v23, v250
    v_mul_f32 v32, v32, v250
    v_mul_f32 v33, v33, v250
    v_mul_f32 v34, v34, v250
    v_mul_f32 v35, v35, v250
    v_mul_f32 v36, v36, v250
    v_mul_f32 v37, v37, v250
    v_mul_f32 v38, v38, v250
    v_mul_f32 v39, v39, v250
    v_mul_f32 v48, v48, v250
    v_mul_f32 v49, v49, v250
    v_mul_f32 v50, v50, v250
    v_mul_f32 v51, v51, v250
    v_mul_f32 v52, v52, v250
    v_mul_f32 v53, v53, v250
    v_mul_f32 v54, v54, v250
    v_mul_f32 v55, v55, v250
    v_add_f32 v96, v96, v253
    v_add_f32 v97, v97, v253
    v_add_f32 v98, v98, v253
    v_add_f32 v99, v99, v253
    v_add_f32 v100, v100, v253
    v_add_f32 v101, v101, v253
    v_add_f32 v102, v102, v253
    v_add_f32 v103, v103, v253
    v_add_f32 v112, v112, v253
    v_add_f32 v113, v113, v253
    v_add_f32 v114, v114, v253
    v_add_f32 v115, v115, v253
    v_add_f32 v116, v116, v253
    v_add_f32 v117, v117, v253
    v_add_f32 v118, v118, v253
    v_add_f32 v119, v119, v253
    v_sub_f32 v254, 0, v254
    v_min_f32 v254, v254, v244
    v_sub_f32 v255, v254, v244
    v_exp_f32 v251, v255
    v_mov_b32 v244, v254
    v_mov_b32 v245, v254
    v_mov_b32 v246, v254
    v_mov_b32 v247, v254
    v_mul_f32 v249, v249, v251
    v_mul_f32 v8, v8, v251
    v_mul_f32 v9, v9, v251
    v_mul_f32 v10, v10, v251
    v_mul_f32 v11, v11, v251
    v_mul_f32 v12, v12, v251
    v_mul_f32 v13, v13, v251
    v_mul_f32 v14, v14, v251
    v_mul_f32 v15, v15, v251
    v_mul_f32 v24, v24, v251
    v_mul_f32 v25, v25, v251
    v_mul_f32 v26, v26, v251
    v_mul_f32 v27, v27, v251
    v_mul_f32 v28, v28, v251
    v_mul_f32 v29, v29, v251
    v_mul_f32 v30, v30, v251
    v_mul_f32 v31, v31, v251
    v_mul_f32 v40, v40, v251
    v_mul_f32 v41, v41, v251
    v_mul_f32 v42, v42, v251
    v_mul_f32 v43, v43, v251
    v_mul_f32 v44, v44, v251
    v_mul_f32 v45, v45, v251
    v_mul_f32 v46, v46, v251
    v_mul_f32 v47, v47, v251
    v_mul_f32 v56, v56, v251
    v_mul_f32 v57, v57, v251
    v_mul_f32 v58, v58, v251
    v_mul_f32 v59, v59, v251
    v_mul_f32 v60, v60, v251
    v_mul_f32 v61, v61, v251
    v_mul_f32 v62, v62, v251
    v_mul_f32 v63, v63, v251
    v_add_f32 v104, v104, v255
    v_add_f32 v105, v105, v255
    v_add_f32 v106, v106, v255
    v_add_f32 v107, v107, v255
    v_add_f32 v108, v108, v255
    v_add_f32 v109, v109, v255
    v_add_f32 v110, v110, v255
    v_add_f32 v111, v111, v255
    v_add_f32 v120, v120, v255
    v_add_f32 v121, v121, v255
    v_add_f32 v122, v122, v255
    v_add_f32 v123, v123, v255
    v_add_f32 v124, v124, v255
    v_add_f32 v125, v125, v255
    v_add_f32 v126, v126, v255
    v_add_f32 v127, v127, v255
    v_add_f32 v64, v64, v241
    v_add_f32 v65, v65, v242
    v_exp_f32 v64, v64
    v_add_f32 v66, v66, v243
    v_exp_f32 v65, v65
    v_add_f32 v67, v67, v240
    v_exp_f32 v66, v66
    v_add_f32 v68, v68, v241
    v_exp_f32 v67, v67
    v_add_f32 v252, v64, v65
    v_cvt_pk_bf16_f32 v64, v64, v65
    v_add_f32 v69, v69, v242
    v_exp_f32 v68, v68
    v_add_f32 v70, v70, v243
    v_exp_f32 v69, v69
    v_add_f32 v253, v66, v67
    v_cvt_pk_bf16_f32 v65, v66, v67
    v_add_f32 v71, v71, v240
    v_exp_f32 v70, v70
    v_add_f32 v252, v252, v68
    v_add_f32 v72, v72, v245
    v_exp_f32 v71, v71
    v_add_f32 v252, v252, v69
    v_cvt_pk_bf16_f32 v66, v68, v69
    v_add_f32 v73, v73, v246
    v_exp_f32 v72, v72
    v_add_f32 v253, v253, v70
    v_add_f32 v74, v74, v247
    v_exp_f32 v73, v73
    v_add_f32 v253, v253, v71
    v_cvt_pk_bf16_f32 v67, v70, v71
    v_add_f32 v75, v75, v244
    v_exp_f32 v74, v74
    v_add_f32 v76, v76, v245
    v_exp_f32 v75, v75
    v_add_f32 v254, v72, v73
    v_cvt_pk_bf16_f32 v72, v72, v73
    v_add_f32 v77, v77, v246
    v_exp_f32 v76, v76
    v_add_f32 v78, v78, v247
    v_exp_f32 v77, v77
    v_add_f32 v255, v74, v75
    v_cvt_pk_bf16_f32 v73, v74, v75
    v_add_f32 v79, v79, v244
    v_exp_f32 v78, v78
    v_add_f32 v254, v254, v76
    v_add_f32 v80, v80, v241
    v_exp_f32 v79, v79
    v_add_f32 v254, v254, v77
    v_cvt_pk_bf16_f32 v74, v76, v77
    v_add_f32 v81, v81, v242
    v_exp_f32 v80, v80
    v_add_f32 v255, v255, v78
    v_add_f32 v82, v82, v243
    v_exp_f32 v81, v81
    v_add_f32 v255, v255, v79
    v_cvt_pk_bf16_f32 v75, v78, v79
    v_add_f32 v83, v83, v240
    v_exp_f32 v82, v82
    v_add_f32 v252, v252, v80
    v_add_f32 v84, v84, v241
    v_exp_f32 v83, v83
    v_add_f32 v252, v252, v81
    v_cvt_pk_bf16_f32 v80, v80, v81
    v_add_f32 v85, v85, v242
    v_exp_f32 v84, v84
    v_add_f32 v253, v253, v82
    v_add_f32 v86, v86, v243
    v_exp_f32 v85, v85
    v_add_f32 v253, v253, v83
    v_cvt_pk_bf16_f32 v81, v82, v83
    v_add_f32 v87, v87, v240
    v_exp_f32 v86, v86
    v_add_f32 v252, v252, v84
    v_add_f32 v88, v88, v245
    v_exp_f32 v87, v87
    v_add_f32 v252, v252, v85
    v_cvt_pk_bf16_f32 v82, v84, v85
    v_add_f32 v89, v89, v246
    v_exp_f32 v88, v88
    v_add_f32 v253, v253, v86
    v_add_f32 v90, v90, v247
    v_exp_f32 v89, v89
    v_add_f32 v253, v253, v87
    v_cvt_pk_bf16_f32 v83, v86, v87
    v_add_f32 v91, v91, v244
    v_exp_f32 v90, v90
    v_add_f32 v254, v254, v88
    v_add_f32 v92, v92, v245
    v_exp_f32 v91, v91
    v_add_f32 v254, v254, v89
    v_cvt_pk_bf16_f32 v88, v88, v89
    v_add_f32 v93, v93, v246
    v_exp_f32 v92, v92
    v_add_f32 v255, v255, v90
    v_add_f32 v94, v94, v247
    v_exp_f32 v93, v93
    v_add_f32 v255, v255, v91
    v_cvt_pk_bf16_f32 v89, v90, v91
    v_add_f32 v95, v95, v244
    v_exp_f32 v94, v94
    v_add_f32 v254, v254, v92
    v_exp_f32 v95, v95
    v_add_f32 v254, v254, v93
    v_cvt_pk_bf16_f32 v90, v92, v93
    v_add_f32 v255, v255, v94
    v_add_f32 v255, v255, v95
    v_cvt_pk_bf16_f32 v91, v94, v95
    v_add_f32 v252, v252, v253
    v_add_f32 v254, v254, v255
    s_nop 3
    s_branch L_back_2_4
L_slow_2_5:
    s_nop 15
    v_add_u32 v239, s44, v224
    v_subrev_u32 v239, s44, v239
    ds_read_b128 v[252:255], v239 offset:16384
    s_waitcnt lgkmcnt(0)
    v_mfma_f32_16x16x32_bf16 v[96:99], v[252:255], v[128:131], 0
    v_mfma_f32_16x16x32_bf16 v[104:107], v[252:255], v[144:147], 0
    s_nop 3
    v_add_u32 v239, s44, v225
    v_subrev_u32 v239, s44, v239
    ds_read_b128 v[252:255], v239 offset:16384
    s_waitcnt lgkmcnt(0)
    v_mfma_f32_16x16x32_bf16 v[96:99], v[252:255], v[132:135], v[96:99]
    v_mfma_f32_16x16x32_bf16 v[104:107], v[252:255], v[148:151], v[104:107]
    s_nop 3
    v_add_u32 v239, s44, v226
    v_subrev_u32 v239, s44, v239
    ds_read_b128 v[252:255], v239 offset:16384
    s_waitcnt lgkmcnt(0)
    v_mfma_f32_16x16x32_bf16 v[96:99], v[252:255], v[136:139], v[96:99]
    v_mfma_f32_16x16x32_bf16 v[104:107], v[252:255], v[152:155], v[104:107]
    s_nop 3
    v_add_u32 v239, s44, v227
    v_subrev_u32 v239, s44, v239
    ds_read_b128 v[252:255], v239 offset:16384
    s_waitcnt lgkmcnt(0)
    v_mfma_f32_16x16x32_bf16 v[96:99], v[252:255], v[140:143], v[96:99]
    v_mfma_f32_16x16x32_bf16 v[104:107], v[252:255], v[156:159], v[104:107]
    s_nop 3
    v_add_u32 v239, s44, v224
    v_subrev_u32 v239, s44, v239
    ds_read_b128 v[252:255], v239 offset:20480
    s_waitcnt lgkmcnt(0)
    v_mfma_f32_16x16x32_bf16 v[100:103], v[252:255], v[128:131], 0
    v_mfma_f32_16x16x32_bf16 v[108:111], v[252:255], v[144:147], 0
    s_nop 3
    v_add_u32 v239, s44, v225
    v_subrev_u32 v239, s44, v239
    ds_read_b128 v[252:255], v239 offset:20480
    s_waitcnt lgkmcnt(0)
    v_mfma_f32_16x16x32_bf16 v[100:103], v[252:255], v[132:135], v[100:103]
    v_mfma_f32_16x16x32_bf16 v[108:111], v[252:255], v[148:151], v[108:111]
    s_nop 3
    v_add_u32 v239, s44, v226
    v_subrev_u32 v239, s44, v239
    ds_read_b128 v[252:255], v239 offset:20480
    s_waitcnt lgkmcnt(0)
    v_mfma_f32_16x16x32_bf16 v[100:103], v[252:255], v[136:139], v[100:103]
    v_mfma_f32_16x16x32_bf16 v[108:111], v[252:255], v[152:155], v[108:111]
    s_nop 3
    v_add_u32 v239, s44, v227
    v_subrev_u32 v239, s44, v239
    ds_read_b128 v[252:255], v239 offset:20480
    s_waitcnt lgkmcnt(0)
    v_mfma_f32_16x16x32_bf16 v[100:103], v[252:255], v[140:143], v[100:103]
    v_mfma_f32_16x16x32_bf16 v[108:111], v[252:255], v[156:159], v[108:111]
    s_nop 3
    v_add_u32 v239, s44, v224
    v_subrev_u32 v239, s44, v239
    ds_read_b128 v[252:255], v239 offset:24576
    s_waitcnt lgkmcnt(0)
    v_mfma_f32_16x16x32_bf16 v[112:115], v[252:255], v[128:131], 0
    v_mfma_f32_16x16x32_bf16 v[120:123], v[252:255], v[144:147], 0
    s_nop 3
    v_add_u32 v239, s44, v225
    v_subrev_u32 v239, s44, v239
    ds_read_b128 v[252:255], v239 offset:24576
    s_waitcnt lgkmcnt(0)
    v_mfma_f32_16x16x32_bf16 v[112:115], v[252:255], v[132:135], v[112:115]
    v_mfma_f32_16x16x32_bf16 v[120:123], v[252:255], v[148:151], v[120:123]
    s_nop 3
    v_add_u32 v239, s44, v226
    v_subrev_u32 v239, s44, v239
    ds_read_b128 v[252:255], v239 offset:24576
    s_waitcnt lgkmcnt(0)
    v_mfma_f32_16x16x32_bf16 v[112:115], v[252:255], v[136:139], v[112:115]
    v_mfma_f32_16x16x32_bf16 v[120:123], v[252:255], v[152:155], v[120:123]
    s_nop 3
    v_add_u32 v239, s44, v227
    v_subrev_u32 v239, s44, v239
    ds_read_b128 v[252:255], v239 offset:24576
    s_waitcnt lgkmcnt(0)
    v_mfma_f32_16x16x32_bf16 v[112:115], v[252:255], v[140:143], v[112:115]
    v_mfma_f32_16x16x32_bf16 v[120:123], v[252:255], v[156:159], v[120:123]
    s_nop 3
    v_add_u32 v239, s44, v224
    v_subrev_u32 v239, s44, v239
    ds_read_b128 v[252:255], v239 offset:28672
    s_waitcnt lgkmcnt(0)
    v_mfma_f32_16x16x32_bf16 v[116:119], v[252:255], v[128:131], 0
    v_mfma_f32_16x16x32_bf16 v[124:127], v[252:255], v[144:147], 0
    s_nop 3
    v_add_u32 v239, s44, v225
    v_subrev_u32 v239, s44, v239
    ds_read_b128 v[252:255], v239 offset:28672
    s_waitcnt lgkmcnt(0)
    v_mfma_f32_16x16x32_bf16 v[116:119], v[252:255], v[132:135], v[116:119]
    v_mfma_f32_16x16x32_bf16 v[124:127], v[252:255], v[148:151], v[124:127]
    s_nop 3
    v_add_u32 v239, s44, v226
    v_subrev_u32 v239, s44, v239
    ds_read_b128 v[252:255], v239 offset:28672
    s_waitcnt lgkmcnt(0)
    v_mfma_f32_16x16x32_bf16 v[116:119], v[252:255], v[136:139], v[116:119]
    v_mfma_f32_16x16x32_bf16 v[124:127], v[252:255], v[152:155], v[124:127]
    s_nop 3
    v_add_u32 v239, s44, v227
    v_subrev_u32 v239, s44, v239
    ds_read_b128 v[252:255], v239 offset:28672
    s_waitcnt lgkmcnt(0)
    v_mfma_f32_16x16x32_bf16 v[116:119], v[252:255], v[140:143], v[116:119]
    v_mfma_f32_16x16x32_bf16 v[124:127], v[252:255], v[156:159], v[124:127]
    s_nop 3
    s_nop 15
    v_max3_f32 v252, v96, v97, v98
    v_max3_f32 v254, v104, v105, v106
    v_max3_f32 v252, v252, v99, v100
    v_max3_f32 v254, v254, v107, v108
    v_max3_f32 v252, v252, v101, v102
    v_max3_f32 v254, v254, v109, v110
    v_max3_f32 v252, v252, v103, v112
    v_max3_f32 v254, v254, v111, v120
    v_max3_f32 v252, v252, v113, v114
    v_max3_f32 v254, v254, v121, v122
    v_max3_f32 v252, v252, v115, v116
    v_max3_f32 v254, v254, v123, v124
    v_max3_f32 v252, v252, v117, v118
    v_max3_f32 v254, v254, v125, v126
    v_max_f32 v252, v252, v119
    v_max_f32 v254, v254, v127
    v_mov_b32 v253, v252
    v_mov_b32 v255, v254
    s_nop 0
    v_permlane16_swap_b32 v252, v253
    v_permlane16_swap_b32 v254, v255
    v_max_f32 v252, v252, v253
    v_max_f32 v254, v254, v255
    v_mov_b32 v253, v252
    v_mov_b32 v255, v254
    s_nop 0
    v_permlane32_swap_b32 v252, v253
    v_permlane32_swap_b32 v254, v255
    v_max_f32 v252, v252, v253
    v_max_f32 v254, v254, v255
    v_sub_f32 v252, 0, v252
    v_min_f32 v252, v252, v240
    v_sub_f32 v253, v252, v240
    v_exp_f32 v250, v253
    v_mov_b32 v240, v252
    v_mov_b32 v241, v252
    v_mov_b32 v242, v252
    v_mov_b32 v243, v252
    v_mul_f32 v248, v248, v250
    v_mul_f32 v0, v0, v250
    v_mul_f32 v1, v1, v250
    v_mul_f32 v2, v2, v250
    v_mul_f32 v3, v3, v250
    v_mul_f32 v4, v4, v250
    v_mul_f32 v5, v5, v250
    v_mul_f32 v6, v6, v250
    v_mul_f32 v7, v7, v250
    v_mul_f32 v16, v16, v250
    v_mul_f32 v17, v17, v250
    v_mul_f32 v18, v18, v250
    v_mul_f32 v19, v19, v250
    v_mul_f32 v20, v20, v250
    v_mul_f32 v21, v21, v250
    v_mul_f32 v22, v22, v250
    v_mul_f32 v23, v23, v250
    v_mul_f32 v32, v32, v250
    v_mul_f32 v33, v33, v250
    v_mul_f32 v34, v34, v250
    v_mul_f32 v35, v35, v250
    v_mul_f32 v36, v36, v250
    v_mul_f32 v37, v37, v250
    v_mul_f32 v38, v38, v250
    v_mul_f32 v39, v39, v250
    v_mul_f32 v48, v48, v250
    v_mul_f32 v49, v49, v250
    v_mul_f32 v50, v50, v250
    v_mul_f32 v51, v51, v250
    v_mul_f32 v52, v52, v250
    v_mul_f32 v53, v53, v250
    v_mul_f32 v54, v54, v250
    v_mul_f32 v55, v55, v250
    v_sub_f32 v254, 0, v254
    v_min_f32 v254, v254, v244
    v_sub_f32 v255, v254, v244
    v_exp_f32 v251, v255
    v_mov_b32 v244, v254
    v_mov_b32 v245, v254
    v_mov_b32 v246, v254
    v_mov_b32 v247, v254
    v_mul_f32 v249, v249, v251
    v_mul_f32 v8, v8, v251
    v_mul_f32 v9, v9, v251
    v_mul_f32 v10, v10, v251
    v_mul_f32 v11, v11, v251
    v_mul_f32 v12, v12, v251
    v_mul_f32 v13, v13, v251
    v_mul_f32 v14, v14, v251
    v_mul_f32 v15, v15, v251
    v_mul_f32 v24, v24, v251
    v_mul_f32 v25, v25, v251
    v_mul_f32 v26, v26, v251
    v_mul_f32 v27, v27, v251
    v_mul_f32 v28, v28, v251
    v_mul_f32 v29, v29, v251
    v_mul_f32 v30, v30, v251
    v_mul_f32 v31, v31, v251
    v_mul_f32 v40, v40, v251
    v_mul_f32 v41, v41, v251
    v_mul_f32 v42, v42, v251
    v_mul_f32 v43, v43, v251
    v_mul_f32 v44, v44, v251
    v_mul_f32 v45, v45, v251
    v_mul_f32 v46, v46, v251
    v_mul_f32 v47, v47, v251
    v_mul_f32 v56, v56, v251
    v_mul_f32 v57, v57, v251
    v_mul_f32 v58, v58, v251
    v_mul_f32 v59, v59, v251
    v_mul_f32 v60, v60, v251
    v_mul_f32 v61, v61, v251
    v_mul_f32 v62, v62, v251
    v_mul_f32 v63, v63, v251
    v_add_f32 v96, v96, v241
    v_add_f32 v97, v97, v242
    v_exp_f32 v96, v96
    v_add_f32 v98, v98, v243
    v_exp_f32 v97, v97
    v_add_f32 v99, v99, v240
    v_exp_f32 v98, v98
    v_add_f32 v100, v100, v241
    v_exp_f32 v99, v99
    v_add_f32 v252, v96, v97
    v_cvt_pk_bf16_f32 v96, v96, v97
    v_add_f32 v101, v101, v242
    v_exp_f32 v100, v100
    v_add_f32 v102, v102, v243
    v_exp_f32 v101, v101
    v_add_f32 v253, v98, v99
    v_cvt_pk_bf16_f32 v97, v98, v99
    v_add_f32 v103, v103, v240
    v_exp_f32 v102, v102
    v_add_f32 v252, v252, v100
    v_add_f32 v104, v104, v245
    v_exp_f32 v103, v103
    v_add_f32 v252, v252, v101
    v_cvt_pk_bf16_f32 v98, v100, v101
    v_add_f32 v105, v105, v246
    v_exp_f32 v104, v104
    v_add_f32 v253, v253, v102
    v_add_f32 v106, v106, v247
    v_exp_f32 v105, v105
    v_add_f32 v253, v253, v103
    v_cvt_pk_bf16_f32 v99, v102, v103
    v_add_f32 v107, v107, v244
    v_exp_f32 v106, v106
    v_add_f32 v108, v108, v245
    v_exp_f32 v107, v107
    v_add_f32 v254, v104, v105
    v_cvt_pk_bf16_f32 v104, v104, v105
    v_add_f32 v109, v109, v246
    v_exp_f32 v108, v108
    v_add_f32 v110, v110, v247
    v_exp_f32 v109, v109
    v_add_f32 v255, v106, v107
    v_cvt_pk_bf16_f32 v105, v106, v107
    v_add_f32 v111, v111, v244
    v_exp_f32 v110, v110
    v_add_f32 v254, v254, v108
    v_add_f32 v112, v112, v241
    v_exp_f32 v111, v111
    v_add_f32 v254, v254, v109
    v_cvt_pk_bf16_f32 v106, v108, v109
    v_add_f32 v113, v113, v242
    v_exp_f32 v112, v112
    v_add_f32 v255, v255, v110
    v_add_f32 v114, v114, v243
    v_exp_f32 v113, v113
    v_add_f32 v255, v255, v111
    v_cvt_pk_bf16_f32 v107, v110, v111
    v_add_f32 v115, v115, v240
    v_exp_f32 v114, v114
    v_add_f32 v252, v252, v112
    v_add_f32 v116, v116, v241
    v_exp_f32 v115, v115
    v_add_f32 v252, v252, v113
    v_cvt_pk_bf16_f32 v112, v112, v113
    v_add_f32 v117, v117, v242
    v_exp_f32 v116, v116
    v_add_f32 v253, v253, v114
    v_add_f32 v118, v118, v243
    v_exp_f32 v117, v117
    v_add_f32 v253, v253, v115
    v_cvt_pk_bf16_f32 v113, v114, v115
    v_add_f32 v119, v119, v240
    v_exp_f32 v118, v118
    v_add_f32 v252, v252, v116
    v_add_f32 v120, v120, v245
    v_exp_f32 v119, v119
    v_add_f32 v252, v252, v117
    v_cvt_pk_bf16_f32 v114, v116, v117
    v_add_f32 v121, v121, v246
    v_exp_f32 v120, v120
    v_add_f32 v253, v253, v118
    v_add_f32 v122, v122, v247
    v_exp_f32 v121, v121
    v_add_f32 v253, v253, v119
    v_cvt_pk_bf16_f32 v115, v118, v119
    v_add_f32 v123, v123, v244
    v_exp_f32 v122, v122
    v_add_f32 v254, v254, v120
    v_add_f32 v124, v124, v245
    v_exp_f32 v123, v123
    v_add_f32 v254, v254, v121
    v_cvt_pk_bf16_f32 v120, v120, v121
    v_add_f32 v125, v125, v246
    v_exp_f32 v124, v124
    v_add_f32 v255, v255, v122
    v_add_f32 v126, v126, v247
    v_exp_f32 v125, v125
    v_add_f32 v255, v255, v123
    v_cvt_pk_bf16_f32 v121, v122, v123
    v_add_f32 v127, v127, v244
    v_exp_f32 v126, v126
    v_add_f32 v254, v254, v124
    v_exp_f32 v127, v127
    v_add_f32 v254, v254, v125
    v_cvt_pk_bf16_f32 v122, v124, v125
    v_add_f32 v255, v255, v126
    v_add_f32 v255, v255, v127
    v_cvt_pk_bf16_f32 v123, v126, v127
    v_add_f32 v252, v252, v253
    v_add_f32 v254, v254, v255
    s_nop 3
    s_branch L_back_2_5
.section .rodata,"a"
.p2align 6
.amdhsa_kernel standalone__gqa_softmax__near_ridge_kernel
  .amdhsa_next_free_vgpr 256
  .amdhsa_next_free_sgpr 98
  .amdhsa_accum_offset 256
  .amdhsa_group_segment_fixed_size 0
  .amdhsa_kernarg_size 48
  .amdhsa_user_sgpr_count 2
  .amdhsa_user_sgpr_kernarg_segment_ptr 1
  .amdhsa_system_sgpr_workgroup_id_x 1
.end_amdhsa_kernel
```
